```python
import torch

def _softmax(x, axis=-1):
    return torch.softmax(x, dim=axis)
def _gelu(x):
    return torch.nn.functional.gelu(x, approximate="tanh")
def _silu(x):
    return torch.nn.functional.silu(x)
def _sigmoid(x):
    return torch.sigmoid(x)
def _layernorm(x, axis=-1, eps=1e-5):
    m = x.mean(dim=axis, keepdim=True)
    v = x.var(dim=axis, keepdim=True, unbiased=False)
    return (x - m) / torch.sqrt(v + eps)
def _scatter_add(tgt, idx, src, axis=0):
    return tgt.clone().index_add_(axis, idx, src)
def _segment_sum(src, seg, n):
    out = torch.zeros((n,) + src.shape[1:], dtype=src.dtype)
    return out.index_add_(0, seg, src)
def _pad(x, pw):
    flat = tuple(v for pair in reversed(pw) for v in pair)
    return torch.nn.functional.pad(x, flat)

kernel_name = 'concat_heads__mha_block_cached__mha_block_cached__near_ridge'

def setup_inputs():

    _w = (lambda a: (lambda t: t.to(torch.bfloat16) if t.is_floating_point() else t)(torch.as_tensor(a)))
    def _A_setup():
        B, Sq, D = 16, 192, 512
        H, Sk, Dh = 32, 512, 128
        return {
            "x": _w((lambda *s: torch.randn(*s, dtype=torch.bfloat16) * 0.8)(B, Sq, D)),
            "k_cache": _w((lambda *s: torch.randn(*s, dtype=torch.bfloat16) * 0.8)(B, H, Sk, Dh)),
            "v_cache": _w((lambda *s: torch.randn(*s, dtype=torch.bfloat16) * 0.05)(B, H, Sk, Dh)),
            "wq": _w((lambda *s: torch.randn(*s, dtype=torch.bfloat16) * 0.8)(D, H * Dh) * (D ** -0.5)),
            "wo": _w((lambda *s: torch.randn(*s, dtype=torch.bfloat16) * 0.05)(H * Dh, D) * ((H * Dh) ** -0.5)),
        }
    _A_in = _A_setup()

    def _B_setup():
        B, Sq, D = 16, 192, 512
        H, Sk, Dh = 32, 512, 128
        return {
            "x": _w((lambda *s: torch.randn(*s, dtype=torch.bfloat16) * 0.8)(B, Sq, D)),
            "k_cache": _w((lambda *s: torch.randn(*s, dtype=torch.bfloat16) * 0.8)(B, H, Sk, Dh)),
            "v_cache": _w((lambda *s: torch.randn(*s, dtype=torch.bfloat16) * 0.05)(B, H, Sk, Dh)),
            "wq": _w((lambda *s: torch.randn(*s, dtype=torch.bfloat16) * 0.8)(D, H * Dh) * (D ** -0.5)),
            "wo": _w((lambda *s: torch.randn(*s, dtype=torch.bfloat16) * 0.05)(H * Dh, D) * ((H * Dh) ** -0.5)),
        }
    _B_in = _B_setup()

    return {
        "A_x": _A_in["x"],
        "A_k_cache": _A_in["k_cache"],
        "A_v_cache": _A_in["v_cache"],
        "A_wq": _A_in["wq"],
        "A_wo": _A_in["wo"],
        "B_x": _B_in["x"],
        "B_k_cache": _B_in["k_cache"],
        "B_v_cache": _B_in["v_cache"],
        "B_wq": _B_in["wq"],
        "B_wo": _B_in["wo"],
    }

def reference(A_x, A_k_cache, A_v_cache, A_wq, A_wo, B_x, B_k_cache, B_v_cache, B_wq, B_wo):
    def _A_ref(x, k_cache, v_cache, wq, wo):
        B, Sq, D = x.shape
        H, Dh = 32, 128
        q = (lambda x, *d: x.permute(*d))((x @ wq).reshape(B, Sq, H, Dh), 0, 2, 1, 3)
        scores = torch.einsum("bhqd,bhkd->bhqk", q, k_cache) * (Dh ** -0.5)
        p = _softmax(scores, axis=-1)
        o = torch.einsum("bhqk,bhkd->bhqd", p, v_cache)
        return (lambda x, *d: x.permute(*d))(o, 0, 2, 1, 3).reshape(B, Sq, H * Dh) @ wo

    def _B_ref(x, k_cache, v_cache, wq, wo):
        B, Sq, D = x.shape
        H, Dh = 32, 128
        q = (lambda x, *d: x.permute(*d))((x @ wq).reshape(B, Sq, H, Dh), 0, 2, 1, 3)
        scores = torch.einsum("bhqd,bhkd->bhqk", q, k_cache) * (Dh ** -0.5)
        p = _softmax(scores, axis=-1)
        o = torch.einsum("bhqk,bhkd->bhqd", p, v_cache)
        return (lambda x, *d: x.permute(*d))(o, 0, 2, 1, 3).reshape(B, Sq, H * Dh) @ wo

    a = _A_ref(A_x, A_k_cache, A_v_cache, A_wq, A_wo)
    b = _B_ref(B_x, B_k_cache, B_v_cache, B_wq, B_wo)
    return torch.concatenate([a, b], axis=-1)
```

```asm
; @launch grid=(256,1,1) block=(256,1,1) lds=163840
.amdgcn_target "amdgcn-amd-amdhsa--gfx950"
.text
.globl concat_heads__mha_block_cached__mha_block_cached__near_ridge_kernel
.p2align 8
.type concat_heads__mha_block_cached__mha_block_cached__near_ridge_kernel,@function
concat_heads__mha_block_cached__mha_block_cached__near_ridge_kernel:
    s_cmp_lt_u32 s2, 0x100
    s_cbranch_scc1 L_start
    s_endpgm
L_start:
    s_load_dwordx16 s[48:63], s[0:1], 0
    s_load_dwordx4 s[64:67], s[0:1], 64
    s_load_dwordx4 s[68:71], s[0:1], 80
    s_load_dwordx2 s[72:73], s[0:1], 96
    v_lshrrev_b32 v232, 6, v0
    v_and_b32 v14, 63, v0
    v_readfirstlane_b32 s40, v232
    s_and_b32 s84, s2, 7
    s_lshr_b32 s85, s2, 3
    s_lshr_b32 s86, s84, 2
    s_and_b32 s87, s84, 3
    s_lshl_b32 s87, s87, 2
    s_lshr_b32 s42, s85, 3
    s_add_u32 s87, s87, s42
    s_and_b32 s41, s85, 7
    s_lshl_b32 s42, s86, 4
    s_add_u32 s42, s42, s87
    s_memrealtime s[100:101]
    v_and_b32 v233, 15, v14
    v_lshrrev_b32 v234, 4, v14
    v_bfe_u32 v235, v14, 2, 2
    v_and_b32 v236, 3, v14
    s_movk_i32 s84, 1056
    v_mul_lo_u32 v1, v235, s84
    v_lshl_add_u32 v1, v236, 6, v1
    v_lshl_add_u32 v1, v234, 4, v1
    v_mul_lo_u32 v2, v234, s84
    v_lshl_add_u32 v2, v235, 6, v2
    v_lshl_add_u32 v2, v236, 3, v2
    v_add_u32 v2, 8448, v2
    v_lshlrev_b32 v3, 11, v234
    v_and_b32 v237, 1, v234
    v_lshl_add_u32 v3, v237, 3, v3
    v_lshrrev_b32 v237, 1, v234
    v_lshl_add_u32 v3, v237, 4, v3
    v_lshl_add_u32 v3, v235, 6, v3
    v_lshl_add_u32 v3, v236, 4, v3
    v_add_u32 v3, 16896, v3
    v_bfe_u32 v237, v14, 1, 3
    v_xor_b32 v237, v237, v234
    v_mul_u32_u24 v4, 6144, v232
    v_bfe_u32 v238, v14, 3, 1
    v_lshl_add_u32 v4, v238, 10, v4
    v_and_b32 v238, 7, v14
    v_lshl_add_u32 v4, v238, 7, v4
    v_add_u32 v4, 100480, v4
    v_xor_b32 v238, 4, v237
    v_lshl_add_u32 v10, v238, 4, v4
    v_lshl_add_u32 v4, v237, 4, v4
    v_lshlrev_b32 v5, 11, v232
    v_lshl_add_u32 v5, v235, 8, v5
    v_lshl_add_u32 v5, v234, 6, v5
    v_lshl_add_u32 v5, v236, 4, v5
    v_lshlrev_b32 v6, 16, v232
    v_lshl_add_u32 v6, v235, 13, v6
    v_lshl_add_u32 v6, v234, 6, v6
    v_lshl_add_u32 v6, v236, 4, v6
    v_add_u32 v7, 31744, v6
    v_add_u32 v247, 32, v5
    v_add_u32 v5, 64, v5
    v_lshrrev_b32 v238, 3, v14
    v_lshrrev_b32 v237, 1, v238
    v_and_b32 v8, 7, v14
    v_xor_b32 v237, v237, v8
    v_mul_u32_u24 v8, 48, v232
    v_add_u32 v8, v8, v238
    v_lshlrev_b32 v8, 10, v8
    v_lshl_add_u32 v8, v237, 4, v8
    v_lshrrev_b32 v238, 3, v14
    v_lshrrev_b32 v237, 1, v238
    v_add_u32 v237, 4, v237
    v_and_b32 v9, 7, v14
    v_xor_b32 v237, v237, v9
    v_mul_u32_u24 v9, 48, v232
    v_add_u32 v9, v9, v238
    v_add_u32 v9, 8, v9
    v_lshlrev_b32 v9, 10, v9
    v_lshl_add_u32 v9, v237, 4, v9
    v_add_u32 v246, 30720, v9
    v_add_u32 v245, 31744, v8
    v_add_u32 v244, 16384, v9
    v_add_u32 v15, 14336, v8
    v_add_u32 v9, 4294966272, v9
    s_mul_i32 s74, s40, 2112
    s_add_u32 s75, s74, 32
    s_add_u32 s76, s74, 8448
    s_add_u32 s77, s74, 8480
    s_lshl_b32 s78, s40, 11
    s_and_b32 s84, s40, 1
    s_lshl_b32 s84, s84, 3
    s_add_u32 s78, s78, s84
    s_lshr_b32 s84, s40, 1
    s_lshl_b32 s84, s84, 4
    s_add_u32 s78, s78, s84
    s_add_u32 s78, s78, 16896
    s_add_u32 s79, s78, 1024
    s_mul_i32 s80, s40, 6144
    s_add_u32 s80, s80, 100480
    s_add_u32 s81, s80, 24576
    s_xor_b32 s81, s81, s80
    s_mov_b32 s99, 24576
    s_mov_b32 s88, 1040356334
    s_mov_b32 s89, 1040356334
    s_waitcnt lgkmcnt(0)
    s_cmp_eq_u32 s86, 0
    s_cselect_b64 s[48:49], s[48:49], s[58:59]
    s_cselect_b64 s[50:51], s[50:51], s[60:61]
    s_cselect_b64 s[52:53], s[52:53], s[62:63]
    s_cselect_b64 s[54:55], s[54:55], s[64:65]
    s_cselect_b64 s[56:57], s[56:57], s[66:67]
    s_mul_i32 s58, s87, 196608
    s_add_u32 s8, s48, s58
    s_addc_u32 s9, s49, 0
    s_mov_b32 s10, 196608
    s_mov_b32 s11, 131072
    s_lshl_b32 s58, s41, 10
    s_sub_u32 s59, 4194304, s58
    s_add_u32 s20, s54, s58
    s_addc_u32 s21, s55, 0
    s_mov_b32 s22, s59
    s_mov_b32 s23, 131072
    s_lshl_b32 s58, s87, 5
    s_lshl_b32 s59, s41, 2
    s_add_u32 s58, s58, s59
    s_lshl_b32 s58, s58, 17
    s_add_u32 s12, s50, s58
    s_addc_u32 s13, s51, 0
    s_mov_b32 s14, 524352
    s_mov_b32 s15, 131072
    s_sub_u32 s12, s12, 64
    s_subb_u32 s13, s13, 0
    s_add_u32 s16, s52, s58
    s_addc_u32 s17, s53, 0
    s_sub_u32 s16, s16, 16448
    s_subb_u32 s17, s17, 0
    s_mov_b32 s18, 540736
    s_mov_b32 s19, 131072
    s_lshl_b32 s58, s41, 19
    s_add_u32 s24, s56, s58
    s_addc_u32 s25, s57, 0
    s_mov_b32 s26, 524288
    s_mov_b32 s27, 131072
    s_mul_i32 s58, s87, 393216
    s_lshl_b32 s59, s86, 10
    s_add_u32 s58, s58, s59
    s_sub_u32 s59, 6291456, s58
    s_add_u32 s32, s68, s58
    s_addc_u32 s33, s69, 0
    s_mov_b32 s34, s59
    s_mov_b32 s35, 131072
    s_mul_i32 s58, s42, 1581056
    s_add_u32 s58, s58, 0
    s_add_u32 s28, s72, s58
    s_addc_u32 s29, s73, 0
    s_mov_b32 s30, 1581056
    s_mov_b32 s31, 131072
    s_mov_b32 s58, 0
    s_add_u32 s36, s70, s58
    s_addc_u32 s37, s71, 0
    s_mov_b32 s38, 256
    s_mov_b32 s39, 131072
    s_mov_b32 s58, 67108864
    s_add_u32 s92, s72, s58
    s_addc_u32 s93, s73, 0
    s_mov_b32 s94, 67108864
    s_mov_b32 s95, 131072
    s_mov_b32 s45, 0
    s_mov_b32 s44, 0
    v_subrev_u32 v255, 16896, v3
    s_sub_u32 s96, s78, 16896
    s_sub_u32 s97, s79, 16896
    s_mul_i32 s84, s41, 96
    s_mul_i32 s85, s40, 24
    s_add_u32 s84, s84, s85
    v_min_u32 v236, 23, v14
    v_add_u32 v236, s84, v236
    v_and_b32 v237, 3, v236
    v_lshrrev_b32 v236, 2, v236
    v_lshlrev_b32 v236, 10, v236
    v_lshl_add_u32 v236, v237, 7, v236
    buffer_load_dword v238, v236, s[8:11], 0 offen nt
    s_and_b32 s84, s42, 3
    s_mul_i32 s84, s84, 128
    s_mul_i32 s85, s40, 32
    s_add_u32 s84, s84, s85
    v_min_u32 v236, 31, v14
    v_add_u32 v236, s84, v236
    v_and_b32 v237, 1, v236
    v_lshrrev_b32 v236, 1, v236
    v_add_u32 v236, 0, v236
    v_lshlrev_b32 v236, 13, v236
    v_lshl_add_u32 v236, v237, 7, v236
    buffer_load_dword v239, v236, s[20:23], 0 offen nt
    s_mov_b32 m0, s80
    s_nop 0
    buffer_load_dwordx4 v8, s[8:11], s44 offen lds
    buffer_load_dwordx4 v9, s[8:11], s44 offen offset:1024 lds
    buffer_load_dwordx4 v15, s[8:11], s44 offen offset:2048 lds
    s_add_u32 m0, s80, 3072
    s_nop 0
    buffer_load_dwordx4 v244, s[8:11], s44 offen lds
    buffer_load_dwordx4 v245, s[8:11], s44 offen offset:1024 lds
    buffer_load_dwordx4 v246, s[8:11], s44 offen offset:2048 lds
    s_add_u32 s44, s44, 128
    s_and_b32 s44, s44, 1023
    s_xor_b32 s80, s80, s81
    s_mov_b32 s46, 0
    s_add_u32 m0, s46, s96
    s_nop 0
    buffer_load_dwordx4 v6, s[20:23], s45 offen nt lds
    buffer_load_dwordx4 v7, s[20:23], s45 offen offset:1024 nt lds
    s_add_u32 s45, s45, 262144
    s_cmp_ge_u32 s45, 4194304
    s_cselect_b32 s84, 4194048, 0
    s_sub_u32 s45, s45, s84
    s_add_u32 m0, s46, s78
    s_nop 0
    buffer_load_dwordx4 v6, s[20:23], s45 offen nt lds
    buffer_load_dwordx4 v7, s[20:23], s45 offen offset:1024 nt lds
    s_add_u32 s45, s45, 262144
    s_cmp_ge_u32 s45, 4194304
    s_cselect_b32 s84, 4194048, 0
    s_sub_u32 s45, s45, s84
    s_mov_b32 s46, 25120
    s_add_u32 m0, s46, s96
    s_nop 0
    buffer_load_dwordx4 v6, s[20:23], s45 offen nt lds
    buffer_load_dwordx4 v7, s[20:23], s45 offen offset:1024 nt lds
    s_add_u32 s45, s45, 262144
    s_cmp_ge_u32 s45, 4194304
    s_cselect_b32 s84, 4194048, 0
    s_sub_u32 s45, s45, s84
    s_add_u32 m0, s46, s78
    s_nop 0
    buffer_load_dwordx4 v6, s[20:23], s45 offen nt lds
    buffer_load_dwordx4 v7, s[20:23], s45 offen offset:1024 nt lds
    s_add_u32 s45, s45, 262144
    s_cmp_ge_u32 s45, 4194304
    s_cselect_b32 s84, 4194048, 0
    s_sub_u32 s45, s45, s84
    s_mov_b32 s46, 50240
    s_add_u32 m0, s46, s96
    s_nop 0
    buffer_load_dwordx4 v6, s[20:23], s45 offen nt lds
    buffer_load_dwordx4 v7, s[20:23], s45 offen offset:1024 nt lds
    s_add_u32 s45, s45, 262144
    s_cmp_ge_u32 s45, 4194304
    s_cselect_b32 s84, 4194048, 0
    s_sub_u32 s45, s45, s84
    s_add_u32 m0, s46, s78
    s_nop 0
    buffer_load_dwordx4 v6, s[20:23], s45 offen nt lds
    buffer_load_dwordx4 v7, s[20:23], s45 offen offset:1024 nt lds
    s_add_u32 s45, s45, 262144
    s_cmp_ge_u32 s45, 4194304
    s_cselect_b32 s84, 4194048, 0
    s_sub_u32 s45, s45, s84
    s_getpc_b64 s[60:61]
L_pca:
    s_mov_b32 s62, L_codeend-L_pca
    s_mov_b32 s63, 131072
    v_lshlrev_b32 v236, 7, v0
    buffer_load_dword v240, v236, s[60:63], 0 offen
    v_add_u32 v237, 32768, v236
    buffer_load_dword v243, v237, s[60:63], 0 offen
    s_mul_i32 s84, s41, 96
    s_mul_i32 s85, s40, 24
    s_add_u32 s84, s84, s85
    v_min_u32 v236, 23, v14
    v_add_u32 v236, s84, v236
    v_and_b32 v237, 3, v236
    v_lshrrev_b32 v236, 2, v236
    v_lshlrev_b32 v236, 10, v236
    v_lshl_add_u32 v236, v237, 7, v236
    s_waitcnt vmcnt(21)
    buffer_load_dword v238, v236, s[8:11], 0 offen offset:512 nt
    s_and_b32 s84, s42, 3
    s_mul_i32 s84, s84, 128
    s_mul_i32 s85, s40, 32
    s_add_u32 s84, s84, s85
    v_min_u32 v236, 31, v14
    v_add_u32 v236, s84, v236
    v_and_b32 v237, 1, v236
    v_lshrrev_b32 v236, 1, v236
    v_add_u32 v236, 256, v236
    v_lshlrev_b32 v236, 13, v236
    v_lshl_add_u32 v236, v237, 7, v236
    s_waitcnt vmcnt(21)
    buffer_load_dword v239, v236, s[20:23], 0 offen nt
    s_mov_b32 s46, 0
    s_add_u32 m0, s46, s76
    s_nop 0
    buffer_load_dwordx4 v5, s[12:15], 0 offen nt lds
    buffer_load_dwordx4 v247, s[12:15], 0 offen offset:1056 nt lds
    s_mov_b32 s46, 75360
    s_mov_b32 s47, 0
    s_mov_b32 s83, 50240
    s_mov_b32 s43, 8192
    v_accvgpr_write_b32 a0, 0
    v_accvgpr_write_b32 a1, 0
    v_accvgpr_write_b32 a2, 0
    v_accvgpr_write_b32 a3, 0
    v_accvgpr_write_b32 a4, 0
    v_accvgpr_write_b32 a5, 0
    v_accvgpr_write_b32 a6, 0
    v_accvgpr_write_b32 a7, 0
    v_accvgpr_write_b32 a8, 0
    v_accvgpr_write_b32 a9, 0
    v_accvgpr_write_b32 a10, 0
    v_accvgpr_write_b32 a11, 0
    v_accvgpr_write_b32 a12, 0
    v_accvgpr_write_b32 a13, 0
    v_accvgpr_write_b32 a14, 0
    v_accvgpr_write_b32 a15, 0
    v_accvgpr_write_b32 a16, 0
    v_accvgpr_write_b32 a17, 0
    v_accvgpr_write_b32 a18, 0
    v_accvgpr_write_b32 a19, 0
    v_accvgpr_write_b32 a20, 0
    v_accvgpr_write_b32 a21, 0
    v_accvgpr_write_b32 a22, 0
    v_accvgpr_write_b32 a23, 0
    v_accvgpr_write_b32 a24, 0
    v_accvgpr_write_b32 a25, 0
    v_accvgpr_write_b32 a26, 0
    v_accvgpr_write_b32 a27, 0
    v_accvgpr_write_b32 a28, 0
    v_accvgpr_write_b32 a29, 0
    v_accvgpr_write_b32 a30, 0
    v_accvgpr_write_b32 a31, 0
    v_accvgpr_write_b32 a32, 0
    v_accvgpr_write_b32 a33, 0
    v_accvgpr_write_b32 a34, 0
    v_accvgpr_write_b32 a35, 0
    v_accvgpr_write_b32 a36, 0
    v_accvgpr_write_b32 a37, 0
    v_accvgpr_write_b32 a38, 0
    v_accvgpr_write_b32 a39, 0
    v_accvgpr_write_b32 a40, 0
    v_accvgpr_write_b32 a41, 0
    v_accvgpr_write_b32 a42, 0
    v_accvgpr_write_b32 a43, 0
    v_accvgpr_write_b32 a44, 0
    v_accvgpr_write_b32 a45, 0
    v_accvgpr_write_b32 a46, 0
    v_accvgpr_write_b32 a47, 0
    v_accvgpr_write_b32 a48, 0
    v_accvgpr_write_b32 a49, 0
    v_accvgpr_write_b32 a50, 0
    v_accvgpr_write_b32 a51, 0
    v_accvgpr_write_b32 a52, 0
    v_accvgpr_write_b32 a53, 0
    v_accvgpr_write_b32 a54, 0
    v_accvgpr_write_b32 a55, 0
    v_accvgpr_write_b32 a56, 0
    v_accvgpr_write_b32 a57, 0
    v_accvgpr_write_b32 a58, 0
    v_accvgpr_write_b32 a59, 0
    v_accvgpr_write_b32 a60, 0
    v_accvgpr_write_b32 a61, 0
    v_accvgpr_write_b32 a62, 0
    v_accvgpr_write_b32 a63, 0
    v_accvgpr_write_b32 a64, 0
    v_accvgpr_write_b32 a65, 0
    v_accvgpr_write_b32 a66, 0
    v_accvgpr_write_b32 a67, 0
    v_accvgpr_write_b32 a68, 0
    v_accvgpr_write_b32 a69, 0
    v_accvgpr_write_b32 a70, 0
    v_accvgpr_write_b32 a71, 0
    v_accvgpr_write_b32 a72, 0
    v_accvgpr_write_b32 a73, 0
    v_accvgpr_write_b32 a74, 0
    v_accvgpr_write_b32 a75, 0
    v_accvgpr_write_b32 a76, 0
    v_accvgpr_write_b32 a77, 0
    v_accvgpr_write_b32 a78, 0
    v_accvgpr_write_b32 a79, 0
    v_accvgpr_write_b32 a80, 0
    v_accvgpr_write_b32 a81, 0
    v_accvgpr_write_b32 a82, 0
    v_accvgpr_write_b32 a83, 0
    v_accvgpr_write_b32 a84, 0
    v_accvgpr_write_b32 a85, 0
    v_accvgpr_write_b32 a86, 0
    v_accvgpr_write_b32 a87, 0
    v_accvgpr_write_b32 a88, 0
    v_accvgpr_write_b32 a89, 0
    v_accvgpr_write_b32 a90, 0
    v_accvgpr_write_b32 a91, 0
    v_accvgpr_write_b32 a92, 0
    v_accvgpr_write_b32 a93, 0
    v_accvgpr_write_b32 a94, 0
    v_accvgpr_write_b32 a95, 0
    s_or_b32 s84, s2, s40
    s_cbranch_scc1 L_nonon
    s_or_b32 s84, s100, 1
    v_mov_b32 v241, s84
    v_mov_b32 v242, 0
    buffer_store_dword v241, v242, s[36:39], 0 offen sc1
L_nonon:
    s_waitcnt vmcnt(14)
    s_barrier
    ds_read_b128 a[192:195], v4 offset:0
    ds_read_b128 a[196:199], v4 offset:2048
    ds_read_b128 a[200:203], v4 offset:4096
    ds_read_b64_tr_b16 a[216:217], v255 offset:0
    ds_read_b64_tr_b16 a[218:219], v255 offset:1024
    ds_read_b64_tr_b16 a[220:221], v255 offset:8
    ds_read_b64_tr_b16 a[222:223], v255 offset:1032
    ds_read_b64_tr_b16 a[224:225], v255 offset:256
    ds_read_b64_tr_b16 a[226:227], v255 offset:1280
    ds_read_b64_tr_b16 a[228:229], v255 offset:264
    ds_read_b64_tr_b16 a[230:231], v255 offset:1288
    s_waitcnt lgkmcnt(0)
    v_mfma_f32_16x16x32_bf16 a[0:3], a[216:219], a[192:195], a[0:3]
    ds_read_b64_tr_b16 a[232:233], v255 offset:512
    v_add_u32 v4, s99, v4
    v_mfma_f32_16x16x32_bf16 a[4:7], a[216:219], a[196:199], a[4:7]
    ds_read_b64_tr_b16 a[234:235], v255 offset:1536
    s_mov_b32 m0, s80
    s_nop 0
    buffer_load_dwordx4 v8, s[8:11], s44 offen lds
    v_mfma_f32_16x16x32_bf16 a[8:11], a[216:219], a[200:203], a[8:11]
    ds_read_b128 a[204:207], v10 offset:0
    v_mfma_f32_16x16x32_bf16 a[12:15], a[220:223], a[192:195], a[12:15]
    ds_read_b64_tr_b16 a[236:237], v255 offset:520
    v_mfma_f32_16x16x32_bf16 a[16:19], a[220:223], a[196:199], a[16:19]
    ds_read_b64_tr_b16 a[238:239], v255 offset:1544
    buffer_load_dwordx4 v9, s[8:11], s44 offen offset:1024 lds
    v_mfma_f32_16x16x32_bf16 a[20:23], a[220:223], a[200:203], a[20:23]
    ds_read_b128 a[208:211], v10 offset:2048
    v_mfma_f32_16x16x32_bf16 a[24:27], a[224:227], a[192:195], a[24:27]
    ds_read_b64_tr_b16 a[240:241], v255 offset:768
    v_mfma_f32_16x16x32_bf16 a[28:31], a[224:227], a[196:199], a[28:31]
    ds_read_b64_tr_b16 a[242:243], v255 offset:1792
    buffer_load_dwordx4 v15, s[8:11], s44 offen offset:2048 lds
    v_mfma_f32_16x16x32_bf16 a[32:35], a[224:227], a[200:203], a[32:35]
    ds_read_b128 a[212:215], v10 offset:4096
    v_mfma_f32_16x16x32_bf16 a[36:39], a[228:231], a[192:195], a[36:39]
    ds_read_b64_tr_b16 a[244:245], v255 offset:776
    v_add_u32 v10, s99, v10
    v_mfma_f32_16x16x32_bf16 a[40:43], a[228:231], a[196:199], a[40:43]
    ds_read_b64_tr_b16 a[246:247], v255 offset:1800
    s_add_u32 m0, s80, 3072
    s_nop 0
    buffer_load_dwordx4 v244, s[8:11], s44 offen lds
    v_mfma_f32_16x16x32_bf16 a[44:47], a[228:231], a[200:203], a[44:47]
    s_waitcnt lgkmcnt(9)
    s_sub_u32 s99, 0, s99
    v_mfma_f32_16x16x32_bf16 a[48:51], a[232:235], a[192:195], a[48:51]
    ds_read_b64_tr_b16 a[216:217], v3 offset:0
    v_mfma_f32_16x16x32_bf16 a[52:55], a[232:235], a[196:199], a[52:55]
    ds_read_b64_tr_b16 a[218:219], v3 offset:1024
    buffer_load_dwordx4 v245, s[8:11], s44 offen offset:1024 lds
    v_mfma_f32_16x16x32_bf16 a[56:59], a[232:235], a[200:203], a[56:59]
    s_waitcnt lgkmcnt(8)
    v_mfma_f32_16x16x32_bf16 a[60:63], a[236:239], a[192:195], a[60:63]
    ds_read_b64_tr_b16 a[220:221], v3 offset:8
    v_mfma_f32_16x16x32_bf16 a[64:67], a[236:239], a[196:199], a[64:67]
    ds_read_b64_tr_b16 a[222:223], v3 offset:1032
    buffer_load_dwordx4 v246, s[8:11], s44 offen offset:2048 lds
    s_add_u32 s44, s44, 128
    s_and_b32 s44, s44, 1023
    s_xor_b32 s80, s80, s81
    v_mfma_f32_16x16x32_bf16 a[68:71], a[236:239], a[200:203], a[68:71]
    s_waitcnt lgkmcnt(7)
    v_mfma_f32_16x16x32_bf16 a[72:75], a[240:243], a[192:195], a[72:75]
    ds_read_b64_tr_b16 a[224:225], v3 offset:256
    v_mfma_f32_16x16x32_bf16 a[76:79], a[240:243], a[196:199], a[76:79]
    ds_read_b64_tr_b16 a[226:227], v3 offset:1280
    v_mfma_f32_16x16x32_bf16 a[80:83], a[240:243], a[200:203], a[80:83]
    s_add_u32 m0, s46, s96
    s_waitcnt lgkmcnt(6)
    buffer_load_dwordx4 v6, s[20:23], s45 offen nt lds
    v_mfma_f32_16x16x32_bf16 a[84:87], a[244:247], a[192:195], a[84:87]
    ds_read_b64_tr_b16 a[228:229], v3 offset:264
    v_mfma_f32_16x16x32_bf16 a[88:91], a[244:247], a[196:199], a[88:91]
    ds_read_b64_tr_b16 a[230:231], v3 offset:1288
    v_mfma_f32_16x16x32_bf16 a[92:95], a[244:247], a[200:203], a[92:95]
    s_waitcnt lgkmcnt(6)
    buffer_load_dwordx4 v7, s[20:23], s45 offen offset:1024 nt lds
    s_add_u32 s45, s45, 262144
    s_cmp_ge_u32 s45, 4194304
    s_cselect_b32 s84, 4194048, 0
    s_sub_u32 s45, s45, s84
    v_mfma_f32_16x16x32_bf16 a[0:3], a[216:219], a[204:207], a[0:3]
    ds_read_b64_tr_b16 a[232:233], v3 offset:512
    v_mfma_f32_16x16x32_bf16 a[4:7], a[216:219], a[208:211], a[4:7]
    ds_read_b64_tr_b16 a[234:235], v3 offset:1536
    v_mfma_f32_16x16x32_bf16 a[8:11], a[216:219], a[212:215], a[8:11]
    s_add_u32 m0, s46, s78
    s_waitcnt lgkmcnt(6)
    buffer_load_dwordx4 v6, s[20:23], s45 offen nt lds
    v_mfma_f32_16x16x32_bf16 a[12:15], a[220:223], a[204:207], a[12:15]
    ds_read_b64_tr_b16 a[236:237], v3 offset:520
    s_xor_b32 s46, s46, 83008
    v_mfma_f32_16x16x32_bf16 a[16:19], a[220:223], a[208:211], a[16:19]
    ds_read_b64_tr_b16 a[238:239], v3 offset:1544
    v_mfma_f32_16x16x32_bf16 a[20:23], a[220:223], a[212:215], a[20:23]
    s_waitcnt lgkmcnt(6)
    buffer_load_dwordx4 v7, s[20:23], s45 offen offset:1024 nt lds
    s_add_u32 s45, s45, 262144
    s_cmp_ge_u32 s45, 4194304
    s_cselect_b32 s84, 4194048, 0
    s_sub_u32 s45, s45, s84
    v_mfma_f32_16x16x32_bf16 a[24:27], a[224:227], a[204:207], a[24:27]
    ds_read_b64_tr_b16 a[240:241], v3 offset:768
    v_mfma_f32_16x16x32_bf16 a[28:31], a[224:227], a[208:211], a[28:31]
    ds_read_b64_tr_b16 a[242:243], v3 offset:1792
    v_mfma_f32_16x16x32_bf16 a[32:35], a[224:227], a[212:215], a[32:35]
    s_waitcnt lgkmcnt(6)
    v_mfma_f32_16x16x32_bf16 a[36:39], a[228:231], a[204:207], a[36:39]
    ds_read_b64_tr_b16 a[244:245], v3 offset:776
    v_mfma_f32_16x16x32_bf16 a[40:43], a[228:231], a[208:211], a[40:43]
    ds_read_b64_tr_b16 a[246:247], v3 offset:1800
    v_mfma_f32_16x16x32_bf16 a[44:47], a[228:231], a[212:215], a[44:47]
    s_waitcnt lgkmcnt(6)
    v_mfma_f32_16x16x32_bf16 a[48:51], a[232:235], a[204:207], a[48:51]
    s_waitcnt vmcnt(4)
    s_barrier
    s_waitcnt lgkmcnt(0)
    v_mfma_f32_16x16x32_bf16 a[52:55], a[232:235], a[208:211], a[52:55]
    ds_read_b64_tr_b16 a[216:217], v255 offset:25120
    s_mov_b32 m0, s80
    s_nop 0
    buffer_load_dwordx4 v8, s[8:11], s44 offen lds
    v_mfma_f32_16x16x32_bf16 a[56:59], a[232:235], a[212:215], a[56:59]
    ds_read_b64_tr_b16 a[218:219], v255 offset:26144
    v_mfma_f32_16x16x32_bf16 a[60:63], a[236:239], a[204:207], a[60:63]
    ds_read_b128 a[192:195], v4 offset:0
    v_mfma_f32_16x16x32_bf16 a[64:67], a[236:239], a[208:211], a[64:67]
    ds_read_b64_tr_b16 a[220:221], v255 offset:25128
    buffer_load_dwordx4 v9, s[8:11], s44 offen offset:1024 lds
    v_mfma_f32_16x16x32_bf16 a[68:71], a[236:239], a[212:215], a[68:71]
    ds_read_b64_tr_b16 a[222:223], v255 offset:26152
    v_mfma_f32_16x16x32_bf16 a[72:75], a[240:243], a[204:207], a[72:75]
    ds_read_b128 a[196:199], v4 offset:2048
    v_mfma_f32_16x16x32_bf16 a[76:79], a[240:243], a[208:211], a[76:79]
    ds_read_b64_tr_b16 a[224:225], v255 offset:25376
    buffer_load_dwordx4 v15, s[8:11], s44 offen offset:2048 lds
    v_mfma_f32_16x16x32_bf16 a[80:83], a[240:243], a[212:215], a[80:83]
    ds_read_b64_tr_b16 a[226:227], v255 offset:26400
    v_mfma_f32_16x16x32_bf16 a[84:87], a[244:247], a[204:207], a[84:87]
    ds_read_b128 a[200:203], v4 offset:4096
    v_mfma_f32_16x16x32_bf16 a[88:91], a[244:247], a[208:211], a[88:91]
    ds_read_b64_tr_b16 a[228:229], v255 offset:25384
    s_add_u32 m0, s80, 3072
    s_nop 0
    buffer_load_dwordx4 v244, s[8:11], s44 offen lds
    v_mfma_f32_16x16x32_bf16 a[92:95], a[244:247], a[212:215], a[92:95]
    ds_read_b64_tr_b16 a[230:231], v255 offset:26408
    v_add_u32 v4, s99, v4
    s_waitcnt lgkmcnt(8)
    v_mfma_f32_16x16x32_bf16 a[0:3], a[216:219], a[192:195], a[0:3]
    ds_read_b64_tr_b16 a[232:233], v255 offset:25632
    s_waitcnt lgkmcnt(6)
    v_mfma_f32_16x16x32_bf16 a[4:7], a[216:219], a[196:199], a[4:7]
    ds_read_b64_tr_b16 a[234:235], v255 offset:26656
    buffer_load_dwordx4 v245, s[8:11], s44 offen offset:1024 lds
    s_waitcnt lgkmcnt(4)
    v_mfma_f32_16x16x32_bf16 a[8:11], a[216:219], a[200:203], a[8:11]
    ds_read_b128 a[204:207], v10 offset:0
    v_mfma_f32_16x16x32_bf16 a[12:15], a[220:223], a[192:195], a[12:15]
    ds_read_b64_tr_b16 a[236:237], v255 offset:25640
    v_mfma_f32_16x16x32_bf16 a[16:19], a[220:223], a[196:199], a[16:19]
    ds_read_b64_tr_b16 a[238:239], v255 offset:26664
    buffer_load_dwordx4 v246, s[8:11], s44 offen offset:2048 lds
    s_add_u32 s44, s44, 128
    s_and_b32 s44, s44, 1023
    s_xor_b32 s80, s80, s81
    v_mfma_f32_16x16x32_bf16 a[20:23], a[220:223], a[200:203], a[20:23]
    ds_read_b128 a[208:211], v10 offset:2048
    v_mfma_f32_16x16x32_bf16 a[24:27], a[224:227], a[192:195], a[24:27]
    ds_read_b64_tr_b16 a[240:241], v255 offset:25888
    v_mfma_f32_16x16x32_bf16 a[28:31], a[224:227], a[196:199], a[28:31]
    ds_read_b64_tr_b16 a[242:243], v255 offset:26912
    v_mfma_f32_16x16x32_bf16 a[32:35], a[224:227], a[200:203], a[32:35]
    ds_read_b128 a[212:215], v10 offset:4096
    s_add_u32 m0, s47, s96
    s_nop 0
    buffer_load_dwordx4 v6, s[20:23], s45 offen nt lds
    s_waitcnt lgkmcnt(9)
    v_mfma_f32_16x16x32_bf16 a[36:39], a[228:231], a[192:195], a[36:39]
    ds_read_b64_tr_b16 a[244:245], v255 offset:25896
    v_add_u32 v10, s99, v10
    v_mfma_f32_16x16x32_bf16 a[40:43], a[228:231], a[196:199], a[40:43]
    ds_read_b64_tr_b16 a[246:247], v255 offset:26920
    s_sub_u32 s99, 0, s99
    v_mfma_f32_16x16x32_bf16 a[44:47], a[228:231], a[200:203], a[44:47]
    s_waitcnt lgkmcnt(9)
    v_add_u32 v255, s83, v255
    v_mfma_f32_16x16x32_bf16 a[48:51], a[232:235], a[192:195], a[48:51]
    ds_read_b64_tr_b16 a[216:217], v3 offset:25120
    v_mfma_f32_16x16x32_bf16 a[52:55], a[232:235], a[196:199], a[52:55]
    ds_read_b64_tr_b16 a[218:219], v3 offset:26144
    v_mfma_f32_16x16x32_bf16 a[56:59], a[232:235], a[200:203], a[56:59]
    s_waitcnt lgkmcnt(8)
    buffer_load_dwordx4 v7, s[20:23], s45 offen offset:1024 nt lds
    s_add_u32 s45, s45, 262144
    s_cmp_ge_u32 s45, 4194304
    s_cselect_b32 s84, 4194048, 0
    s_sub_u32 s45, s45, s84
    v_mfma_f32_16x16x32_bf16 a[60:63], a[236:239], a[192:195], a[60:63]
    ds_read_b64_tr_b16 a[220:221], v3 offset:25128
    v_mfma_f32_16x16x32_bf16 a[64:67], a[236:239], a[196:199], a[64:67]
    ds_read_b64_tr_b16 a[222:223], v3 offset:26152
    v_mfma_f32_16x16x32_bf16 a[68:71], a[236:239], a[200:203], a[68:71]
    s_waitcnt lgkmcnt(7)
    v_mfma_f32_16x16x32_bf16 a[72:75], a[240:243], a[192:195], a[72:75]
    ds_read_b64_tr_b16 a[224:225], v3 offset:25376
    v_mfma_f32_16x16x32_bf16 a[76:79], a[240:243], a[196:199], a[76:79]
    ds_read_b64_tr_b16 a[226:227], v3 offset:26400
    v_mfma_f32_16x16x32_bf16 a[80:83], a[240:243], a[200:203], a[80:83]
    s_add_u32 m0, s47, s78
    s_waitcnt lgkmcnt(6)
    buffer_load_dwordx4 v6, s[20:23], s45 offen nt lds
    v_mfma_f32_16x16x32_bf16 a[84:87], a[244:247], a[192:195], a[84:87]
    ds_read_b64_tr_b16 a[228:229], v3 offset:25384
    s_xor_b32 s47, s47, 50240
    v_mfma_f32_16x16x32_bf16 a[88:91], a[244:247], a[196:199], a[88:91]
    ds_read_b64_tr_b16 a[230:231], v3 offset:26408
    v_mfma_f32_16x16x32_bf16 a[92:95], a[244:247], a[200:203], a[92:95]
    s_waitcnt lgkmcnt(6)
    v_mfma_f32_16x16x32_bf16 a[0:3], a[216:219], a[204:207], a[0:3]
    ds_read_b64_tr_b16 a[232:233], v3 offset:25632
    v_mfma_f32_16x16x32_bf16 a[4:7], a[216:219], a[208:211], a[4:7]
    ds_read_b64_tr_b16 a[234:235], v3 offset:26656
    v_mfma_f32_16x16x32_bf16 a[8:11], a[216:219], a[212:215], a[8:11]
    s_waitcnt lgkmcnt(6)
    buffer_load_dwordx4 v7, s[20:23], s45 offen offset:1024 nt lds
    s_add_u32 s45, s45, 262144
    s_cmp_ge_u32 s45, 4194304
    s_cselect_b32 s84, 4194048, 0
    s_sub_u32 s45, s45, s84
    v_mfma_f32_16x16x32_bf16 a[12:15], a[220:223], a[204:207], a[12:15]
    ds_read_b64_tr_b16 a[236:237], v3 offset:25640
    v_mfma_f32_16x16x32_bf16 a[16:19], a[220:223], a[208:211], a[16:19]
    ds_read_b64_tr_b16 a[238:239], v3 offset:26664
    v_mfma_f32_16x16x32_bf16 a[20:23], a[220:223], a[212:215], a[20:23]
    s_waitcnt lgkmcnt(6)
    v_mfma_f32_16x16x32_bf16 a[24:27], a[224:227], a[204:207], a[24:27]
    ds_read_b64_tr_b16 a[240:241], v3 offset:25888
    v_mfma_f32_16x16x32_bf16 a[28:31], a[224:227], a[208:211], a[28:31]
    ds_read_b64_tr_b16 a[242:243], v3 offset:26912
    v_mfma_f32_16x16x32_bf16 a[32:35], a[224:227], a[212:215], a[32:35]
    s_waitcnt lgkmcnt(6)
    v_mfma_f32_16x16x32_bf16 a[36:39], a[228:231], a[204:207], a[36:39]
    ds_read_b64_tr_b16 a[244:245], v3 offset:25896
    v_mfma_f32_16x16x32_bf16 a[40:43], a[228:231], a[208:211], a[40:43]
    ds_read_b64_tr_b16 a[246:247], v3 offset:26920
    v_mfma_f32_16x16x32_bf16 a[44:47], a[228:231], a[212:215], a[44:47]
    s_waitcnt lgkmcnt(6)
    v_add_u32 v3, s83, v3
    s_sub_u32 s83, 0, s83
    s_mov_b32 s90, 1
    v_mfma_f32_16x16x32_bf16 a[48:51], a[232:235], a[204:207], a[48:51]
    s_waitcnt vmcnt(4)
    s_barrier
    s_waitcnt lgkmcnt(0)
    v_mfma_f32_16x16x32_bf16 a[52:55], a[232:235], a[208:211], a[52:55]
    ds_read_b64_tr_b16 a[216:217], v255 offset:0
    s_mov_b32 m0, s80
    s_nop 0
    buffer_load_dwordx4 v8, s[8:11], s44 offen lds
    v_mfma_f32_16x16x32_bf16 a[56:59], a[232:235], a[212:215], a[56:59]
    ds_read_b64_tr_b16 a[218:219], v255 offset:1024
    v_mfma_f32_16x16x32_bf16 a[60:63], a[236:239], a[204:207], a[60:63]
    ds_read_b128 a[192:195], v4 offset:0
    v_mfma_f32_16x16x32_bf16 a[64:67], a[236:239], a[208:211], a[64:67]
    ds_read_b64_tr_b16 a[220:221], v255 offset:8
    buffer_load_dwordx4 v9, s[8:11], s44 offen offset:1024 lds
    v_mfma_f32_16x16x32_bf16 a[68:71], a[236:239], a[212:215], a[68:71]
    ds_read_b64_tr_b16 a[222:223], v255 offset:1032
    v_mfma_f32_16x16x32_bf16 a[72:75], a[240:243], a[204:207], a[72:75]
    ds_read_b128 a[196:199], v4 offset:2048
    v_mfma_f32_16x16x32_bf16 a[76:79], a[240:243], a[208:211], a[76:79]
    ds_read_b64_tr_b16 a[224:225], v255 offset:256
    buffer_load_dwordx4 v15, s[8:11], s44 offen offset:2048 lds
    v_mfma_f32_16x16x32_bf16 a[80:83], a[240:243], a[212:215], a[80:83]
    ds_read_b64_tr_b16 a[226:227], v255 offset:1280
    v_mfma_f32_16x16x32_bf16 a[84:87], a[244:247], a[204:207], a[84:87]
    ds_read_b128 a[200:203], v4 offset:4096
    v_mfma_f32_16x16x32_bf16 a[88:91], a[244:247], a[208:211], a[88:91]
    ds_read_b64_tr_b16 a[228:229], v255 offset:264
    s_add_u32 m0, s80, 3072
    s_nop 0
    buffer_load_dwordx4 v244, s[8:11], s44 offen lds
    v_mfma_f32_16x16x32_bf16 a[92:95], a[244:247], a[212:215], a[92:95]
    ds_read_b64_tr_b16 a[230:231], v255 offset:1288
    v_add_u32 v4, s99, v4
    s_waitcnt lgkmcnt(8)
    v_mfma_f32_16x16x32_bf16 a[0:3], a[216:219], a[192:195], a[0:3]
    ds_read_b64_tr_b16 a[232:233], v255 offset:512
    s_waitcnt lgkmcnt(6)
    v_mfma_f32_16x16x32_bf16 a[4:7], a[216:219], a[196:199], a[4:7]
    ds_read_b64_tr_b16 a[234:235], v255 offset:1536
    buffer_load_dwordx4 v245, s[8:11], s44 offen offset:1024 lds
    s_waitcnt lgkmcnt(4)
    v_mfma_f32_16x16x32_bf16 a[8:11], a[216:219], a[200:203], a[8:11]
    ds_read_b128 a[204:207], v10 offset:0
    v_mfma_f32_16x16x32_bf16 a[12:15], a[220:223], a[192:195], a[12:15]
    ds_read_b64_tr_b16 a[236:237], v255 offset:520
    v_mfma_f32_16x16x32_bf16 a[16:19], a[220:223], a[196:199], a[16:19]
    ds_read_b64_tr_b16 a[238:239], v255 offset:1544
    buffer_load_dwordx4 v246, s[8:11], s44 offen offset:2048 lds
    s_add_u32 s44, s44, 128
    s_and_b32 s44, s44, 1023
    s_xor_b32 s80, s80, s81
    v_mfma_f32_16x16x32_bf16 a[20:23], a[220:223], a[200:203], a[20:23]
    ds_read_b128 a[208:211], v10 offset:2048
    v_mfma_f32_16x16x32_bf16 a[24:27], a[224:227], a[192:195], a[24:27]
    ds_read_b64_tr_b16 a[240:241], v255 offset:768
    v_mfma_f32_16x16x32_bf16 a[28:31], a[224:227], a[196:199], a[28:31]
    ds_read_b64_tr_b16 a[242:243], v255 offset:1792
    v_mfma_f32_16x16x32_bf16 a[32:35], a[224:227], a[200:203], a[32:35]
    ds_read_b128 a[212:215], v10 offset:4096
    s_add_u32 m0, s46, s96
    s_nop 0
    buffer_load_dwordx4 v6, s[20:23], s45 offen nt lds
    s_waitcnt lgkmcnt(9)
    v_mfma_f32_16x16x32_bf16 a[36:39], a[228:231], a[192:195], a[36:39]
    ds_read_b64_tr_b16 a[244:245], v255 offset:776
    v_add_u32 v10, s99, v10
    v_mfma_f32_16x16x32_bf16 a[40:43], a[228:231], a[196:199], a[40:43]
    ds_read_b64_tr_b16 a[246:247], v255 offset:1800
    s_sub_u32 s99, 0, s99
    v_mfma_f32_16x16x32_bf16 a[44:47], a[228:231], a[200:203], a[44:47]
    s_waitcnt lgkmcnt(9)
    v_mfma_f32_16x16x32_bf16 a[48:51], a[232:235], a[192:195], a[48:51]
    ds_read_b64_tr_b16 a[216:217], v3 offset:0
    v_mfma_f32_16x16x32_bf16 a[52:55], a[232:235], a[196:199], a[52:55]
    ds_read_b64_tr_b16 a[218:219], v3 offset:1024
    v_mfma_f32_16x16x32_bf16 a[56:59], a[232:235], a[200:203], a[56:59]
    s_waitcnt lgkmcnt(8)
    buffer_load_dwordx4 v7, s[20:23], s45 offen offset:1024 nt lds
    s_add_u32 s45, s45, 262144
    s_cmp_ge_u32 s45, 4194304
    s_cselect_b32 s84, 4194048, 0
    s_sub_u32 s45, s45, s84
    v_mfma_f32_16x16x32_bf16 a[60:63], a[236:239], a[192:195], a[60:63]
    ds_read_b64_tr_b16 a[220:221], v3 offset:8
    v_mfma_f32_16x16x32_bf16 a[64:67], a[236:239], a[196:199], a[64:67]
    ds_read_b64_tr_b16 a[222:223], v3 offset:1032
    v_mfma_f32_16x16x32_bf16 a[68:71], a[236:239], a[200:203], a[68:71]
    s_waitcnt lgkmcnt(7)
    v_mfma_f32_16x16x32_bf16 a[72:75], a[240:243], a[192:195], a[72:75]
    ds_read_b64_tr_b16 a[224:225], v3 offset:256
    v_mfma_f32_16x16x32_bf16 a[76:79], a[240:243], a[196:199], a[76:79]
    ds_read_b64_tr_b16 a[226:227], v3 offset:1280
    v_mfma_f32_16x16x32_bf16 a[80:83], a[240:243], a[200:203], a[80:83]
    s_add_u32 m0, s46, s78
    s_waitcnt lgkmcnt(6)
    buffer_load_dwordx4 v6, s[20:23], s45 offen nt lds
    v_mfma_f32_16x16x32_bf16 a[84:87], a[244:247], a[192:195], a[84:87]
    ds_read_b64_tr_b16 a[228:229], v3 offset:264
    s_xor_b32 s46, s46, 83008
    v_mfma_f32_16x16x32_bf16 a[88:91], a[244:247], a[196:199], a[88:91]
    ds_read_b64_tr_b16 a[230:231], v3 offset:1288
    v_mfma_f32_16x16x32_bf16 a[92:95], a[244:247], a[200:203], a[92:95]
    s_waitcnt lgkmcnt(6)
    v_mfma_f32_16x16x32_bf16 a[0:3], a[216:219], a[204:207], a[0:3]
    ds_read_b64_tr_b16 a[232:233], v3 offset:512
    v_mfma_f32_16x16x32_bf16 a[4:7], a[216:219], a[208:211], a[4:7]
    ds_read_b64_tr_b16 a[234:235], v3 offset:1536
    v_mfma_f32_16x16x32_bf16 a[8:11], a[216:219], a[212:215], a[8:11]
    s_waitcnt lgkmcnt(6)
    buffer_load_dwordx4 v7, s[20:23], s45 offen offset:1024 nt lds
    s_add_u32 s45, s45, 262144
    s_cmp_ge_u32 s45, 4194304
    s_cselect_b32 s84, 4194048, 0
    s_sub_u32 s45, s45, s84
    v_mfma_f32_16x16x32_bf16 a[12:15], a[220:223], a[204:207], a[12:15]
    ds_read_b64_tr_b16 a[236:237], v3 offset:520
    v_mfma_f32_16x16x32_bf16 a[16:19], a[220:223], a[208:211], a[16:19]
    ds_read_b64_tr_b16 a[238:239], v3 offset:1544
    v_mfma_f32_16x16x32_bf16 a[20:23], a[220:223], a[212:215], a[20:23]
    s_waitcnt lgkmcnt(6)
    v_mfma_f32_16x16x32_bf16 a[24:27], a[224:227], a[204:207], a[24:27]
    ds_read_b64_tr_b16 a[240:241], v3 offset:768
    v_mfma_f32_16x16x32_bf16 a[28:31], a[224:227], a[208:211], a[28:31]
    ds_read_b64_tr_b16 a[242:243], v3 offset:1792
    v_mfma_f32_16x16x32_bf16 a[32:35], a[224:227], a[212:215], a[32:35]
    s_waitcnt lgkmcnt(6)
    v_mfma_f32_16x16x32_bf16 a[36:39], a[228:231], a[204:207], a[36:39]
    ds_read_b64_tr_b16 a[244:245], v3 offset:776
    v_mfma_f32_16x16x32_bf16 a[40:43], a[228:231], a[208:211], a[40:43]
    ds_read_b64_tr_b16 a[246:247], v3 offset:1800
    v_mfma_f32_16x16x32_bf16 a[44:47], a[228:231], a[212:215], a[44:47]
    s_waitcnt lgkmcnt(6)
    v_mfma_f32_16x16x32_bf16 a[48:51], a[232:235], a[204:207], a[48:51]
    s_waitcnt vmcnt(4)
    s_barrier
    s_waitcnt lgkmcnt(0)
    v_mfma_f32_16x16x32_bf16 a[52:55], a[232:235], a[208:211], a[52:55]
    ds_read_b64_tr_b16 a[216:217], v255 offset:25120
    s_mov_b32 m0, s80
    s_nop 0
    buffer_load_dwordx4 v8, s[8:11], s44 offen lds
    v_mfma_f32_16x16x32_bf16 a[56:59], a[232:235], a[212:215], a[56:59]
    ds_read_b64_tr_b16 a[218:219], v255 offset:26144
    v_mfma_f32_16x16x32_bf16 a[60:63], a[236:239], a[204:207], a[60:63]
    ds_read_b128 a[192:195], v4 offset:0
    v_mfma_f32_16x16x32_bf16 a[64:67], a[236:239], a[208:211], a[64:67]
    ds_read_b64_tr_b16 a[220:221], v255 offset:25128
    buffer_load_dwordx4 v9, s[8:11], s44 offen offset:1024 lds
    v_mfma_f32_16x16x32_bf16 a[68:71], a[236:239], a[212:215], a[68:71]
    ds_read_b64_tr_b16 a[222:223], v255 offset:26152
    v_mfma_f32_16x16x32_bf16 a[72:75], a[240:243], a[204:207], a[72:75]
    ds_read_b128 a[196:199], v4 offset:2048
    v_mfma_f32_16x16x32_bf16 a[76:79], a[240:243], a[208:211], a[76:79]
    ds_read_b64_tr_b16 a[224:225], v255 offset:25376
    buffer_load_dwordx4 v15, s[8:11], s44 offen offset:2048 lds
    v_mfma_f32_16x16x32_bf16 a[80:83], a[240:243], a[212:215], a[80:83]
    ds_read_b64_tr_b16 a[226:227], v255 offset:26400
    v_mfma_f32_16x16x32_bf16 a[84:87], a[244:247], a[204:207], a[84:87]
    ds_read_b128 a[200:203], v4 offset:4096
    v_mfma_f32_16x16x32_bf16 a[88:91], a[244:247], a[208:211], a[88:91]
    ds_read_b64_tr_b16 a[228:229], v255 offset:25384
    s_add_u32 m0, s80, 3072
    s_nop 0
    buffer_load_dwordx4 v244, s[8:11], s44 offen lds
    v_mfma_f32_16x16x32_bf16 a[92:95], a[244:247], a[212:215], a[92:95]
    ds_read_b64_tr_b16 a[230:231], v255 offset:26408
    v_add_u32 v4, s99, v4
    s_waitcnt lgkmcnt(8)
    v_mfma_f32_16x16x32_bf16 a[0:3], a[216:219], a[192:195], a[0:3]
    ds_read_b64_tr_b16 a[232:233], v255 offset:25632
    s_waitcnt lgkmcnt(6)
    v_mfma_f32_16x16x32_bf16 a[4:7], a[216:219], a[196:199], a[4:7]
    ds_read_b64_tr_b16 a[234:235], v255 offset:26656
    buffer_load_dwordx4 v245, s[8:11], s44 offen offset:1024 lds
    s_waitcnt lgkmcnt(4)
    v_mfma_f32_16x16x32_bf16 a[8:11], a[216:219], a[200:203], a[8:11]
    ds_read_b128 a[204:207], v10 offset:0
    v_mfma_f32_16x16x32_bf16 a[12:15], a[220:223], a[192:195], a[12:15]
    ds_read_b64_tr_b16 a[236:237], v255 offset:25640
    v_mfma_f32_16x16x32_bf16 a[16:19], a[220:223], a[196:199], a[16:19]
    ds_read_b64_tr_b16 a[238:239], v255 offset:26664
    buffer_load_dwordx4 v246, s[8:11], s44 offen offset:2048 lds
    s_add_u32 s44, s44, 128
    s_and_b32 s44, s44, 1023
    s_xor_b32 s80, s80, s81
    v_mfma_f32_16x16x32_bf16 a[20:23], a[220:223], a[200:203], a[20:23]
    ds_read_b128 a[208:211], v10 offset:2048
    v_mfma_f32_16x16x32_bf16 a[24:27], a[224:227], a[192:195], a[24:27]
    ds_read_b64_tr_b16 a[240:241], v255 offset:25888
    v_mfma_f32_16x16x32_bf16 a[28:31], a[224:227], a[196:199], a[28:31]
    ds_read_b64_tr_b16 a[242:243], v255 offset:26912
    v_mfma_f32_16x16x32_bf16 a[32:35], a[224:227], a[200:203], a[32:35]
    ds_read_b128 a[212:215], v10 offset:4096
    s_add_u32 m0, s47, s96
    s_nop 0
    buffer_load_dwordx4 v6, s[20:23], s45 offen nt lds
    s_waitcnt lgkmcnt(9)
    v_mfma_f32_16x16x32_bf16 a[36:39], a[228:231], a[192:195], a[36:39]
    ds_read_b64_tr_b16 a[244:245], v255 offset:25896
    v_add_u32 v10, s99, v10
    v_mfma_f32_16x16x32_bf16 a[40:43], a[228:231], a[196:199], a[40:43]
    ds_read_b64_tr_b16 a[246:247], v255 offset:26920
    s_sub_u32 s99, 0, s99
    v_mfma_f32_16x16x32_bf16 a[44:47], a[228:231], a[200:203], a[44:47]
    s_waitcnt lgkmcnt(9)
    v_add_u32 v255, s83, v255
    v_mfma_f32_16x16x32_bf16 a[48:51], a[232:235], a[192:195], a[48:51]
    ds_read_b64_tr_b16 a[216:217], v3 offset:25120
    v_mfma_f32_16x16x32_bf16 a[52:55], a[232:235], a[196:199], a[52:55]
    ds_read_b64_tr_b16 a[218:219], v3 offset:26144
    v_mfma_f32_16x16x32_bf16 a[56:59], a[232:235], a[200:203], a[56:59]
    s_waitcnt lgkmcnt(8)
    buffer_load_dwordx4 v7, s[20:23], s45 offen offset:1024 nt lds
    s_add_u32 s45, s45, 262144
    s_cmp_ge_u32 s45, 4194304
    s_cselect_b32 s84, 4194048, 0
    s_sub_u32 s45, s45, s84
    v_mfma_f32_16x16x32_bf16 a[60:63], a[236:239], a[192:195], a[60:63]
    ds_read_b64_tr_b16 a[220:221], v3 offset:25128
    v_mfma_f32_16x16x32_bf16 a[64:67], a[236:239], a[196:199], a[64:67]
    ds_read_b64_tr_b16 a[222:223], v3 offset:26152
    v_mfma_f32_16x16x32_bf16 a[68:71], a[236:239], a[200:203], a[68:71]
    s_waitcnt lgkmcnt(7)
    v_mfma_f32_16x16x32_bf16 a[72:75], a[240:243], a[192:195], a[72:75]
    ds_read_b64_tr_b16 a[224:225], v3 offset:25376
    v_mfma_f32_16x16x32_bf16 a[76:79], a[240:243], a[196:199], a[76:79]
    ds_read_b64_tr_b16 a[226:227], v3 offset:26400
    v_mfma_f32_16x16x32_bf16 a[80:83], a[240:243], a[200:203], a[80:83]
    s_add_u32 m0, s47, s78
    s_waitcnt lgkmcnt(6)
    buffer_load_dwordx4 v6, s[20:23], s45 offen nt lds
    v_mfma_f32_16x16x32_bf16 a[84:87], a[244:247], a[192:195], a[84:87]
    ds_read_b64_tr_b16 a[228:229], v3 offset:25384
    s_xor_b32 s47, s47, 50240
    v_mfma_f32_16x16x32_bf16 a[88:91], a[244:247], a[196:199], a[88:91]
    ds_read_b64_tr_b16 a[230:231], v3 offset:26408
    v_mfma_f32_16x16x32_bf16 a[92:95], a[244:247], a[200:203], a[92:95]
    s_waitcnt lgkmcnt(6)
    v_mfma_f32_16x16x32_bf16 a[0:3], a[216:219], a[204:207], a[0:3]
    ds_read_b64_tr_b16 a[232:233], v3 offset:25632
    v_mfma_f32_16x16x32_bf16 a[4:7], a[216:219], a[208:211], a[4:7]
    ds_read_b64_tr_b16 a[234:235], v3 offset:26656
    v_mfma_f32_16x16x32_bf16 a[8:11], a[216:219], a[212:215], a[8:11]
    s_waitcnt lgkmcnt(6)
    buffer_load_dwordx4 v7, s[20:23], s45 offen offset:1024 nt lds
    s_add_u32 s45, s45, 262144
    s_cmp_ge_u32 s45, 4194304
    s_cselect_b32 s84, 4194048, 0
    s_sub_u32 s45, s45, s84
    v_mfma_f32_16x16x32_bf16 a[12:15], a[220:223], a[204:207], a[12:15]
    ds_read_b64_tr_b16 a[236:237], v3 offset:25640
    v_mfma_f32_16x16x32_bf16 a[16:19], a[220:223], a[208:211], a[16:19]
    ds_read_b64_tr_b16 a[238:239], v3 offset:26664
    v_mfma_f32_16x16x32_bf16 a[20:23], a[220:223], a[212:215], a[20:23]
    s_waitcnt lgkmcnt(6)
    v_mfma_f32_16x16x32_bf16 a[24:27], a[224:227], a[204:207], a[24:27]
    ds_read_b64_tr_b16 a[240:241], v3 offset:25888
    v_mfma_f32_16x16x32_bf16 a[28:31], a[224:227], a[208:211], a[28:31]
    ds_read_b64_tr_b16 a[242:243], v3 offset:26912
    v_mfma_f32_16x16x32_bf16 a[32:35], a[224:227], a[212:215], a[32:35]
    s_waitcnt lgkmcnt(6)
    v_mfma_f32_16x16x32_bf16 a[36:39], a[228:231], a[204:207], a[36:39]
    ds_read_b64_tr_b16 a[244:245], v3 offset:25896
    v_mfma_f32_16x16x32_bf16 a[40:43], a[228:231], a[208:211], a[40:43]
    ds_read_b64_tr_b16 a[246:247], v3 offset:26920
    v_mfma_f32_16x16x32_bf16 a[44:47], a[228:231], a[212:215], a[44:47]
    s_waitcnt lgkmcnt(6)
    v_add_u32 v3, s83, v3
    s_sub_u32 s83, 0, s83
    v_mfma_f32_16x16x32_bf16 a[48:51], a[232:235], a[204:207], a[48:51]
    s_waitcnt vmcnt(4)
    s_barrier
    s_waitcnt lgkmcnt(0)
    v_mfma_f32_16x16x32_bf16 a[52:55], a[232:235], a[208:211], a[52:55]
    ds_read_b64_tr_b16 a[216:217], v255 offset:0
    s_mov_b32 m0, s80
    s_nop 0
    buffer_load_dwordx4 v8, s[8:11], s44 offen lds
    v_mfma_f32_16x16x32_bf16 a[56:59], a[232:235], a[212:215], a[56:59]
    ds_read_b64_tr_b16 a[218:219], v255 offset:1024
    v_mfma_f32_16x16x32_bf16 a[60:63], a[236:239], a[204:207], a[60:63]
    ds_read_b128 a[192:195], v4 offset:0
    v_mfma_f32_16x16x32_bf16 a[64:67], a[236:239], a[208:211], a[64:67]
    ds_read_b64_tr_b16 a[220:221], v255 offset:8
    buffer_load_dwordx4 v9, s[8:11], s44 offen offset:1024 lds
    v_mfma_f32_16x16x32_bf16 a[68:71], a[236:239], a[212:215], a[68:71]
    ds_read_b64_tr_b16 a[222:223], v255 offset:1032
    v_mfma_f32_16x16x32_bf16 a[72:75], a[240:243], a[204:207], a[72:75]
    ds_read_b128 a[196:199], v4 offset:2048
    v_mfma_f32_16x16x32_bf16 a[76:79], a[240:243], a[208:211], a[76:79]
    ds_read_b64_tr_b16 a[224:225], v255 offset:256
    buffer_load_dwordx4 v15, s[8:11], s44 offen offset:2048 lds
    v_mfma_f32_16x16x32_bf16 a[80:83], a[240:243], a[212:215], a[80:83]
    ds_read_b64_tr_b16 a[226:227], v255 offset:1280
    v_mfma_f32_16x16x32_bf16 a[84:87], a[244:247], a[204:207], a[84:87]
    ds_read_b128 a[200:203], v4 offset:4096
    v_mfma_f32_16x16x32_bf16 a[88:91], a[244:247], a[208:211], a[88:91]
    ds_read_b64_tr_b16 a[228:229], v255 offset:264
    s_add_u32 m0, s80, 3072
    s_nop 0
    buffer_load_dwordx4 v244, s[8:11], s44 offen lds
    v_mfma_f32_16x16x32_bf16 a[92:95], a[244:247], a[212:215], a[92:95]
    ds_read_b64_tr_b16 a[230:231], v255 offset:1288
    v_add_u32 v4, s99, v4
    s_waitcnt lgkmcnt(8)
    v_mfma_f32_16x16x32_bf16 a[0:3], a[216:219], a[192:195], a[0:3]
    ds_read_b64_tr_b16 a[232:233], v255 offset:512
    s_waitcnt lgkmcnt(6)
    v_mfma_f32_16x16x32_bf16 a[4:7], a[216:219], a[196:199], a[4:7]
    ds_read_b64_tr_b16 a[234:235], v255 offset:1536
    buffer_load_dwordx4 v245, s[8:11], s44 offen offset:1024 lds
    s_waitcnt lgkmcnt(4)
    v_mfma_f32_16x16x32_bf16 a[8:11], a[216:219], a[200:203], a[8:11]
    ds_read_b128 a[204:207], v10 offset:0
    v_mfma_f32_16x16x32_bf16 a[12:15], a[220:223], a[192:195], a[12:15]
    ds_read_b64_tr_b16 a[236:237], v255 offset:520
    v_mfma_f32_16x16x32_bf16 a[16:19], a[220:223], a[196:199], a[16:19]
    ds_read_b64_tr_b16 a[238:239], v255 offset:1544
    buffer_load_dwordx4 v246, s[8:11], s44 offen offset:2048 lds
    s_add_u32 s44, s44, 128
    s_and_b32 s44, s44, 1023
    s_xor_b32 s80, s80, s81
    v_mfma_f32_16x16x32_bf16 a[20:23], a[220:223], a[200:203], a[20:23]
    ds_read_b128 a[208:211], v10 offset:2048
    v_mfma_f32_16x16x32_bf16 a[24:27], a[224:227], a[192:195], a[24:27]
    ds_read_b64_tr_b16 a[240:241], v255 offset:768
    v_mfma_f32_16x16x32_bf16 a[28:31], a[224:227], a[196:199], a[28:31]
    ds_read_b64_tr_b16 a[242:243], v255 offset:1792
    v_mfma_f32_16x16x32_bf16 a[32:35], a[224:227], a[200:203], a[32:35]
    ds_read_b128 a[212:215], v10 offset:4096
    s_add_u32 m0, s46, s96
    s_nop 0
    buffer_load_dwordx4 v6, s[20:23], s45 offen nt lds
    s_waitcnt lgkmcnt(9)
    v_mfma_f32_16x16x32_bf16 a[36:39], a[228:231], a[192:195], a[36:39]
    ds_read_b64_tr_b16 a[244:245], v255 offset:776
    v_add_u32 v10, s99, v10
    v_mfma_f32_16x16x32_bf16 a[40:43], a[228:231], a[196:199], a[40:43]
    ds_read_b64_tr_b16 a[246:247], v255 offset:1800
    s_sub_u32 s99, 0, s99
    v_mfma_f32_16x16x32_bf16 a[44:47], a[228:231], a[200:203], a[44:47]
    s_waitcnt lgkmcnt(9)
    v_mfma_f32_16x16x32_bf16 a[48:51], a[232:235], a[192:195], a[48:51]
    ds_read_b64_tr_b16 a[216:217], v3 offset:0
    v_mfma_f32_16x16x32_bf16 a[52:55], a[232:235], a[196:199], a[52:55]
    ds_read_b64_tr_b16 a[218:219], v3 offset:1024
    v_mfma_f32_16x16x32_bf16 a[56:59], a[232:235], a[200:203], a[56:59]
    s_waitcnt lgkmcnt(8)
    buffer_load_dwordx4 v7, s[20:23], s45 offen offset:1024 nt lds
    s_add_u32 s45, s45, 262144
    s_cmp_ge_u32 s45, 4194304
    s_cselect_b32 s84, 4194048, 0
    s_sub_u32 s45, s45, s84
    v_mfma_f32_16x16x32_bf16 a[60:63], a[236:239], a[192:195], a[60:63]
    ds_read_b64_tr_b16 a[220:221], v3 offset:8
    v_mfma_f32_16x16x32_bf16 a[64:67], a[236:239], a[196:199], a[64:67]
    ds_read_b64_tr_b16 a[222:223], v3 offset:1032
    v_mfma_f32_16x16x32_bf16 a[68:71], a[236:239], a[200:203], a[68:71]
    s_waitcnt lgkmcnt(7)
    v_mfma_f32_16x16x32_bf16 a[72:75], a[240:243], a[192:195], a[72:75]
    ds_read_b64_tr_b16 a[224:225], v3 offset:256
    v_mfma_f32_16x16x32_bf16 a[76:79], a[240:243], a[196:199], a[76:79]
    ds_read_b64_tr_b16 a[226:227], v3 offset:1280
    v_mfma_f32_16x16x32_bf16 a[80:83], a[240:243], a[200:203], a[80:83]
    s_add_u32 m0, s46, s78
    s_waitcnt lgkmcnt(6)
    buffer_load_dwordx4 v6, s[20:23], s45 offen nt lds
    v_mfma_f32_16x16x32_bf16 a[84:87], a[244:247], a[192:195], a[84:87]
    ds_read_b64_tr_b16 a[228:229], v3 offset:264
    s_xor_b32 s46, s46, 83008
    v_mfma_f32_16x16x32_bf16 a[88:91], a[244:247], a[196:199], a[88:91]
    ds_read_b64_tr_b16 a[230:231], v3 offset:1288
    v_mfma_f32_16x16x32_bf16 a[92:95], a[244:247], a[200:203], a[92:95]
    s_waitcnt lgkmcnt(6)
    v_mfma_f32_16x16x32_bf16 a[0:3], a[216:219], a[204:207], a[0:3]
    ds_read_b64_tr_b16 a[232:233], v3 offset:512
    v_mfma_f32_16x16x32_bf16 a[4:7], a[216:219], a[208:211], a[4:7]
    ds_read_b64_tr_b16 a[234:235], v3 offset:1536
    v_mfma_f32_16x16x32_bf16 a[8:11], a[216:219], a[212:215], a[8:11]
    s_waitcnt lgkmcnt(6)
    buffer_load_dwordx4 v7, s[20:23], s45 offen offset:1024 nt lds
    s_add_u32 s45, s45, 262144
    s_cmp_ge_u32 s45, 4194304
    s_cselect_b32 s84, 4194048, 0
    s_sub_u32 s45, s45, s84
    v_mfma_f32_16x16x32_bf16 a[12:15], a[220:223], a[204:207], a[12:15]
    ds_read_b64_tr_b16 a[236:237], v3 offset:520
    v_mfma_f32_16x16x32_bf16 a[16:19], a[220:223], a[208:211], a[16:19]
    ds_read_b64_tr_b16 a[238:239], v3 offset:1544
    v_mfma_f32_16x16x32_bf16 a[20:23], a[220:223], a[212:215], a[20:23]
    s_waitcnt lgkmcnt(6)
    v_mfma_f32_16x16x32_bf16 a[24:27], a[224:227], a[204:207], a[24:27]
    ds_read_b64_tr_b16 a[240:241], v3 offset:768
    v_mfma_f32_16x16x32_bf16 a[28:31], a[224:227], a[208:211], a[28:31]
    ds_read_b64_tr_b16 a[242:243], v3 offset:1792
    v_mfma_f32_16x16x32_bf16 a[32:35], a[224:227], a[212:215], a[32:35]
    s_waitcnt lgkmcnt(6)
    v_mfma_f32_16x16x32_bf16 a[36:39], a[228:231], a[204:207], a[36:39]
    ds_read_b64_tr_b16 a[244:245], v3 offset:776
    v_mfma_f32_16x16x32_bf16 a[40:43], a[228:231], a[208:211], a[40:43]
    ds_read_b64_tr_b16 a[246:247], v3 offset:1800
    v_mfma_f32_16x16x32_bf16 a[44:47], a[228:231], a[212:215], a[44:47]
    s_waitcnt lgkmcnt(6)
    v_mfma_f32_16x16x32_bf16 a[48:51], a[232:235], a[204:207], a[48:51]
    s_waitcnt vmcnt(4)
    s_barrier
    s_waitcnt lgkmcnt(0)
    v_mfma_f32_16x16x32_bf16 a[52:55], a[232:235], a[208:211], a[52:55]
    ds_read_b64_tr_b16 a[216:217], v255 offset:25120
    s_mov_b32 m0, s80
    s_nop 0
    buffer_load_dwordx4 v8, s[8:11], s44 offen lds
    v_mfma_f32_16x16x32_bf16 a[56:59], a[232:235], a[212:215], a[56:59]
    ds_read_b64_tr_b16 a[218:219], v255 offset:26144
    v_mfma_f32_16x16x32_bf16 a[60:63], a[236:239], a[204:207], a[60:63]
    ds_read_b128 a[192:195], v4 offset:0
    v_mfma_f32_16x16x32_bf16 a[64:67], a[236:239], a[208:211], a[64:67]
    ds_read_b64_tr_b16 a[220:221], v255 offset:25128
    buffer_load_dwordx4 v9, s[8:11], s44 offen offset:1024 lds
    v_mfma_f32_16x16x32_bf16 a[68:71], a[236:239], a[212:215], a[68:71]
    ds_read_b64_tr_b16 a[222:223], v255 offset:26152
    v_mfma_f32_16x16x32_bf16 a[72:75], a[240:243], a[204:207], a[72:75]
    ds_read_b128 a[196:199], v4 offset:2048
    v_mfma_f32_16x16x32_bf16 a[76:79], a[240:243], a[208:211], a[76:79]
    ds_read_b64_tr_b16 a[224:225], v255 offset:25376
    buffer_load_dwordx4 v15, s[8:11], s44 offen offset:2048 lds
    v_mfma_f32_16x16x32_bf16 a[80:83], a[240:243], a[212:215], a[80:83]
    ds_read_b64_tr_b16 a[226:227], v255 offset:26400
    v_mfma_f32_16x16x32_bf16 a[84:87], a[244:247], a[204:207], a[84:87]
    ds_read_b128 a[200:203], v4 offset:4096
    v_mfma_f32_16x16x32_bf16 a[88:91], a[244:247], a[208:211], a[88:91]
    ds_read_b64_tr_b16 a[228:229], v255 offset:25384
    s_add_u32 m0, s80, 3072
    s_nop 0
    buffer_load_dwordx4 v244, s[8:11], s44 offen lds
    v_mfma_f32_16x16x32_bf16 a[92:95], a[244:247], a[212:215], a[92:95]
    ds_read_b64_tr_b16 a[230:231], v255 offset:26408
    v_add_u32 v4, s99, v4
    s_waitcnt lgkmcnt(8)
    v_mfma_f32_16x16x32_bf16 a[0:3], a[216:219], a[192:195], a[0:3]
    ds_read_b64_tr_b16 a[232:233], v255 offset:25632
    s_waitcnt lgkmcnt(6)
    v_mfma_f32_16x16x32_bf16 a[4:7], a[216:219], a[196:199], a[4:7]
    ds_read_b64_tr_b16 a[234:235], v255 offset:26656
    buffer_load_dwordx4 v245, s[8:11], s44 offen offset:1024 lds
    s_waitcnt lgkmcnt(4)
    v_mfma_f32_16x16x32_bf16 a[8:11], a[216:219], a[200:203], a[8:11]
    ds_read_b128 a[204:207], v10 offset:0
    v_mfma_f32_16x16x32_bf16 a[12:15], a[220:223], a[192:195], a[12:15]
    ds_read_b64_tr_b16 a[236:237], v255 offset:25640
    v_mfma_f32_16x16x32_bf16 a[16:19], a[220:223], a[196:199], a[16:19]
    ds_read_b64_tr_b16 a[238:239], v255 offset:26664
    buffer_load_dwordx4 v246, s[8:11], s44 offen offset:2048 lds
    s_add_u32 s44, s44, 128
    s_and_b32 s44, s44, 1023
    s_xor_b32 s80, s80, s81
    v_mfma_f32_16x16x32_bf16 a[20:23], a[220:223], a[200:203], a[20:23]
    ds_read_b128 a[208:211], v10 offset:2048
    v_mfma_f32_16x16x32_bf16 a[24:27], a[224:227], a[192:195], a[24:27]
    ds_read_b64_tr_b16 a[240:241], v255 offset:25888
    v_mfma_f32_16x16x32_bf16 a[28:31], a[224:227], a[196:199], a[28:31]
    ds_read_b64_tr_b16 a[242:243], v255 offset:26912
    v_mfma_f32_16x16x32_bf16 a[32:35], a[224:227], a[200:203], a[32:35]
    ds_read_b128 a[212:215], v10 offset:4096
    s_add_u32 m0, s47, s74
    s_nop 0
    buffer_load_dwordx4 v5, s[12:15], s43 offen nt lds
    s_waitcnt lgkmcnt(9)
    v_mfma_f32_16x16x32_bf16 a[36:39], a[228:231], a[192:195], a[36:39]
    ds_read_b64_tr_b16 a[244:245], v255 offset:25896
    v_add_u32 v10, s99, v10
    v_mfma_f32_16x16x32_bf16 a[40:43], a[228:231], a[196:199], a[40:43]
    ds_read_b64_tr_b16 a[246:247], v255 offset:26920
    s_sub_u32 s99, 0, s99
    v_mfma_f32_16x16x32_bf16 a[44:47], a[228:231], a[200:203], a[44:47]
    s_waitcnt lgkmcnt(9)
    v_add_u32 v255, s83, v255
    v_mfma_f32_16x16x32_bf16 a[48:51], a[232:235], a[192:195], a[48:51]
    ds_read_b64_tr_b16 a[216:217], v3 offset:25120
    v_mfma_f32_16x16x32_bf16 a[52:55], a[232:235], a[196:199], a[52:55]
    ds_read_b64_tr_b16 a[218:219], v3 offset:26144
    v_mfma_f32_16x16x32_bf16 a[56:59], a[232:235], a[200:203], a[56:59]
    s_waitcnt lgkmcnt(8)
    buffer_load_dwordx4 v247, s[12:15], s43 offen offset:1056 nt lds
    v_mfma_f32_16x16x32_bf16 a[60:63], a[236:239], a[192:195], a[60:63]
    ds_read_b64_tr_b16 a[220:221], v3 offset:25128
    s_add_u32 s43, s43, 8192
    v_mfma_f32_16x16x32_bf16 a[64:67], a[236:239], a[196:199], a[64:67]
    ds_read_b64_tr_b16 a[222:223], v3 offset:26152
    v_mfma_f32_16x16x32_bf16 a[68:71], a[236:239], a[200:203], a[68:71]
    s_waitcnt lgkmcnt(7)
    v_mfma_f32_16x16x32_bf16 a[72:75], a[240:243], a[192:195], a[72:75]
    ds_read_b64_tr_b16 a[224:225], v3 offset:25376
    v_mfma_f32_16x16x32_bf16 a[76:79], a[240:243], a[196:199], a[76:79]
    ds_read_b64_tr_b16 a[226:227], v3 offset:26400
    v_mfma_f32_16x16x32_bf16 a[80:83], a[240:243], a[200:203], a[80:83]
    s_add_u32 m0, s47, s78
    s_waitcnt lgkmcnt(6)
    buffer_load_dwordx4 v6, s[20:23], s45 offen nt lds
    v_mfma_f32_16x16x32_bf16 a[84:87], a[244:247], a[192:195], a[84:87]
    ds_read_b64_tr_b16 a[228:229], v3 offset:25384
    s_xor_b32 s47, s47, 50240
    v_mfma_f32_16x16x32_bf16 a[88:91], a[244:247], a[196:199], a[88:91]
    ds_read_b64_tr_b16 a[230:231], v3 offset:26408
    v_mfma_f32_16x16x32_bf16 a[92:95], a[244:247], a[200:203], a[92:95]
    s_waitcnt lgkmcnt(6)
    v_mfma_f32_16x16x32_bf16 a[0:3], a[216:219], a[204:207], a[0:3]
    ds_read_b64_tr_b16 a[232:233], v3 offset:25632
    v_mfma_f32_16x16x32_bf16 a[4:7], a[216:219], a[208:211], a[4:7]
    ds_read_b64_tr_b16 a[234:235], v3 offset:26656
    v_mfma_f32_16x16x32_bf16 a[8:11], a[216:219], a[212:215], a[8:11]
    s_waitcnt lgkmcnt(6)
    buffer_load_dwordx4 v7, s[20:23], s45 offen offset:1024 nt lds
    v_mfma_f32_16x16x32_bf16 a[12:15], a[220:223], a[204:207], a[12:15]
    ds_read_b64_tr_b16 a[236:237], v3 offset:25640
    s_add_u32 s45, s45, 262144
    v_mfma_f32_16x16x32_bf16 a[16:19], a[220:223], a[208:211], a[16:19]
    ds_read_b64_tr_b16 a[238:239], v3 offset:26664
    s_cmp_ge_u32 s45, 4194304
    s_cselect_b32 s84, 4194048, 0
    v_mfma_f32_16x16x32_bf16 a[20:23], a[220:223], a[212:215], a[20:23]
    s_waitcnt lgkmcnt(6)
    s_sub_u32 s45, s45, s84
    v_mfma_f32_16x16x32_bf16 a[24:27], a[224:227], a[204:207], a[24:27]
    ds_read_b64_tr_b16 a[240:241], v3 offset:25888
    v_mfma_f32_16x16x32_bf16 a[28:31], a[224:227], a[208:211], a[28:31]
    ds_read_b64_tr_b16 a[242:243], v3 offset:26912
    v_mfma_f32_16x16x32_bf16 a[32:35], a[224:227], a[212:215], a[32:35]
    s_waitcnt lgkmcnt(6)
    v_mfma_f32_16x16x32_bf16 a[36:39], a[228:231], a[204:207], a[36:39]
    ds_read_b64_tr_b16 a[244:245], v3 offset:25896
    v_mfma_f32_16x16x32_bf16 a[40:43], a[228:231], a[208:211], a[40:43]
    ds_read_b64_tr_b16 a[246:247], v3 offset:26920
    v_mfma_f32_16x16x32_bf16 a[44:47], a[228:231], a[212:215], a[44:47]
    s_waitcnt lgkmcnt(6)
    v_add_u32 v3, s83, v3
    s_sub_u32 s83, 0, s83
    v_mfma_f32_16x16x32_bf16 a[48:51], a[232:235], a[204:207], a[48:51]
    s_waitcnt vmcnt(4)
    s_barrier
    s_waitcnt lgkmcnt(0)
    v_mfma_f32_16x16x32_bf16 a[52:55], a[232:235], a[208:211], a[52:55]
    ds_read_b64_tr_b16 a[216:217], v255 offset:0
    s_mov_b32 m0, s80
    s_nop 0
    buffer_load_dwordx4 v8, s[8:11], s44 offen lds
    v_mfma_f32_16x16x32_bf16 a[56:59], a[232:235], a[212:215], a[56:59]
    ds_read_b64_tr_b16 a[218:219], v255 offset:1024
    v_mfma_f32_16x16x32_bf16 a[60:63], a[236:239], a[204:207], a[60:63]
    ds_read_b128 a[192:195], v4 offset:0
    v_mfma_f32_16x16x32_bf16 a[64:67], a[236:239], a[208:211], a[64:67]
    ds_read_b64_tr_b16 a[220:221], v255 offset:8
    buffer_load_dwordx4 v9, s[8:11], s44 offen offset:1024 lds
    v_mfma_f32_16x16x32_bf16 a[68:71], a[236:239], a[212:215], a[68:71]
    ds_read_b64_tr_b16 a[222:223], v255 offset:1032
    v_mfma_f32_16x16x32_bf16 a[72:75], a[240:243], a[204:207], a[72:75]
    ds_read_b128 a[196:199], v4 offset:2048
    v_mfma_f32_16x16x32_bf16 a[76:79], a[240:243], a[208:211], a[76:79]
    ds_read_b64_tr_b16 a[224:225], v255 offset:256
    buffer_load_dwordx4 v15, s[8:11], s44 offen offset:2048 lds
    v_mfma_f32_16x16x32_bf16 a[80:83], a[240:243], a[212:215], a[80:83]
    ds_read_b64_tr_b16 a[226:227], v255 offset:1280
    v_mfma_f32_16x16x32_bf16 a[84:87], a[244:247], a[204:207], a[84:87]
    ds_read_b128 a[200:203], v4 offset:4096
    v_mfma_f32_16x16x32_bf16 a[88:91], a[244:247], a[208:211], a[88:91]
    ds_read_b64_tr_b16 a[228:229], v255 offset:264
    s_add_u32 m0, s80, 3072
    s_nop 0
    buffer_load_dwordx4 v244, s[8:11], s44 offen lds
    v_mfma_f32_16x16x32_bf16 a[92:95], a[244:247], a[212:215], a[92:95]
    ds_read_b64_tr_b16 a[230:231], v255 offset:1288
    v_add_u32 v4, s99, v4
    s_waitcnt lgkmcnt(8)
    v_mfma_f32_16x16x32_bf16 a[0:3], a[216:219], a[192:195], a[0:3]
    ds_read_b64_tr_b16 a[232:233], v255 offset:512
    s_waitcnt lgkmcnt(6)
    v_mfma_f32_16x16x32_bf16 a[4:7], a[216:219], a[196:199], a[4:7]
    ds_read_b64_tr_b16 a[234:235], v255 offset:1536
    buffer_load_dwordx4 v245, s[8:11], s44 offen offset:1024 lds
    s_waitcnt lgkmcnt(4)
    v_mfma_f32_16x16x32_bf16 a[8:11], a[216:219], a[200:203], a[8:11]
    ds_read_b128 a[204:207], v10 offset:0
    v_mfma_f32_16x16x32_bf16 a[12:15], a[220:223], a[192:195], a[12:15]
    ds_read_b64_tr_b16 a[236:237], v255 offset:520
    v_mfma_f32_16x16x32_bf16 a[16:19], a[220:223], a[196:199], a[16:19]
    ds_read_b64_tr_b16 a[238:239], v255 offset:1544
    buffer_load_dwordx4 v246, s[8:11], s44 offen offset:2048 lds
    s_add_u32 s44, s44, 128
    s_and_b32 s44, s44, 1023
    s_xor_b32 s80, s80, s81
    v_mfma_f32_16x16x32_bf16 a[20:23], a[220:223], a[200:203], a[20:23]
    ds_read_b128 a[208:211], v10 offset:2048
    v_mfma_f32_16x16x32_bf16 a[24:27], a[224:227], a[192:195], a[24:27]
    ds_read_b64_tr_b16 a[240:241], v255 offset:768
    v_mfma_f32_16x16x32_bf16 a[28:31], a[224:227], a[196:199], a[28:31]
    ds_read_b64_tr_b16 a[242:243], v255 offset:1792
    v_mfma_f32_16x16x32_bf16 a[32:35], a[224:227], a[200:203], a[32:35]
    ds_read_b128 a[212:215], v10 offset:4096
    s_add_u32 m0, s46, s74
    s_nop 0
    buffer_load_dwordx4 v5, s[12:15], s43 offen nt lds
    s_waitcnt lgkmcnt(9)
    v_mfma_f32_16x16x32_bf16 a[36:39], a[228:231], a[192:195], a[36:39]
    ds_read_b64_tr_b16 a[244:245], v255 offset:776
    v_add_u32 v10, s99, v10
    v_mfma_f32_16x16x32_bf16 a[40:43], a[228:231], a[196:199], a[40:43]
    ds_read_b64_tr_b16 a[246:247], v255 offset:1800
    s_sub_u32 s99, 0, s99
    v_mfma_f32_16x16x32_bf16 a[44:47], a[228:231], a[200:203], a[44:47]
    s_waitcnt lgkmcnt(9)
    v_mfma_f32_16x16x32_bf16 a[48:51], a[232:235], a[192:195], a[48:51]
    ds_read_b64_tr_b16 a[216:217], v3 offset:0
    buffer_load_dwordx4 v247, s[12:15], s43 offen offset:1056 nt lds
    v_mfma_f32_16x16x32_bf16 a[52:55], a[232:235], a[196:199], a[52:55]
    ds_read_b64_tr_b16 a[218:219], v3 offset:1024
    v_mfma_f32_16x16x32_bf16 a[56:59], a[232:235], a[200:203], a[56:59]
    s_waitcnt lgkmcnt(8)
    v_mfma_f32_16x16x32_bf16 a[60:63], a[236:239], a[192:195], a[60:63]
    ds_read_b64_tr_b16 a[220:221], v3 offset:8
    v_mfma_f32_16x16x32_bf16 a[64:67], a[236:239], a[196:199], a[64:67]
    ds_read_b64_tr_b16 a[222:223], v3 offset:1032
    s_add_u32 m0, s46, s76
    s_nop 0
    buffer_load_dwordx4 v5, s[16:19], s43 offen nt lds
    v_mfma_f32_16x16x32_bf16 a[68:71], a[236:239], a[200:203], a[68:71]
    s_waitcnt lgkmcnt(7)
    v_mfma_f32_16x16x32_bf16 a[72:75], a[240:243], a[192:195], a[72:75]
    ds_read_b64_tr_b16 a[224:225], v3 offset:256
    v_mfma_f32_16x16x32_bf16 a[76:79], a[240:243], a[196:199], a[76:79]
    ds_read_b64_tr_b16 a[226:227], v3 offset:1280
    v_mfma_f32_16x16x32_bf16 a[80:83], a[240:243], a[200:203], a[80:83]
    s_waitcnt lgkmcnt(6)
    buffer_load_dwordx4 v247, s[16:19], s43 offen offset:1056 nt lds
    v_mfma_f32_16x16x32_bf16 a[84:87], a[244:247], a[192:195], a[84:87]
    ds_read_b64_tr_b16 a[228:229], v3 offset:264
    s_add_u32 s43, s43, 8192
    v_mfma_f32_16x16x32_bf16 a[88:91], a[244:247], a[196:199], a[88:91]
    ds_read_b64_tr_b16 a[230:231], v3 offset:1288
    v_mfma_f32_16x16x32_bf16 a[92:95], a[244:247], a[200:203], a[92:95]
    s_waitcnt lgkmcnt(6)
    v_mfma_f32_16x16x32_bf16 a[0:3], a[216:219], a[204:207], a[0:3]
    ds_read_b64_tr_b16 a[232:233], v3 offset:512
    s_add_u32 m0, s46, s78
    s_nop 0
    buffer_load_dwordx4 v6, s[20:23], s45 offen nt lds
    v_mfma_f32_16x16x32_bf16 a[4:7], a[216:219], a[208:211], a[4:7]
    ds_read_b64_tr_b16 a[234:235], v3 offset:1536
    s_xor_b32 s46, s46, 83008
    v_mfma_f32_16x16x32_bf16 a[8:11], a[216:219], a[212:215], a[8:11]
    s_waitcnt lgkmcnt(6)
    v_mfma_f32_16x16x32_bf16 a[12:15], a[220:223], a[204:207], a[12:15]
    ds_read_b64_tr_b16 a[236:237], v3 offset:520
    v_mfma_f32_16x16x32_bf16 a[16:19], a[220:223], a[208:211], a[16:19]
    ds_read_b64_tr_b16 a[238:239], v3 offset:1544
    buffer_load_dwordx4 v7, s[20:23], s45 offen offset:1024 nt lds
    v_mfma_f32_16x16x32_bf16 a[20:23], a[220:223], a[212:215], a[20:23]
    s_waitcnt lgkmcnt(6)
    s_add_u32 s45, s45, 262144
    s_cmp_ge_u32 s45, 4194304
    s_cselect_b32 s84, 4194048, 0
    v_mfma_f32_16x16x32_bf16 a[24:27], a[224:227], a[204:207], a[24:27]
    ds_read_b64_tr_b16 a[240:241], v3 offset:768
    s_sub_u32 s45, s45, s84
    v_mfma_f32_16x16x32_bf16 a[28:31], a[224:227], a[208:211], a[28:31]
    ds_read_b64_tr_b16 a[242:243], v3 offset:1792
    v_mfma_f32_16x16x32_bf16 a[32:35], a[224:227], a[212:215], a[32:35]
    s_waitcnt lgkmcnt(6)
    v_mfma_f32_16x16x32_bf16 a[36:39], a[228:231], a[204:207], a[36:39]
    ds_read_b64_tr_b16 a[244:245], v3 offset:776
    v_mfma_f32_16x16x32_bf16 a[40:43], a[228:231], a[208:211], a[40:43]
    ds_read_b64_tr_b16 a[246:247], v3 offset:1800
    v_mfma_f32_16x16x32_bf16 a[44:47], a[228:231], a[212:215], a[44:47]
    s_waitcnt lgkmcnt(6)
    v_mfma_f32_16x16x32_bf16 a[48:51], a[232:235], a[204:207], a[48:51]
    s_waitcnt vmcnt(6)
    s_barrier
    s_waitcnt lgkmcnt(0)
    v_mfma_f32_16x16x32_bf16 a[52:55], a[232:235], a[208:211], a[52:55]
    ds_read_b64_tr_b16 a[216:217], v255 offset:25120
    s_mov_b32 m0, s80
    s_nop 0
    buffer_load_dwordx4 v8, s[8:11], s44 offen lds
    v_mfma_f32_16x16x32_bf16 a[56:59], a[232:235], a[212:215], a[56:59]
    ds_read_b64_tr_b16 a[218:219], v255 offset:26144
    v_mfma_f32_16x16x32_bf16 a[60:63], a[236:239], a[204:207], a[60:63]
    ds_read_b128 a[192:195], v4 offset:0
    v_mfma_f32_16x16x32_bf16 a[64:67], a[236:239], a[208:211], a[64:67]
    ds_read_b64_tr_b16 a[220:221], v255 offset:25128
    buffer_load_dwordx4 v9, s[8:11], s44 offen offset:1024 lds
    v_mfma_f32_16x16x32_bf16 a[68:71], a[236:239], a[212:215], a[68:71]
    ds_read_b64_tr_b16 a[222:223], v255 offset:26152
    v_mfma_f32_16x16x32_bf16 a[72:75], a[240:243], a[204:207], a[72:75]
    ds_read_b128 a[196:199], v4 offset:2048
    v_mfma_f32_16x16x32_bf16 a[76:79], a[240:243], a[208:211], a[76:79]
    ds_read_b64_tr_b16 a[224:225], v255 offset:25376
    buffer_load_dwordx4 v15, s[8:11], s44 offen offset:2048 lds
    v_mfma_f32_16x16x32_bf16 a[80:83], a[240:243], a[212:215], a[80:83]
    ds_read_b64_tr_b16 a[226:227], v255 offset:26400
    v_mfma_f32_16x16x32_bf16 a[84:87], a[244:247], a[204:207], a[84:87]
    ds_read_b128 a[200:203], v4 offset:4096
    v_mfma_f32_16x16x32_bf16 a[88:91], a[244:247], a[208:211], a[88:91]
    ds_read_b64_tr_b16 a[228:229], v255 offset:25384
    s_add_u32 m0, s80, 3072
    s_nop 0
    buffer_load_dwordx4 v244, s[8:11], s44 offen lds
    v_mfma_f32_16x16x32_bf16 a[92:95], a[244:247], a[212:215], a[92:95]
    ds_read_b64_tr_b16 a[230:231], v255 offset:26408
    v_add_u32 v4, s99, v4
    s_waitcnt lgkmcnt(8)
    v_mfma_f32_16x16x32_bf16 a[0:3], a[216:219], a[192:195], a[0:3]
    ds_read_b64_tr_b16 a[232:233], v255 offset:25632
    s_waitcnt lgkmcnt(6)
    v_mfma_f32_16x16x32_bf16 a[4:7], a[216:219], a[196:199], a[4:7]
    ds_read_b64_tr_b16 a[234:235], v255 offset:26656
    buffer_load_dwordx4 v245, s[8:11], s44 offen offset:1024 lds
    s_waitcnt lgkmcnt(4)
    v_mfma_f32_16x16x32_bf16 a[8:11], a[216:219], a[200:203], a[8:11]
    ds_read_b128 a[204:207], v10 offset:0
    v_mfma_f32_16x16x32_bf16 a[12:15], a[220:223], a[192:195], a[12:15]
    ds_read_b64_tr_b16 a[236:237], v255 offset:25640
    v_mfma_f32_16x16x32_bf16 a[16:19], a[220:223], a[196:199], a[16:19]
    ds_read_b64_tr_b16 a[238:239], v255 offset:26664
    buffer_load_dwordx4 v246, s[8:11], s44 offen offset:2048 lds
    s_add_u32 s44, s44, 128
    s_and_b32 s44, s44, 1023
    s_xor_b32 s80, s80, s81
    v_mfma_f32_16x16x32_bf16 a[20:23], a[220:223], a[200:203], a[20:23]
    ds_read_b128 a[208:211], v10 offset:2048
    v_mfma_f32_16x16x32_bf16 a[24:27], a[224:227], a[192:195], a[24:27]
    ds_read_b64_tr_b16 a[240:241], v255 offset:25888
    v_mfma_f32_16x16x32_bf16 a[28:31], a[224:227], a[196:199], a[28:31]
    ds_read_b64_tr_b16 a[242:243], v255 offset:26912
    v_mfma_f32_16x16x32_bf16 a[32:35], a[224:227], a[200:203], a[32:35]
    ds_read_b128 a[212:215], v10 offset:4096
    s_add_u32 m0, s47, s74
    s_nop 0
    buffer_load_dwordx4 v5, s[12:15], s43 offen nt lds
    s_waitcnt lgkmcnt(9)
    v_mfma_f32_16x16x32_bf16 a[36:39], a[228:231], a[192:195], a[36:39]
    ds_read_b64_tr_b16 a[244:245], v255 offset:25896
    v_add_u32 v10, s99, v10
    v_mfma_f32_16x16x32_bf16 a[40:43], a[228:231], a[196:199], a[40:43]
    ds_read_b64_tr_b16 a[246:247], v255 offset:26920
    s_sub_u32 s99, 0, s99
    v_mfma_f32_16x16x32_bf16 a[44:47], a[228:231], a[200:203], a[44:47]
    s_waitcnt lgkmcnt(9)
    v_add_u32 v255, s83, v255
    v_mfma_f32_16x16x32_bf16 a[48:51], a[232:235], a[192:195], a[48:51]
    ds_read_b64_tr_b16 a[216:217], v3 offset:25120
    buffer_load_dwordx4 v247, s[12:15], s43 offen offset:1056 nt lds
    v_mfma_f32_16x16x32_bf16 a[52:55], a[232:235], a[196:199], a[52:55]
    ds_read_b64_tr_b16 a[218:219], v3 offset:26144
    v_mfma_f32_16x16x32_bf16 a[56:59], a[232:235], a[200:203], a[56:59]
    s_waitcnt lgkmcnt(8)
    v_mfma_f32_16x16x32_bf16 a[60:63], a[236:239], a[192:195], a[60:63]
    ds_read_b64_tr_b16 a[220:221], v3 offset:25128
    v_mfma_f32_16x16x32_bf16 a[64:67], a[236:239], a[196:199], a[64:67]
    ds_read_b64_tr_b16 a[222:223], v3 offset:26152
    s_add_u32 m0, s47, s76
    s_nop 0
    buffer_load_dwordx4 v5, s[16:19], s43 offen nt lds
    v_mfma_f32_16x16x32_bf16 a[68:71], a[236:239], a[200:203], a[68:71]
    s_waitcnt lgkmcnt(7)
    v_mfma_f32_16x16x32_bf16 a[72:75], a[240:243], a[192:195], a[72:75]
    ds_read_b64_tr_b16 a[224:225], v3 offset:25376
    v_mfma_f32_16x16x32_bf16 a[76:79], a[240:243], a[196:199], a[76:79]
    ds_read_b64_tr_b16 a[226:227], v3 offset:26400
    v_mfma_f32_16x16x32_bf16 a[80:83], a[240:243], a[200:203], a[80:83]
    s_waitcnt lgkmcnt(6)
    buffer_load_dwordx4 v247, s[16:19], s43 offen offset:1056 nt lds
    v_mfma_f32_16x16x32_bf16 a[84:87], a[244:247], a[192:195], a[84:87]
    ds_read_b64_tr_b16 a[228:229], v3 offset:25384
    s_add_u32 s43, s43, 8192
    v_mfma_f32_16x16x32_bf16 a[88:91], a[244:247], a[196:199], a[88:91]
    ds_read_b64_tr_b16 a[230:231], v3 offset:26408
    v_mfma_f32_16x16x32_bf16 a[92:95], a[244:247], a[200:203], a[92:95]
    s_waitcnt lgkmcnt(6)
    v_mfma_f32_16x16x32_bf16 a[0:3], a[216:219], a[204:207], a[0:3]
    ds_read_b64_tr_b16 a[232:233], v3 offset:25632
    s_add_u32 m0, s47, s78
    s_nop 0
    buffer_load_dwordx4 v6, s[20:23], s45 offen nt lds
    v_mfma_f32_16x16x32_bf16 a[4:7], a[216:219], a[208:211], a[4:7]
    ds_read_b64_tr_b16 a[234:235], v3 offset:26656
    s_xor_b32 s47, s47, 50240
    v_mfma_f32_16x16x32_bf16 a[8:11], a[216:219], a[212:215], a[8:11]
    s_waitcnt lgkmcnt(6)
    v_mfma_f32_16x16x32_bf16 a[12:15], a[220:223], a[204:207], a[12:15]
    ds_read_b64_tr_b16 a[236:237], v3 offset:25640
    v_mfma_f32_16x16x32_bf16 a[16:19], a[220:223], a[208:211], a[16:19]
    ds_read_b64_tr_b16 a[238:239], v3 offset:26664
    buffer_load_dwordx4 v7, s[20:23], s45 offen offset:1024 nt lds
    v_mfma_f32_16x16x32_bf16 a[20:23], a[220:223], a[212:215], a[20:23]
    s_waitcnt lgkmcnt(6)
    s_add_u32 s45, s45, 262144
    s_cmp_ge_u32 s45, 4194304
    s_cselect_b32 s84, 4194048, 0
    v_mfma_f32_16x16x32_bf16 a[24:27], a[224:227], a[204:207], a[24:27]
    ds_read_b64_tr_b16 a[240:241], v3 offset:25888
    s_sub_u32 s45, s45, s84
    v_mfma_f32_16x16x32_bf16 a[28:31], a[224:227], a[208:211], a[28:31]
    ds_read_b64_tr_b16 a[242:243], v3 offset:26912
    v_mfma_f32_16x16x32_bf16 a[32:35], a[224:227], a[212:215], a[32:35]
    s_mov_b32 m0, s80
    s_waitcnt lgkmcnt(6)
    buffer_load_dwordx4 v8, s[8:11], s44 offen lds
    v_mfma_f32_16x16x32_bf16 a[36:39], a[228:231], a[204:207], a[36:39]
    ds_read_b64_tr_b16 a[244:245], v3 offset:25896
    v_mfma_f32_16x16x32_bf16 a[40:43], a[228:231], a[208:211], a[40:43]
    ds_read_b64_tr_b16 a[246:247], v3 offset:26920
    v_mfma_f32_16x16x32_bf16 a[44:47], a[228:231], a[212:215], a[44:47]
    s_waitcnt lgkmcnt(6)
    v_add_u32 v3, s83, v3
    s_sub_u32 s83, 0, s83
    v_mfma_f32_16x16x32_bf16 a[48:51], a[232:235], a[204:207], a[48:51]
    buffer_load_dwordx4 v9, s[8:11], s44 offen offset:1024 lds
    v_mfma_f32_16x16x32_bf16 a[52:55], a[232:235], a[208:211], a[52:55]
    v_mfma_f32_16x16x32_bf16 a[56:59], a[232:235], a[212:215], a[56:59]
    s_waitcnt lgkmcnt(4)
    v_mfma_f32_16x16x32_bf16 a[60:63], a[236:239], a[204:207], a[60:63]
    v_mfma_f32_16x16x32_bf16 a[64:67], a[236:239], a[208:211], a[64:67]
    buffer_load_dwordx4 v15, s[8:11], s44 offen offset:2048 lds
    v_mfma_f32_16x16x32_bf16 a[68:71], a[236:239], a[212:215], a[68:71]
    s_waitcnt lgkmcnt(2)
    v_mfma_f32_16x16x32_bf16 a[72:75], a[240:243], a[204:207], a[72:75]
    v_mfma_f32_16x16x32_bf16 a[76:79], a[240:243], a[208:211], a[76:79]
    v_mfma_f32_16x16x32_bf16 a[80:83], a[240:243], a[212:215], a[80:83]
    s_waitcnt lgkmcnt(0)
    v_mfma_f32_16x16x32_bf16 a[84:87], a[244:247], a[204:207], a[84:87]
    v_mfma_f32_16x16x32_bf16 a[88:91], a[244:247], a[208:211], a[88:91]
    v_mfma_f32_16x16x32_bf16 a[92:95], a[244:247], a[212:215], a[92:95]
    v_add_u32 v254, 8448, v1
    s_mov_b32 s91, 0
    ds_read_b128 a[216:219], v254 offset:0
    ds_read_b128 a[220:223], v254 offset:4224
    ds_read_b128 a[224:227], v254 offset:256
    ds_read_b128 a[228:231], v254 offset:4480
    s_waitcnt lgkmcnt(3)
    v_accvgpr_read_b32 v232, a0
    v_accvgpr_read_b32 v233, a1
    v_accvgpr_read_b32 v234, a2
    v_accvgpr_read_b32 v235, a3
    v_mul_f32 v232, s88, v232
    v_mul_f32 v233, s88, v233
    v_mul_f32 v234, s88, v234
    v_mul_f32 v235, s88, v235
    v_cvt_pk_bf16_f32 v88, v232, v233
    v_cvt_pk_bf16_f32 v89, v234, v235
    v_accvgpr_read_b32 v236, a12
    v_accvgpr_read_b32 v237, a13
    v_accvgpr_read_b32 v238, a14
    v_accvgpr_read_b32 v239, a15
    v_mul_f32 v236, s88, v236
    v_mul_f32 v237, s88, v237
    v_mul_f32 v238, s88, v238
    v_mul_f32 v239, s88, v239
    v_cvt_pk_bf16_f32 v90, v236, v237
    v_cvt_pk_bf16_f32 v91, v238, v239
    s_nop 1
    v_mfma_f32_16x16x32_bf16 v[16:19], a[216:219], v[88:91], 0
    ds_read_b128 a[232:235], v254 offset:512
    v_accvgpr_read_b32 v240, a4
    v_accvgpr_read_b32 v241, a5
    v_accvgpr_read_b32 v242, a6
    v_accvgpr_read_b32 v243, a7
    v_mul_f32 v240, s88, v240
    v_mul_f32 v241, s88, v241
    v_mul_f32 v242, s88, v242
    v_mul_f32 v243, s88, v243
    v_cvt_pk_bf16_f32 v92, v240, v241
    v_cvt_pk_bf16_f32 v93, v242, v243
    v_accvgpr_read_b32 v232, a16
    v_accvgpr_read_b32 v233, a17
    v_accvgpr_read_b32 v234, a18
    v_accvgpr_read_b32 v235, a19
    v_mul_f32 v232, s88, v232
    v_mul_f32 v233, s88, v233
    v_mul_f32 v234, s88, v234
    v_mul_f32 v235, s88, v235
    v_cvt_pk_bf16_f32 v94, v232, v233
    v_cvt_pk_bf16_f32 v95, v234, v235
    s_nop 1
    v_mfma_f32_16x16x32_bf16 v[20:23], a[216:219], v[92:95], 0
    v_accvgpr_read_b32 v236, a8
    v_accvgpr_read_b32 v237, a9
    v_accvgpr_read_b32 v238, a10
    v_accvgpr_read_b32 v239, a11
    v_mul_f32 v236, s88, v236
    v_mul_f32 v237, s88, v237
    v_mul_f32 v238, s88, v238
    v_mul_f32 v239, s88, v239
    v_cvt_pk_bf16_f32 v96, v236, v237
    v_cvt_pk_bf16_f32 v97, v238, v239
    v_accvgpr_read_b32 v240, a20
    v_accvgpr_read_b32 v241, a21
    v_accvgpr_read_b32 v242, a22
    v_accvgpr_read_b32 v243, a23
    v_mul_f32 v240, s88, v240
    v_mul_f32 v241, s88, v241
    v_mul_f32 v242, s88, v242
    v_mul_f32 v243, s88, v243
    v_cvt_pk_bf16_f32 v98, v240, v241
    v_cvt_pk_bf16_f32 v99, v242, v243
    s_nop 1
    v_mfma_f32_16x16x32_bf16 v[24:27], a[216:219], v[96:99], 0
    s_waitcnt lgkmcnt(3)
    v_accvgpr_read_b32 v232, a24
    v_accvgpr_read_b32 v233, a25
    v_mfma_f32_16x16x32_bf16 v[28:31], a[220:223], v[88:91], 0
    ds_read_b128 a[236:239], v254 offset:4736
    v_accvgpr_read_b32 v234, a26
    v_mfma_f32_16x16x32_bf16 v[32:35], a[220:223], v[92:95], 0
    v_accvgpr_read_b32 v235, a27
    v_mul_f32 v232, s88, v232
    v_mfma_f32_16x16x32_bf16 v[36:39], a[220:223], v[96:99], 0
    s_waitcnt lgkmcnt(3)
    v_mul_f32 v233, s88, v233
    v_mul_f32 v234, s88, v234
    v_mul_f32 v235, s88, v235
    v_cvt_pk_bf16_f32 v100, v232, v233
    v_cvt_pk_bf16_f32 v101, v234, v235
    v_accvgpr_read_b32 v236, a36
    v_accvgpr_read_b32 v237, a37
    v_accvgpr_read_b32 v238, a38
    v_accvgpr_read_b32 v239, a39
    v_mul_f32 v236, s88, v236
    v_mul_f32 v237, s88, v237
    v_mul_f32 v238, s88, v238
    v_mul_f32 v239, s88, v239
    v_cvt_pk_bf16_f32 v102, v236, v237
    v_cvt_pk_bf16_f32 v103, v238, v239
    s_nop 1
    v_mfma_f32_16x16x32_bf16 v[16:19], a[224:227], v[100:103], v[16:19]
    ds_read_b128 a[240:243], v254 offset:768
    v_accvgpr_read_b32 v240, a28
    v_accvgpr_read_b32 v241, a29
    v_accvgpr_read_b32 v242, a30
    v_accvgpr_read_b32 v243, a31
    v_mul_f32 v240, s88, v240
    v_mul_f32 v241, s88, v241
    v_mul_f32 v242, s88, v242
    v_mul_f32 v243, s88, v243
    v_cvt_pk_bf16_f32 v104, v240, v241
    v_cvt_pk_bf16_f32 v105, v242, v243
    v_accvgpr_read_b32 v232, a40
    v_accvgpr_read_b32 v233, a41
    v_accvgpr_read_b32 v234, a42
    v_accvgpr_read_b32 v235, a43
    v_mul_f32 v232, s88, v232
    v_mul_f32 v233, s88, v233
    v_mul_f32 v234, s88, v234
    v_mul_f32 v235, s88, v235
    v_cvt_pk_bf16_f32 v106, v232, v233
    v_cvt_pk_bf16_f32 v107, v234, v235
    s_nop 1
    v_mfma_f32_16x16x32_bf16 v[20:23], a[224:227], v[104:107], v[20:23]
    v_accvgpr_read_b32 v236, a32
    v_accvgpr_read_b32 v237, a33
    v_accvgpr_read_b32 v238, a34
    v_accvgpr_read_b32 v239, a35
    v_mul_f32 v236, s88, v236
    v_mul_f32 v237, s88, v237
    v_mul_f32 v238, s88, v238
    v_mul_f32 v239, s88, v239
    v_cvt_pk_bf16_f32 v108, v236, v237
    v_cvt_pk_bf16_f32 v109, v238, v239
    v_accvgpr_read_b32 v240, a44
    v_accvgpr_read_b32 v241, a45
    v_accvgpr_read_b32 v242, a46
    v_accvgpr_read_b32 v243, a47
    v_mul_f32 v240, s88, v240
    v_mul_f32 v241, s88, v241
    v_mul_f32 v242, s88, v242
    v_mul_f32 v243, s88, v243
    v_cvt_pk_bf16_f32 v110, v240, v241
    v_cvt_pk_bf16_f32 v111, v242, v243
    s_nop 1
    v_mfma_f32_16x16x32_bf16 v[24:27], a[224:227], v[108:111], v[24:27]
    s_waitcnt lgkmcnt(3)
    v_accvgpr_read_b32 v232, a48
    v_accvgpr_read_b32 v233, a49
    v_mfma_f32_16x16x32_bf16 v[28:31], a[228:231], v[100:103], v[28:31]
    ds_read_b128 a[244:247], v254 offset:4992
    v_accvgpr_read_b32 v234, a50
    v_mfma_f32_16x16x32_bf16 v[32:35], a[228:231], v[104:107], v[32:35]
    v_accvgpr_read_b32 v235, a51
    v_mul_f32 v232, s88, v232
    v_mfma_f32_16x16x32_bf16 v[36:39], a[228:231], v[108:111], v[36:39]
    s_waitcnt lgkmcnt(3)
    v_mul_f32 v233, s88, v233
    v_mul_f32 v234, s88, v234
    v_mul_f32 v235, s88, v235
    v_cvt_pk_bf16_f32 v112, v232, v233
    v_cvt_pk_bf16_f32 v113, v234, v235
    v_accvgpr_read_b32 v236, a60
    v_accvgpr_read_b32 v237, a61
    v_accvgpr_read_b32 v238, a62
    v_accvgpr_read_b32 v239, a63
    v_mul_f32 v236, s88, v236
    v_mul_f32 v237, s88, v237
    v_mul_f32 v238, s88, v238
    v_mul_f32 v239, s88, v239
    v_cvt_pk_bf16_f32 v114, v236, v237
    v_cvt_pk_bf16_f32 v115, v238, v239
    s_nop 1
    v_mfma_f32_16x16x32_bf16 v[16:19], a[232:235], v[112:115], v[16:19]
    v_accvgpr_read_b32 v240, a52
    v_accvgpr_read_b32 v241, a53
    v_accvgpr_read_b32 v242, a54
    v_accvgpr_read_b32 v243, a55
    v_mul_f32 v240, s88, v240
    v_mul_f32 v241, s88, v241
    v_mul_f32 v242, s88, v242
    v_mul_f32 v243, s88, v243
    v_cvt_pk_bf16_f32 v116, v240, v241
    v_cvt_pk_bf16_f32 v117, v242, v243
    v_accvgpr_read_b32 v232, a64
    v_accvgpr_read_b32 v233, a65
    v_accvgpr_read_b32 v234, a66
    v_accvgpr_read_b32 v235, a67
    v_mul_f32 v232, s88, v232
    v_mul_f32 v233, s88, v233
    v_mul_f32 v234, s88, v234
    v_mul_f32 v235, s88, v235
    v_cvt_pk_bf16_f32 v118, v232, v233
    v_cvt_pk_bf16_f32 v119, v234, v235
    s_nop 1
    v_mfma_f32_16x16x32_bf16 v[20:23], a[232:235], v[116:119], v[20:23]
    v_accvgpr_read_b32 v236, a56
    v_accvgpr_read_b32 v237, a57
    v_accvgpr_read_b32 v238, a58
    v_accvgpr_read_b32 v239, a59
    v_mul_f32 v236, s88, v236
    v_mul_f32 v237, s88, v237
    v_mul_f32 v238, s88, v238
    v_mul_f32 v239, s88, v239
    v_cvt_pk_bf16_f32 v120, v236, v237
    v_cvt_pk_bf16_f32 v121, v238, v239
    v_accvgpr_read_b32 v240, a68
    v_accvgpr_read_b32 v241, a69
    v_accvgpr_read_b32 v242, a70
    v_accvgpr_read_b32 v243, a71
    v_mul_f32 v240, s88, v240
    v_mul_f32 v241, s88, v241
    v_mul_f32 v242, s88, v242
    v_mul_f32 v243, s88, v243
    v_cvt_pk_bf16_f32 v122, v240, v241
    v_cvt_pk_bf16_f32 v123, v242, v243
    s_nop 1
    v_mfma_f32_16x16x32_bf16 v[24:27], a[232:235], v[120:123], v[24:27]
    s_waitcnt lgkmcnt(2)
    v_accvgpr_read_b32 v232, a72
    v_accvgpr_read_b32 v233, a73
    v_mfma_f32_16x16x32_bf16 v[28:31], a[236:239], v[112:115], v[28:31]
    v_accvgpr_read_b32 v234, a74
    v_accvgpr_read_b32 v235, a75
    v_mfma_f32_16x16x32_bf16 v[32:35], a[236:239], v[116:119], v[32:35]
    v_mul_f32 v232, s88, v232
    v_mul_f32 v233, s88, v233
    v_mfma_f32_16x16x32_bf16 v[36:39], a[236:239], v[120:123], v[36:39]
    s_waitcnt lgkmcnt(1)
    v_mul_f32 v234, s88, v234
    v_mul_f32 v235, s88, v235
    v_cvt_pk_bf16_f32 v124, v232, v233
    v_cvt_pk_bf16_f32 v125, v234, v235
    v_accvgpr_read_b32 v236, a84
    v_accvgpr_read_b32 v237, a85
    v_accvgpr_read_b32 v238, a86
    v_accvgpr_read_b32 v239, a87
    v_mul_f32 v236, s88, v236
    v_mul_f32 v237, s88, v237
    v_mul_f32 v238, s88, v238
    v_mul_f32 v239, s88, v239
    v_cvt_pk_bf16_f32 v126, v236, v237
    v_cvt_pk_bf16_f32 v127, v238, v239
    s_nop 1
    v_mfma_f32_16x16x32_bf16 v[16:19], a[240:243], v[124:127], v[16:19]
    v_accvgpr_read_b32 v240, a76
    v_accvgpr_read_b32 v241, a77
    v_accvgpr_read_b32 v242, a78
    v_accvgpr_read_b32 v243, a79
    v_mul_f32 v240, s88, v240
    v_mul_f32 v241, s88, v241
    v_mul_f32 v242, s88, v242
    v_mul_f32 v243, s88, v243
    v_cvt_pk_bf16_f32 v128, v240, v241
    v_cvt_pk_bf16_f32 v129, v242, v243
    v_accvgpr_read_b32 v232, a88
    v_accvgpr_read_b32 v233, a89
    v_accvgpr_read_b32 v234, a90
    v_accvgpr_read_b32 v235, a91
    v_mul_f32 v232, s88, v232
    v_mul_f32 v233, s88, v233
    v_mul_f32 v234, s88, v234
    v_mul_f32 v235, s88, v235
    v_cvt_pk_bf16_f32 v130, v232, v233
    v_cvt_pk_bf16_f32 v131, v234, v235
    s_nop 1
    v_mfma_f32_16x16x32_bf16 v[20:23], a[240:243], v[128:131], v[20:23]
    v_accvgpr_read_b32 v236, a80
    v_accvgpr_read_b32 v237, a81
    v_accvgpr_read_b32 v238, a82
    v_accvgpr_read_b32 v239, a83
    v_mul_f32 v236, s88, v236
    v_mul_f32 v237, s88, v237
    v_mul_f32 v238, s88, v238
    v_mul_f32 v239, s88, v239
    v_cvt_pk_bf16_f32 v132, v236, v237
    v_cvt_pk_bf16_f32 v133, v238, v239
    v_accvgpr_read_b32 v240, a92
    v_accvgpr_read_b32 v241, a93
    v_accvgpr_read_b32 v242, a94
    v_accvgpr_read_b32 v243, a95
    v_mul_f32 v240, s88, v240
    v_mul_f32 v241, s88, v241
    v_mul_f32 v242, s88, v242
    v_mul_f32 v243, s88, v243
    v_cvt_pk_bf16_f32 v134, v240, v241
    v_cvt_pk_bf16_f32 v135, v242, v243
    s_nop 1
    v_mfma_f32_16x16x32_bf16 v[24:27], a[240:243], v[132:135], v[24:27]
    s_waitcnt lgkmcnt(0)
    v_mfma_f32_16x16x32_bf16 v[28:31], a[244:247], v[124:127], v[28:31]
    v_mfma_f32_16x16x32_bf16 v[32:35], a[244:247], v[128:131], v[32:35]
    v_mfma_f32_16x16x32_bf16 v[36:39], a[244:247], v[132:135], v[36:39]
    s_waitcnt lgkmcnt(0)
    s_waitcnt vmcnt(9)
    s_barrier
    ds_read_b128 a[192:195], v4 offset:0
    ds_read_b128 a[196:199], v4 offset:2048
    ds_read_b128 a[200:203], v4 offset:4096
    ds_read_b128 a[216:219], v1 offset:0
    ds_read_b128 a[220:223], v1 offset:256
    ds_read_b64_tr_b16 a[224:225], v3 offset:0
    ds_read_b64_tr_b16 a[226:227], v3 offset:1024
    ds_read_b64_tr_b16 a[228:229], v3 offset:8
    ds_read_b64_tr_b16 a[230:231], v3 offset:1032
    s_waitcnt lgkmcnt(5)
    v_mfma_f32_16x16x32_bf16 v[40:43], a[216:219], v[88:91], 0
    ds_read_b128 a[232:235], v1 offset:512
    v_mfma_f32_16x16x32_bf16 v[44:47], a[216:219], v[92:95], 0
    v_exp_f32 v16, v16
    v_mfma_f32_16x16x32_bf16 v[48:51], a[216:219], v[96:99], 0
    s_waitcnt lgkmcnt(5)
    v_exp_f32 v17, v17
    v_mfma_f32_16x16x32_bf16 v[40:43], a[220:223], v[100:103], v[40:43]
    ds_read_b64_tr_b16 a[236:237], v3 offset:256
    v_mov_b32 v11, v16
    v_mfma_f32_16x16x32_bf16 v[44:47], a[220:223], v[104:107], v[44:47]
    ds_read_b64_tr_b16 a[238:239], v3 offset:1280
    v_add_f32 v11, v17, v11
    v_mfma_f32_16x16x32_bf16 v[48:51], a[220:223], v[108:111], v[48:51]
    s_add_u32 m0, s80, 3072
    s_waitcnt lgkmcnt(5)
    buffer_load_dwordx4 v244, s[8:11], s44 offen lds
    v_mfma_f32_16x16x32_bf16 a[0:3], a[224:227], a[192:195], 0
    ds_read_b64_tr_b16 a[240:241], v3 offset:264
    v_cvt_pk_bf16_f32 v64, v16, v17
    v_mfma_f32_16x16x32_bf16 a[4:7], a[224:227], a[196:199], 0
    ds_read_b64_tr_b16 a[242:243], v3 offset:1288
    s_xor_b32 s80, s80, s81
    v_mfma_f32_16x16x32_bf16 a[8:11], a[224:227], a[200:203], 0
    s_waitcnt lgkmcnt(5)
    buffer_load_dwordx4 v245, s[8:11], s44 offen offset:1024 lds
    v_mfma_f32_16x16x32_bf16 a[12:15], a[228:231], a[192:195], 0
    ds_read_b128 a[244:247], v1 offset:768
    v_exp_f32 v18, v18
    v_mfma_f32_16x16x32_bf16 a[16:19], a[228:231], a[196:199], 0
    buffer_load_dwordx4 v246, s[8:11], s44 offen offset:2048 lds
    v_mfma_f32_16x16x32_bf16 a[20:23], a[228:231], a[200:203], 0
    s_waitcnt lgkmcnt(5)
    v_exp_f32 v19, v19
    v_mfma_f32_16x16x32_bf16 v[40:43], a[232:235], v[112:115], v[40:43]
    ds_read_b64_tr_b16 a[216:217], v3 offset:512
    v_exp_f32 v20, v20
    v_mfma_f32_16x16x32_bf16 v[44:47], a[232:235], v[116:119], v[44:47]
    ds_read_b64_tr_b16 a[218:219], v3 offset:1536
    v_exp_f32 v21, v21
    v_mfma_f32_16x16x32_bf16 v[48:51], a[232:235], v[120:123], v[48:51]
    s_add_u32 s44, s44, 128
    s_add_u32 m0, s46, s74
    s_waitcnt lgkmcnt(5)
    buffer_load_dwordx4 v5, s[12:15], s43 offen nt lds
    v_mfma_f32_16x16x32_bf16 a[24:27], a[236:239], a[192:195], 0
    ds_read_b64_tr_b16 a[220:221], v3 offset:520
    v_exp_f32 v22, v22
    v_mfma_f32_16x16x32_bf16 a[28:31], a[236:239], a[196:199], 0
    ds_read_b64_tr_b16 a[222:223], v3 offset:1544
    v_exp_f32 v23, v23
    v_mfma_f32_16x16x32_bf16 a[32:35], a[236:239], a[200:203], 0
    s_and_b32 s44, s44, 1023
    s_waitcnt lgkmcnt(5)
    buffer_load_dwordx4 v247, s[12:15], s43 offen offset:1056 nt lds
    v_mfma_f32_16x16x32_bf16 a[36:39], a[240:243], a[192:195], 0
    ds_read_b128 a[224:227], v1 offset:4224
    v_exp_f32 v24, v24
    v_mfma_f32_16x16x32_bf16 a[40:43], a[240:243], a[196:199], 0
    s_add_u32 m0, s46, s76
    s_nop 0
    buffer_load_dwordx4 v5, s[16:19], s43 offen nt lds
    v_mfma_f32_16x16x32_bf16 a[44:47], a[240:243], a[200:203], 0
    s_waitcnt lgkmcnt(5)
    v_exp_f32 v25, v25
    v_mfma_f32_16x16x32_bf16 v[40:43], a[244:247], v[124:127], v[40:43]
    ds_read_b64_tr_b16 a[228:229], v3 offset:768
    v_exp_f32 v26, v26
    v_mfma_f32_16x16x32_bf16 v[44:47], a[244:247], v[128:131], v[44:47]
    ds_read_b64_tr_b16 a[230:231], v3 offset:1792
    v_exp_f32 v27, v27
    v_mfma_f32_16x16x32_bf16 v[48:51], a[244:247], v[132:135], v[48:51]
    s_waitcnt lgkmcnt(5)
    buffer_load_dwordx4 v247, s[16:19], s43 offen offset:1056 nt lds
    v_mfma_f32_16x16x32_bf16 a[48:51], a[216:219], a[192:195], 0
    ds_read_b64_tr_b16 a[232:233], v3 offset:776
    v_exp_f32 v28, v28
    v_mfma_f32_16x16x32_bf16 a[52:55], a[216:219], a[196:199], 0
    ds_read_b64_tr_b16 a[234:235], v3 offset:1800
    v_exp_f32 v29, v29
    v_mfma_f32_16x16x32_bf16 a[56:59], a[216:219], a[200:203], 0
    s_add_u32 s43, s43, 8192
    s_add_u32 m0, s46, s78
    s_waitcnt lgkmcnt(5)
    buffer_load_dwordx4 v6, s[20:23], s45 offen nt lds
    v_mfma_f32_16x16x32_bf16 a[60:63], a[220:223], a[192:195], 0
    ds_read_b128 a[236:239], v1 offset:4480
    v_add_f32 v11, v18, v11
    v_mfma_f32_16x16x32_bf16 a[64:67], a[220:223], a[196:199], 0
    s_xor_b32 s46, s46, 83008
    buffer_load_dwordx4 v7, s[20:23], s45 offen offset:1024 nt lds
    v_mfma_f32_16x16x32_bf16 a[68:71], a[220:223], a[200:203], 0
    s_waitcnt lgkmcnt(5)
    v_exp_f32 v30, v30
    v_mfma_f32_16x16x32_bf16 v[52:55], a[224:227], v[88:91], 0
    ds_read_b128 a[240:243], v1 offset:4736
    v_add_f32 v11, v19, v11
    v_mfma_f32_16x16x32_bf16 v[56:59], a[224:227], v[92:95], 0
    v_exp_f32 v31, v31
    v_mfma_f32_16x16x32_bf16 v[60:63], a[224:227], v[96:99], 0
    s_waitcnt lgkmcnt(4)
    v_exp_f32 v32, v32
    v_mfma_f32_16x16x32_bf16 a[72:75], a[228:231], a[192:195], 0
    ds_read_b128 a[244:247], v1 offset:4992
    v_cvt_pk_bf16_f32 v65, v18, v19
    v_mfma_f32_16x16x32_bf16 a[76:79], a[228:231], a[196:199], 0
    v_exp_f32 v33, v33
    v_mfma_f32_16x16x32_bf16 a[80:83], a[228:231], a[200:203], 0
    s_waitcnt lgkmcnt(3)
    v_exp_f32 v34, v34
    v_mov_b32 v12, v20
    v_add_f32 v12, v21, v12
    v_cvt_pk_bf16_f32 v68, v20, v21
    v_add_f32 v12, v22, v12
    v_add_f32 v12, v23, v12
    v_cvt_pk_bf16_f32 v69, v22, v23
    v_mov_b32 v13, v24
    v_add_f32 v13, v25, v13
    v_cvt_pk_bf16_f32 v72, v24, v25
    v_add_f32 v13, v26, v13
    v_add_f32 v13, v27, v13
    v_cvt_pk_bf16_f32 v73, v26, v27
    v_add_f32 v11, v28, v11
    v_add_f32 v11, v29, v11
    v_cvt_pk_bf16_f32 v66, v28, v29
    v_add_f32 v11, v30, v11
    v_exp_f32 v35, v35
    v_add_f32 v11, v31, v11
    v_cvt_pk_bf16_f32 v67, v30, v31
    v_exp_f32 v36, v36
    v_add_f32 v12, v32, v12
    v_exp_f32 v37, v37
    v_add_f32 v12, v33, v12
    v_exp_f32 v38, v38
    v_cvt_pk_bf16_f32 v70, v32, v33
    v_add_f32 v12, v34, v12
    v_exp_f32 v39, v39
    s_add_u32 s45, s45, 262144
    s_cmp_ge_u32 s45, 4194304
    s_cselect_b32 s84, 4194048, 0
    s_sub_u32 s45, s45, s84
    v_mfma_f32_16x16x32_bf16 a[84:87], a[232:235], a[192:195], 0
    s_barrier
    s_waitcnt lgkmcnt(0)
    v_mfma_f32_16x16x32_bf16 a[88:91], a[232:235], a[196:199], 0
    ds_read_b128 a[216:219], v1 offset:25120
    v_add_f32 v12, v35, v12
    v_mfma_f32_16x16x32_bf16 a[92:95], a[232:235], a[200:203], 0
    ds_read_b128 a[192:195], v10 offset:0
    v_cvt_pk_bf16_f32 v71, v34, v35
    v_mfma_f32_16x16x32_bf16 v[52:55], a[236:239], v[100:103], v[52:55]
    ds_read_b64_tr_b16 a[220:221], v2 offset:25120
    v_add_f32 v13, v36, v13
    v_mfma_f32_16x16x32_bf16 v[56:59], a[236:239], v[104:107], v[56:59]
    ds_read_b64_tr_b16 a[222:223], v2 offset:29344
    v_add_f32 v13, v37, v13
    v_mfma_f32_16x16x32_bf16 v[60:63], a[236:239], v[108:111], v[60:63]
    ds_read_b128 a[196:199], v10 offset:2048
    v_cvt_pk_bf16_f32 v74, v36, v37
    v_mfma_f32_16x16x32_bf16 v[52:55], a[240:243], v[112:115], v[52:55]
    ds_read_b64_tr_b16 a[224:225], v3 offset:25120
    v_add_f32 v13, v38, v13
    v_mfma_f32_16x16x32_bf16 v[56:59], a[240:243], v[116:119], v[56:59]
    ds_read_b64_tr_b16 a[226:227], v3 offset:26144
    v_add_f32 v13, v39, v13
    v_mfma_f32_16x16x32_bf16 v[60:63], a[240:243], v[120:123], v[60:63]
    ds_read_b128 a[200:203], v10 offset:4096
    v_cvt_pk_bf16_f32 v75, v38, v39
    v_mfma_f32_16x16x32_bf16 v[52:55], a[244:247], v[124:127], v[52:55]
    ds_read_b64_tr_b16 a[228:229], v3 offset:25128
    v_add_u32 v4, s99, v4
    v_mfma_f32_16x16x32_bf16 v[56:59], a[244:247], v[128:131], v[56:59]
    ds_read_b64_tr_b16 a[230:231], v3 offset:26152
    v_add_u32 v10, s99, v10
    v_mfma_f32_16x16x32_bf16 v[60:63], a[244:247], v[132:135], v[60:63]
    s_sub_u32 s99, 0, s99
    s_add_u32 m0, s47, s74
    s_waitcnt lgkmcnt(9)
    buffer_load_dwordx4 v5, s[12:15], s43 offen nt lds
    v_mfma_f32_16x16x32_bf16 v[16:19], a[216:219], v[88:91], 0
    ds_read_b128 a[232:235], v1 offset:25376
    v_exp_f32 v40, v40
    v_mfma_f32_16x16x32_bf16 v[20:23], a[216:219], v[92:95], 0
    buffer_load_dwordx4 v247, s[12:15], s43 offen offset:1056 nt lds
    v_mfma_f32_16x16x32_bf16 v[24:27], a[216:219], v[96:99], 0
    s_waitcnt lgkmcnt(7)
    v_exp_f32 v41, v41
    v_mfma_f32_16x16x32_bf16 v[136:139], a[220:223], v[64:67], 0
    ds_read_b64_tr_b16 a[236:237], v3 offset:25376
    v_add_f32 v11, v40, v11
    v_mfma_f32_16x16x32_bf16 v[140:143], a[220:223], v[68:71], 0
    ds_read_b64_tr_b16 a[238:239], v3 offset:26400
    v_add_f32 v11, v41, v11
    v_mfma_f32_16x16x32_bf16 v[144:147], a[220:223], v[72:75], 0
    s_add_u32 m0, s47, s76
    s_waitcnt lgkmcnt(5)
    buffer_load_dwordx4 v5, s[16:19], s43 offen nt lds
    v_mfma_f32_16x16x32_bf16 a[0:3], a[224:227], a[192:195], a[0:3]
    ds_read_b64_tr_b16 a[240:241], v3 offset:25384
    v_cvt_pk_bf16_f32 v76, v40, v41
    v_mfma_f32_16x16x32_bf16 a[4:7], a[224:227], a[196:199], a[4:7]
    ds_read_b64_tr_b16 a[242:243], v3 offset:26408
    v_mfma_f32_16x16x32_bf16 a[8:11], a[224:227], a[200:203], a[8:11]
    s_waitcnt lgkmcnt(5)
    v_exp_f32 v42, v42
    v_mfma_f32_16x16x32_bf16 a[12:15], a[228:231], a[192:195], a[12:15]
    ds_read_b64_tr_b16 a[244:245], v2 offset:25152
    v_add_f32 v11, v42, v11
    v_mfma_f32_16x16x32_bf16 a[16:19], a[228:231], a[196:199], a[16:19]
    ds_read_b64_tr_b16 a[246:247], v2 offset:29376
    v_exp_f32 v43, v43
    v_mfma_f32_16x16x32_bf16 a[20:23], a[228:231], a[200:203], a[20:23]
    s_waitcnt lgkmcnt(6)
    buffer_load_dwordx4 v247, s[16:19], s43 offen offset:1056 nt lds
    v_mfma_f32_16x16x32_bf16 v[16:19], a[232:235], v[100:103], v[16:19]
    ds_read_b64_tr_b16 a[216:217], v3 offset:25632
    v_add_f32 v11, v43, v11
    v_mfma_f32_16x16x32_bf16 v[20:23], a[232:235], v[104:107], v[20:23]
    ds_read_b64_tr_b16 a[218:219], v3 offset:26656
    v_cvt_pk_bf16_f32 v77, v42, v43
    v_mfma_f32_16x16x32_bf16 v[24:27], a[232:235], v[108:111], v[24:27]
    s_waitcnt lgkmcnt(6)
    v_exp_f32 v44, v44
    v_mfma_f32_16x16x32_bf16 a[24:27], a[236:239], a[192:195], a[24:27]
    ds_read_b64_tr_b16 a[220:221], v3 offset:25640
    v_add_f32 v12, v44, v12
    v_mfma_f32_16x16x32_bf16 a[28:31], a[236:239], a[196:199], a[28:31]
    ds_read_b64_tr_b16 a[222:223], v3 offset:26664
    s_add_u32 s43, s43, 8192
    v_mfma_f32_16x16x32_bf16 a[32:35], a[236:239], a[200:203], a[32:35]
    s_add_u32 m0, s47, s78
    s_waitcnt lgkmcnt(6)
    buffer_load_dwordx4 v6, s[20:23], s45 offen nt lds
    v_mfma_f32_16x16x32_bf16 a[36:39], a[240:243], a[192:195], a[36:39]
    ds_read_b128 a[224:227], v1 offset:25632
    s_xor_b32 s47, s47, 50240
    v_mfma_f32_16x16x32_bf16 a[40:43], a[240:243], a[196:199], a[40:43]
    v_exp_f32 v45, v45
    v_mfma_f32_16x16x32_bf16 a[44:47], a[240:243], a[200:203], a[44:47]
    s_waitcnt lgkmcnt(5)
    v_exp_f32 v46, v46
    v_mfma_f32_16x16x32_bf16 v[148:151], a[244:247], v[64:67], 0
    ds_read_b64_tr_b16 a[228:229], v3 offset:25888
    v_exp_f32 v47, v47
    v_mfma_f32_16x16x32_bf16 v[152:155], a[244:247], v[68:71], 0
    ds_read_b64_tr_b16 a[230:231], v3 offset:26912
    v_add_f32 v12, v45, v12
    v_mfma_f32_16x16x32_bf16 v[156:159], a[244:247], v[72:75], 0
    s_waitcnt lgkmcnt(5)
    buffer_load_dwordx4 v7, s[20:23], s45 offen offset:1024 nt lds
    v_mfma_f32_16x16x32_bf16 a[48:51], a[216:219], a[192:195], a[48:51]
    ds_read_b64_tr_b16 a[232:233], v3 offset:25896
    v_cvt_pk_bf16_f32 v80, v44, v45
    v_mfma_f32_16x16x32_bf16 a[52:55], a[216:219], a[196:199], a[52:55]
    ds_read_b64_tr_b16 a[234:235], v3 offset:26920
    v_add_f32 v12, v46, v12
    v_mfma_f32_16x16x32_bf16 a[56:59], a[216:219], a[200:203], a[56:59]
    s_waitcnt lgkmcnt(5)
    v_exp_f32 v48, v48
    v_mfma_f32_16x16x32_bf16 a[60:63], a[220:223], a[192:195], a[60:63]
    ds_read_b64_tr_b16 a[236:237], v2 offset:25376
    v_add_f32 v12, v47, v12
    v_mfma_f32_16x16x32_bf16 a[64:67], a[220:223], a[196:199], a[64:67]
    ds_read_b64_tr_b16 a[238:239], v2 offset:29600
    v_exp_f32 v49, v49
    v_mfma_f32_16x16x32_bf16 a[68:71], a[220:223], a[200:203], a[68:71]
    s_waitcnt lgkmcnt(6)
    v_exp_f32 v50, v50
    v_mfma_f32_16x16x32_bf16 v[16:19], a[224:227], v[112:115], v[16:19]
    ds_read_b64_tr_b16 a[240:241], v2 offset:25408
    v_cvt_pk_bf16_f32 v81, v46, v47
    v_mfma_f32_16x16x32_bf16 v[20:23], a[224:227], v[116:119], v[20:23]
    ds_read_b64_tr_b16 a[242:243], v2 offset:29632
    v_add_f32 v13, v48, v13
    v_mfma_f32_16x16x32_bf16 v[24:27], a[224:227], v[120:123], v[24:27]
    s_add_u32 s45, s45, 262144
    s_mov_b32 m0, s80
    s_waitcnt lgkmcnt(6)
    buffer_load_dwordx4 v8, s[8:11], s44 offen lds
    v_mfma_f32_16x16x32_bf16 a[72:75], a[228:231], a[192:195], a[72:75]
    ds_read_b128 a[244:247], v1 offset:25888
    v_add_f32 v13, v49, v13
    v_mfma_f32_16x16x32_bf16 a[76:79], a[228:231], a[196:199], a[76:79]
    v_exp_f32 v51, v51
    v_mfma_f32_16x16x32_bf16 a[80:83], a[228:231], a[200:203], a[80:83]
    s_waitcnt lgkmcnt(5)
    v_exp_f32 v52, v52
    v_mfma_f32_16x16x32_bf16 a[84:87], a[232:235], a[192:195], a[84:87]
    ds_read_b64_tr_b16 a[216:217], v2 offset:25632
    v_cvt_pk_bf16_f32 v84, v48, v49
    v_mfma_f32_16x16x32_bf16 a[88:91], a[232:235], a[196:199], a[88:91]
    ds_read_b64_tr_b16 a[218:219], v2 offset:29856
    v_add_f32 v13, v50, v13
    v_mfma_f32_16x16x32_bf16 a[92:95], a[232:235], a[200:203], a[92:95]
    s_cmp_ge_u32 s45, 4194304
    s_cselect_b32 s84, 4194048, 0
    s_waitcnt lgkmcnt(5)
    buffer_load_dwordx4 v9, s[8:11], s44 offen offset:1024 lds
    v_mfma_f32_16x16x32_bf16 v[160:163], a[236:239], v[64:67], 0
    ds_read_b64_tr_b16 a[220:221], v2 offset:25664
    v_exp_f32 v53, v53
    v_mfma_f32_16x16x32_bf16 v[164:167], a[236:239], v[68:71], 0
    ds_read_b64_tr_b16 a[222:223], v2 offset:29888
    v_add_f32 v13, v51, v13
    v_mfma_f32_16x16x32_bf16 v[168:171], a[236:239], v[72:75], 0
    s_waitcnt lgkmcnt(5)
    v_exp_f32 v54, v54
    v_mfma_f32_16x16x32_bf16 v[172:175], a[240:243], v[64:67], 0
    ds_read_b64_tr_b16 a[224:225], v2 offset:25888
    v_cvt_pk_bf16_f32 v85, v50, v51
    v_mfma_f32_16x16x32_bf16 v[176:179], a[240:243], v[68:71], 0
    ds_read_b64_tr_b16 a[226:227], v2 offset:30112
    v_add_f32 v11, v52, v11
    v_mfma_f32_16x16x32_bf16 v[180:183], a[240:243], v[72:75], 0
    s_sub_u32 s45, s45, s84
    s_waitcnt lgkmcnt(6)
    buffer_load_dwordx4 v15, s[8:11], s44 offen offset:2048 lds
    v_mfma_f32_16x16x32_bf16 v[16:19], a[244:247], v[124:127], v[16:19]
    ds_read_b64_tr_b16 a[228:229], v2 offset:25920
    v_add_f32 v11, v53, v11
    v_mfma_f32_16x16x32_bf16 v[20:23], a[244:247], v[128:131], v[20:23]
    ds_read_b64_tr_b16 a[230:231], v2 offset:30144
    v_cvt_pk_bf16_f32 v78, v52, v53
    v_mfma_f32_16x16x32_bf16 v[24:27], a[244:247], v[132:135], v[24:27]
    s_waitcnt lgkmcnt(6)
    v_exp_f32 v55, v55
    v_mfma_f32_16x16x32_bf16 v[184:187], a[216:219], v[64:67], 0
    ds_read_b128 a[232:235], v1 offset:29344
    v_add_f32 v11, v54, v11
    v_mfma_f32_16x16x32_bf16 v[188:191], a[216:219], v[68:71], 0
    v_exp_f32 v56, v56
    v_mfma_f32_16x16x32_bf16 v[192:195], a[216:219], v[72:75], 0
    s_waitcnt lgkmcnt(5)
    v_exp_f32 v57, v57
    v_mfma_f32_16x16x32_bf16 v[196:199], a[220:223], v[64:67], 0
    ds_read_b128 a[236:239], v1 offset:29600
    v_add_f32 v11, v55, v11
    v_mfma_f32_16x16x32_bf16 v[200:203], a[220:223], v[68:71], 0
    v_exp_f32 v58, v58
    v_mfma_f32_16x16x32_bf16 v[204:207], a[220:223], v[72:75], 0
    s_waitcnt lgkmcnt(4)
    v_exp_f32 v59, v59
    v_mfma_f32_16x16x32_bf16 v[208:211], a[224:227], v[64:67], 0
    ds_read_b128 a[240:243], v1 offset:29856
    v_cvt_pk_bf16_f32 v79, v54, v55
    v_mfma_f32_16x16x32_bf16 v[212:215], a[224:227], v[68:71], 0
    v_exp_f32 v60, v60
    v_mfma_f32_16x16x32_bf16 v[216:219], a[224:227], v[72:75], 0
    s_waitcnt lgkmcnt(3)
    v_exp_f32 v61, v61
    v_mfma_f32_16x16x32_bf16 v[220:223], a[228:231], v[64:67], 0
    ds_read_b128 a[244:247], v1 offset:30112
    v_add_f32 v12, v56, v12
    v_mfma_f32_16x16x32_bf16 v[224:227], a[228:231], v[68:71], 0
    v_exp_f32 v62, v62
    v_mfma_f32_16x16x32_bf16 v[228:231], a[228:231], v[72:75], 0
    s_waitcnt lgkmcnt(3)
    v_exp_f32 v63, v63
    v_add_f32 v12, v57, v12
    v_cvt_pk_bf16_f32 v82, v56, v57
    v_add_f32 v12, v58, v12
    v_add_u32 v1, s83, v1
    v_add_u32 v2, s83, v2
    v_add_u32 v3, s83, v3
    s_sub_u32 s83, 0, s83
    s_mov_b32 s90, 6
    s_branch L_B
L_A12:
    v_mfma_f32_16x16x32_bf16 v[28:31], a[236:239], v[112:115], v[28:31]
    s_waitcnt vmcnt(15)
    s_barrier
    s_waitcnt lgkmcnt(0)
    v_mfma_f32_16x16x32_bf16 v[32:35], a[236:239], v[116:119], v[32:35]
    ds_read_b64_tr_b16 a[216:217], v2 offset:0
    v_accvgpr_mov_b32 a96, a144
    v_accvgpr_mov_b32 a97, a145
    v_accvgpr_mov_b32 a98, a146
    v_accvgpr_mov_b32 a99, a147
    v_accvgpr_mov_b32 a100, a148
    v_accvgpr_mov_b32 a101, a149
    v_accvgpr_mov_b32 a102, a150
    v_accvgpr_mov_b32 a103, a151
    v_mfma_f32_16x16x32_bf16 v[36:39], a[236:239], v[120:123], v[36:39]
    ds_read_b64_tr_b16 a[218:219], v2 offset:4224
    v_accvgpr_mov_b32 a104, a152
    v_accvgpr_mov_b32 a105, a153
    v_accvgpr_mov_b32 a106, a154
    v_accvgpr_mov_b32 a107, a155
    v_mfma_f32_16x16x32_bf16 v[16:19], a[240:243], v[124:127], v[16:19]
    ds_read_b128 a[192:195], v4 offset:0
    v_accvgpr_mov_b32 a108, a156
    v_accvgpr_mov_b32 a109, a157
    v_accvgpr_mov_b32 a110, a158
    v_accvgpr_mov_b32 a111, a159
    v_accvgpr_mov_b32 a112, a160
    v_mfma_f32_16x16x32_bf16 v[20:23], a[240:243], v[128:131], v[20:23]
    ds_read_b64_tr_b16 a[220:221], v2 offset:32
    v_accvgpr_mov_b32 a113, a161
    v_accvgpr_mov_b32 a114, a162
    v_accvgpr_mov_b32 a115, a163
    v_accvgpr_mov_b32 a116, a164
    v_mfma_f32_16x16x32_bf16 v[24:27], a[240:243], v[132:135], v[24:27]
    ds_read_b64_tr_b16 a[222:223], v2 offset:4256
    v_accvgpr_mov_b32 a117, a165
    v_accvgpr_mov_b32 a118, a166
    v_accvgpr_mov_b32 a119, a167
    v_accvgpr_mov_b32 a120, a168
    v_accvgpr_mov_b32 a121, a169
    v_mfma_f32_16x16x32_bf16 v[28:31], a[244:247], v[124:127], v[28:31]
    ds_read_b128 a[196:199], v4 offset:2048
    v_accvgpr_mov_b32 a122, a170
    v_exp_f32 v16, v16
    v_exp_f32 v17, v17
    v_mfma_f32_16x16x32_bf16 v[32:35], a[244:247], v[128:131], v[32:35]
    ds_read_b64_tr_b16 a[224:225], v2 offset:256
    v_mov_b32 v11, v16
    v_exp_f32 v18, v18
    v_exp_f32 v19, v19
    v_mfma_f32_16x16x32_bf16 v[36:39], a[244:247], v[132:135], v[36:39]
    ds_read_b64_tr_b16 a[226:227], v2 offset:4480
    v_add_f32 v11, v17, v11
    v_exp_f32 v20, v20
    v_exp_f32 v21, v21
    s_waitcnt lgkmcnt(6)
    v_mfma_f32_16x16x32_bf16 v[136:139], a[216:219], v[76:79], v[136:139]
    ds_read_b128 a[200:203], v4 offset:4096
    v_cvt_pk_bf16_f32 v64, v16, v17
    v_exp_f32 v22, v22
    v_mfma_f32_16x16x32_bf16 v[140:143], a[216:219], v[80:83], v[140:143]
    ds_read_b64_tr_b16 a[228:229], v2 offset:288
    v_accvgpr_mov_b32 a123, a171
    v_accvgpr_mov_b32 a124, a172
    v_accvgpr_mov_b32 a125, a173
    v_add_f32 v11, v18, v11
    v_accvgpr_mov_b32 a126, a174
    v_mfma_f32_16x16x32_bf16 v[144:147], a[216:219], v[84:87], v[144:147]
    ds_read_b64_tr_b16 a[230:231], v2 offset:4512
    v_accvgpr_mov_b32 a127, a175
    v_accvgpr_mov_b32 a128, a176
    v_exp_f32 v23, v23
    s_waitcnt lgkmcnt(6)
    v_mfma_f32_16x16x32_bf16 v[148:151], a[220:223], v[76:79], v[148:151]
    ds_read_b64_tr_b16 a[232:233], v3 offset:0
    v_accvgpr_mov_b32 a129, a177
    v_accvgpr_mov_b32 a130, a178
    v_accvgpr_mov_b32 a131, a179
    v_add_f32 v11, v19, v11
    v_accvgpr_mov_b32 a132, a180
    v_mfma_f32_16x16x32_bf16 v[152:155], a[220:223], v[80:83], v[152:155]
    ds_read_b64_tr_b16 a[234:235], v3 offset:1024
    v_accvgpr_mov_b32 a133, a181
    v_accvgpr_mov_b32 a134, a182
    v_cvt_pk_bf16_f32 v65, v18, v19
    v_accvgpr_mov_b32 a135, a183
    v_accvgpr_mov_b32 a136, a184
    v_mfma_f32_16x16x32_bf16 v[156:159], a[220:223], v[84:87], v[156:159]
    ds_read_b64_tr_b16 a[236:237], v2 offset:512
    v_accvgpr_mov_b32 a137, a185
    v_exp_f32 v24, v24
    v_accvgpr_mov_b32 a138, a186
    s_waitcnt lgkmcnt(6)
    v_mfma_f32_16x16x32_bf16 v[160:163], a[224:227], v[76:79], v[160:163]
    ds_read_b64_tr_b16 a[238:239], v2 offset:4736
    v_accvgpr_mov_b32 a139, a187
    v_accvgpr_mov_b32 a140, a188
    v_mov_b32 v12, v20
    v_accvgpr_mov_b32 a141, a189
    v_accvgpr_mov_b32 a142, a190
    v_mfma_f32_16x16x32_bf16 v[164:167], a[224:227], v[80:83], v[164:167]
    ds_read_b64_tr_b16 a[240:241], v2 offset:544
    v_accvgpr_mov_b32 a143, a191
    v_exp_f32 v25, v25
    v_mul_f32 v232, v136, v248
    v_mfma_f32_16x16x32_bf16 v[168:171], a[224:227], v[84:87], v[168:171]
    ds_read_b64_tr_b16 a[242:243], v2 offset:4768
    v_mul_f32 v233, v137, v248
    v_mul_f32 v234, v138, v248
    v_add_f32 v12, v21, v12
    v_mul_f32 v235, v139, v248
    v_cvt_pk_bf16_f32 v236, v232, v233
    s_waitcnt lgkmcnt(6)
    v_mfma_f32_16x16x32_bf16 v[172:175], a[228:231], v[76:79], v[172:175]
    ds_read_b64_tr_b16 a[244:245], v3 offset:8
    v_cvt_pk_bf16_f32 v237, v234, v235
    v_exp_f32 v26, v26
    v_accvgpr_write_b32 a144, v236
    v_accvgpr_write_b32 a145, v237
    v_mfma_f32_16x16x32_bf16 v[176:179], a[228:231], v[80:83], v[176:179]
    ds_read_b64_tr_b16 a[246:247], v3 offset:1032
    v_mul_f32 v238, v140, v249
    v_cvt_pk_bf16_f32 v68, v20, v21
    v_mul_f32 v239, v141, v249
    v_mul_f32 v240, v142, v249
    v_mfma_f32_16x16x32_bf16 v[180:183], a[228:231], v[84:87], v[180:183]
    s_add_u32 m0, s80, 3072
    s_waitcnt lgkmcnt(6)
    buffer_load_dwordx4 v244, s[8:11], s44 offen lds
    v_mul_f32 v241, v143, v249
    v_add_f32 v12, v22, v12
    v_cvt_pk_bf16_f32 v242, v238, v239
    v_cvt_pk_bf16_f32 v243, v240, v241
    v_accvgpr_write_b32 a148, v242
    v_mfma_f32_16x16x32_bf16 a[0:3], a[232:235], a[192:195], 0
    ds_read_b64_tr_b16 a[216:217], v2 offset:768
    v_accvgpr_write_b32 a149, v243
    v_exp_f32 v27, v27
    v_mul_f32 v232, v144, v250
    v_mfma_f32_16x16x32_bf16 a[4:7], a[232:235], a[196:199], 0
    ds_read_b64_tr_b16 a[218:219], v2 offset:4992
    v_mul_f32 v233, v145, v250
    v_add_f32 v12, v23, v12
    v_mul_f32 v234, v146, v250
    v_mul_f32 v235, v147, v250
    v_cvt_pk_bf16_f32 v236, v232, v233
    v_mfma_f32_16x16x32_bf16 a[8:11], a[232:235], a[200:203], 0
    s_xor_b32 s80, s80, s81
    s_waitcnt lgkmcnt(6)
    buffer_load_dwordx4 v245, s[8:11], s44 offen offset:1024 lds
    v_cvt_pk_bf16_f32 v69, v22, v23
    v_cvt_pk_bf16_f32 v237, v234, v235
    v_accvgpr_write_b32 a152, v236
    v_accvgpr_write_b32 a153, v237
    v_mfma_f32_16x16x32_bf16 v[184:187], a[236:239], v[76:79], v[184:187]
    ds_read_b64_tr_b16 a[220:221], v2 offset:800
    v_mul_f32 v238, v148, v248
    v_exp_f32 v28, v28
    v_mul_f32 v239, v149, v248
    v_mul_f32 v240, v150, v248
    v_mfma_f32_16x16x32_bf16 v[188:191], a[236:239], v[80:83], v[188:191]
    ds_read_b64_tr_b16 a[222:223], v2 offset:5024
    v_mov_b32 v13, v24
    v_mul_f32 v241, v151, v248
    v_cvt_pk_bf16_f32 v242, v238, v239
    v_cvt_pk_bf16_f32 v243, v240, v241
    v_exp_f32 v29, v29
    v_mfma_f32_16x16x32_bf16 v[192:195], a[236:239], v[84:87], v[192:195]
    s_waitcnt lgkmcnt(6)
    buffer_load_dwordx4 v246, s[8:11], s44 offen offset:2048 lds
    v_accvgpr_write_b32 a146, v242
    v_accvgpr_write_b32 a147, v243
    v_mul_f32 v232, v152, v249
    v_mfma_f32_16x16x32_bf16 v[196:199], a[240:243], v[76:79], v[196:199]
    ds_read_b64_tr_b16 a[224:225], v3 offset:256
    v_add_f32 v13, v25, v13
    v_mul_f32 v233, v153, v249
    v_mul_f32 v234, v154, v249
    v_mul_f32 v235, v155, v249
    v_exp_f32 v30, v30
    v_mfma_f32_16x16x32_bf16 v[200:203], a[240:243], v[80:83], v[200:203]
    ds_read_b64_tr_b16 a[226:227], v3 offset:1280
    v_cvt_pk_bf16_f32 v236, v232, v233
    v_cvt_pk_bf16_f32 v237, v234, v235
    v_accvgpr_write_b32 a150, v236
    v_mfma_f32_16x16x32_bf16 v[204:207], a[240:243], v[84:87], v[204:207]
    s_add_u32 s44, s44, 128
    s_add_u32 m0, s46, s74
    s_waitcnt lgkmcnt(6)
    buffer_load_dwordx4 v5, s[12:15], s43 offen nt lds
    v_cvt_pk_bf16_f32 v72, v24, v25
    v_accvgpr_write_b32 a151, v237
    v_mul_f32 v238, v156, v250
    v_mul_f32 v239, v157, v250
    v_add_f32 v13, v26, v13
    v_mfma_f32_16x16x32_bf16 a[12:15], a[244:247], a[192:195], 0
    ds_read_b64_tr_b16 a[228:229], v3 offset:264
    v_mul_f32 v240, v158, v250
    v_mul_f32 v241, v159, v250
    v_cvt_pk_bf16_f32 v242, v238, v239
    v_exp_f32 v31, v31
    v_mfma_f32_16x16x32_bf16 a[16:19], a[244:247], a[196:199], 0
    ds_read_b64_tr_b16 a[230:231], v3 offset:1288
    v_cvt_pk_bf16_f32 v243, v240, v241
    v_accvgpr_write_b32 a154, v242
    v_accvgpr_write_b32 a155, v243
    v_add_f32 v13, v27, v13
    v_mfma_f32_16x16x32_bf16 a[20:23], a[244:247], a[200:203], 0
    s_and_b32 s44, s44, 1023
    s_waitcnt lgkmcnt(6)
    buffer_load_dwordx4 v247, s[12:15], s43 offen offset:1056 nt lds
    v_mul_f32 v232, v160, v248
    v_mul_f32 v233, v161, v248
    v_mul_f32 v234, v162, v248
    v_cvt_pk_bf16_f32 v73, v26, v27
    v_mul_f32 v235, v163, v248
    v_mfma_f32_16x16x32_bf16 v[208:211], a[216:219], v[76:79], v[208:211]
    ds_read_b128 a[232:235], v1 offset:0
    v_cvt_pk_bf16_f32 v236, v232, v233
    v_cvt_pk_bf16_f32 v237, v234, v235
    v_exp_f32 v32, v32
    v_mfma_f32_16x16x32_bf16 v[212:215], a[216:219], v[80:83], v[212:215]
    s_add_u32 m0, s46, s76
    s_nop 0
    buffer_load_dwordx4 v5, s[16:19], s43 offen nt lds
    v_accvgpr_write_b32 a156, v236
    v_accvgpr_write_b32 a157, v237
    v_mul_f32 v238, v164, v249
    v_add_f32 v11, v28, v11
    v_mul_f32 v239, v165, v249
    v_mfma_f32_16x16x32_bf16 v[216:219], a[216:219], v[84:87], v[216:219]
    s_waitcnt lgkmcnt(5)
    v_exp_f32 v33, v33
    v_mul_f32 v240, v166, v249
    v_mul_f32 v241, v167, v249
    v_mfma_f32_16x16x32_bf16 v[220:223], a[220:223], v[76:79], v[220:223]
    ds_read_b64_tr_b16 a[236:237], v3 offset:512
    v_cvt_pk_bf16_f32 v242, v238, v239
    v_cvt_pk_bf16_f32 v243, v240, v241
    v_accvgpr_write_b32 a160, v242
    v_add_f32 v11, v29, v11
    v_accvgpr_write_b32 a161, v243
    v_mfma_f32_16x16x32_bf16 v[224:227], a[220:223], v[80:83], v[224:227]
    ds_read_b64_tr_b16 a[238:239], v3 offset:1536
    v_mul_f32 v232, v168, v250
    v_mul_f32 v233, v169, v250
    v_exp_f32 v34, v34
    v_mul_f32 v234, v170, v250
    v_mfma_f32_16x16x32_bf16 v[228:231], a[220:223], v[84:87], v[228:231]
    s_waitcnt lgkmcnt(5)
    v_exp_f32 v35, v35
    v_mul_f32 v235, v171, v250
    v_cvt_pk_bf16_f32 v236, v232, v233
    v_mfma_f32_16x16x32_bf16 a[24:27], a[224:227], a[192:195], 0
    ds_read_b64_tr_b16 a[240:241], v3 offset:520
    v_cvt_pk_bf16_f32 v66, v28, v29
    v_cvt_pk_bf16_f32 v237, v234, v235
    v_accvgpr_write_b32 a164, v236
    v_accvgpr_write_b32 a165, v237
    v_add_f32 v11, v30, v11
    v_mfma_f32_16x16x32_bf16 a[28:31], a[224:227], a[196:199], 0
    ds_read_b64_tr_b16 a[242:243], v3 offset:1544
    v_mul_f32 v238, v172, v248
    v_mul_f32 v239, v173, v248
    v_mul_f32 v240, v174, v248
    v_mul_f32 v241, v175, v248
    v_mfma_f32_16x16x32_bf16 a[32:35], a[224:227], a[200:203], 0
    s_waitcnt lgkmcnt(5)
    buffer_load_dwordx4 v247, s[16:19], s43 offen offset:1056 nt lds
    v_cvt_pk_bf16_f32 v242, v238, v239
    v_cvt_pk_bf16_f32 v243, v240, v241
    v_add_f32 v11, v31, v11
    v_accvgpr_write_b32 a158, v242
    v_accvgpr_write_b32 a159, v243
    v_mfma_f32_16x16x32_bf16 a[36:39], a[228:231], a[192:195], 0
    ds_read_b128 a[244:247], v1 offset:256
    v_mul_f32 v232, v176, v249
    v_cvt_pk_bf16_f32 v67, v30, v31
    v_mul_f32 v233, v177, v249
    v_mul_f32 v234, v178, v249
    v_mfma_f32_16x16x32_bf16 a[40:43], a[228:231], a[196:199], 0
    v_exp_f32 v36, v36
    v_mul_f32 v235, v179, v249
    v_cvt_pk_bf16_f32 v236, v232, v233
    v_cvt_pk_bf16_f32 v237, v234, v235
    v_mfma_f32_16x16x32_bf16 a[44:47], a[228:231], a[200:203], 0
    s_waitcnt lgkmcnt(5)
    v_exp_f32 v37, v37
    v_accvgpr_write_b32 a162, v236
    v_add_f32 v12, v32, v12
    v_accvgpr_write_b32 a163, v237
    v_mfma_f32_16x16x32_bf16 v[40:43], a[232:235], v[88:91], 0
    ds_read_b64_tr_b16 a[216:217], v3 offset:768
    v_mul_f32 v238, v180, v250
    v_mul_f32 v239, v181, v250
    v_mul_f32 v240, v182, v250
    v_mul_f32 v241, v183, v250
    v_mfma_f32_16x16x32_bf16 v[44:47], a[232:235], v[92:95], 0
    ds_read_b64_tr_b16 a[218:219], v3 offset:1792
    v_cvt_pk_bf16_f32 v242, v238, v239
    v_add_f32 v12, v33, v12
    v_cvt_pk_bf16_f32 v243, v240, v241
    v_accvgpr_write_b32 a166, v242
    v_accvgpr_write_b32 a167, v243
    v_mfma_f32_16x16x32_bf16 v[48:51], a[232:235], v[96:99], 0
    s_add_u32 s43, s43, 8192
    s_add_u32 m0, s46, s78
    s_waitcnt lgkmcnt(5)
    buffer_load_dwordx4 v6, s[20:23], s45 offen nt lds
    v_exp_f32 v38, v38
    v_mul_f32 v232, v184, v248
    v_mul_f32 v233, v185, v248
    v_mfma_f32_16x16x32_bf16 a[48:51], a[236:239], a[192:195], 0
    ds_read_b64_tr_b16 a[220:221], v3 offset:776
    v_mul_f32 v234, v186, v248
    v_cvt_pk_bf16_f32 v70, v32, v33
    v_mul_f32 v235, v187, v248
    v_cvt_pk_bf16_f32 v236, v232, v233
    v_cvt_pk_bf16_f32 v237, v234, v235
    v_mfma_f32_16x16x32_bf16 a[52:55], a[236:239], a[196:199], 0
    ds_read_b64_tr_b16 a[222:223], v3 offset:1800
    v_add_f32 v12, v34, v12
    v_accvgpr_write_b32 a168, v236
    v_accvgpr_write_b32 a169, v237
    v_mul_f32 v238, v188, v249
    v_mfma_f32_16x16x32_bf16 a[56:59], a[236:239], a[200:203], 0
    s_waitcnt lgkmcnt(5)
    v_exp_f32 v39, v39
    v_mul_f32 v239, v189, v249
    v_mul_f32 v240, v190, v249
    v_mul_f32 v241, v191, v249
    v_mfma_f32_16x16x32_bf16 a[60:63], a[240:243], a[192:195], 0
    ds_read_b128 a[224:227], v1 offset:512
    v_cvt_pk_bf16_f32 v242, v238, v239
    v_cvt_pk_bf16_f32 v243, v240, v241
    v_accvgpr_write_b32 a172, v242
    v_accvgpr_write_b32 a173, v243
    v_mul_f32 v232, v192, v250
    v_mfma_f32_16x16x32_bf16 a[64:67], a[240:243], a[196:199], 0
    v_mul_f32 v233, v193, v250
    v_mul_f32 v234, v194, v250
    v_mul_f32 v235, v195, v250
    v_cvt_pk_bf16_f32 v236, v232, v233
    v_mfma_f32_16x16x32_bf16 a[68:71], a[240:243], a[200:203], 0
    s_xor_b32 s46, s46, 83008
    s_waitcnt lgkmcnt(5)
    buffer_load_dwordx4 v7, s[20:23], s45 offen offset:1024 nt lds
    v_cvt_pk_bf16_f32 v237, v234, v235
    v_accvgpr_write_b32 a176, v236
    v_accvgpr_write_b32 a177, v237
    v_mul_f32 v238, v196, v248
    v_mul_f32 v239, v197, v248
    v_mfma_f32_16x16x32_bf16 v[40:43], a[244:247], v[100:103], v[40:43]
    ds_read_b128 a[228:231], v1 offset:768
    v_mul_f32 v240, v198, v248
    v_mul_f32 v241, v199, v248
    v_cvt_pk_bf16_f32 v242, v238, v239
    v_cvt_pk_bf16_f32 v243, v240, v241
    v_mfma_f32_16x16x32_bf16 v[44:47], a[244:247], v[104:107], v[44:47]
    v_accvgpr_write_b32 a170, v242
    v_accvgpr_write_b32 a171, v243
    v_mul_f32 v232, v200, v249
    v_mul_f32 v233, v201, v249
    v_mul_f32 v234, v202, v249
    v_mfma_f32_16x16x32_bf16 v[48:51], a[244:247], v[108:111], v[48:51]
    s_waitcnt lgkmcnt(4)
    v_mul_f32 v235, v203, v249
    v_cvt_pk_bf16_f32 v236, v232, v233
    v_cvt_pk_bf16_f32 v237, v234, v235
    v_accvgpr_write_b32 a174, v236
    v_accvgpr_write_b32 a175, v237
    v_mfma_f32_16x16x32_bf16 a[72:75], a[216:219], a[192:195], 0
    ds_read_b128 a[232:235], v1 offset:4224
    v_mul_f32 v238, v204, v250
    v_mul_f32 v239, v205, v250
    v_mul_f32 v240, v206, v250
    v_mul_f32 v241, v207, v250
    v_mfma_f32_16x16x32_bf16 a[76:79], a[216:219], a[196:199], 0
    v_cvt_pk_bf16_f32 v242, v238, v239
    v_cvt_pk_bf16_f32 v243, v240, v241
    v_accvgpr_write_b32 a178, v242
    v_accvgpr_write_b32 a179, v243
    v_mul_f32 v232, v208, v248
    v_mfma_f32_16x16x32_bf16 a[80:83], a[216:219], a[200:203], 0
    s_waitcnt lgkmcnt(3)
    v_mul_f32 v233, v209, v248
    v_mul_f32 v234, v210, v248
    v_mul_f32 v235, v211, v248
    v_cvt_pk_bf16_f32 v236, v232, v233
    v_mfma_f32_16x16x32_bf16 a[84:87], a[220:223], a[192:195], 0
    ds_read_b128 a[236:239], v1 offset:4480
    v_cvt_pk_bf16_f32 v237, v234, v235
    v_accvgpr_write_b32 a180, v236
    v_accvgpr_write_b32 a181, v237
    v_mul_f32 v238, v212, v249
    v_mul_f32 v239, v213, v249
    v_mfma_f32_16x16x32_bf16 a[88:91], a[220:223], a[196:199], 0
    v_mul_f32 v240, v214, v249
    v_mul_f32 v241, v215, v249
    v_cvt_pk_bf16_f32 v242, v238, v239
    v_cvt_pk_bf16_f32 v243, v240, v241
    v_mfma_f32_16x16x32_bf16 a[92:95], a[220:223], a[200:203], 0
    s_waitcnt lgkmcnt(3)
    v_accvgpr_write_b32 a184, v242
    v_accvgpr_write_b32 a185, v243
    v_mul_f32 v232, v216, v250
    v_mul_f32 v233, v217, v250
    v_mul_f32 v234, v218, v250
    v_mfma_f32_16x16x32_bf16 v[40:43], a[224:227], v[112:115], v[40:43]
    ds_read_b128 a[240:243], v1 offset:4736
    v_mul_f32 v235, v219, v250
    v_cvt_pk_bf16_f32 v236, v232, v233
    v_cvt_pk_bf16_f32 v237, v234, v235
    v_accvgpr_write_b32 a188, v236
    v_accvgpr_write_b32 a189, v237
    v_mfma_f32_16x16x32_bf16 v[44:47], a[224:227], v[116:119], v[44:47]
    v_mul_f32 v238, v220, v248
    v_mul_f32 v239, v221, v248
    v_mul_f32 v240, v222, v248
    v_mul_f32 v241, v223, v248
    v_mfma_f32_16x16x32_bf16 v[48:51], a[224:227], v[120:123], v[48:51]
    s_waitcnt lgkmcnt(3)
    v_cvt_pk_bf16_f32 v242, v238, v239
    v_cvt_pk_bf16_f32 v243, v240, v241
    v_accvgpr_write_b32 a182, v242
    v_accvgpr_write_b32 a183, v243
    v_mul_f32 v232, v224, v249
    v_mfma_f32_16x16x32_bf16 v[40:43], a[228:231], v[124:127], v[40:43]
    ds_read_b128 a[244:247], v1 offset:4992
    v_mul_f32 v233, v225, v249
    v_mul_f32 v234, v226, v249
    v_mul_f32 v235, v227, v249
    v_cvt_pk_bf16_f32 v236, v232, v233
    v_mfma_f32_16x16x32_bf16 v[44:47], a[228:231], v[128:131], v[44:47]
    v_cvt_pk_bf16_f32 v237, v234, v235
    v_accvgpr_write_b32 a186, v236
    v_accvgpr_write_b32 a187, v237
    v_mul_f32 v238, v228, v250
    v_mul_f32 v239, v229, v250
    v_mfma_f32_16x16x32_bf16 v[48:51], a[228:231], v[132:135], v[48:51]
    s_waitcnt lgkmcnt(3)
    v_mul_f32 v240, v230, v250
    v_mul_f32 v241, v231, v250
    v_cvt_pk_bf16_f32 v242, v238, v239
    v_cvt_pk_bf16_f32 v243, v240, v241
    v_accvgpr_write_b32 a190, v242
    v_accvgpr_write_b32 a191, v243
    s_add_u32 s45, s45, 262144
    s_cmp_ge_u32 s45, 4194304
    s_cselect_b32 s84, 4194048, 0
    s_sub_u32 s45, s45, s84
    v_mfma_f32_16x16x32_bf16 v[52:55], a[232:235], v[88:91], 0
    s_waitcnt vmcnt(18)
    s_barrier
    s_waitcnt lgkmcnt(0)
    v_mfma_f32_16x16x32_bf16 v[56:59], a[232:235], v[92:95], 0
    ds_read_b128 a[216:219], v1 offset:25120
    v_add_f32 v12, v35, v12
    v_mfma_f32_16x16x32_bf16 v[60:63], a[232:235], v[96:99], 0
    ds_read_b128 a[192:195], v10 offset:0
    v_cvt_pk_bf16_f32 v71, v34, v35
    v_mfma_f32_16x16x32_bf16 v[52:55], a[236:239], v[100:103], v[52:55]
    ds_read_b64_tr_b16 a[220:221], v2 offset:25120
    v_add_f32 v13, v36, v13
    v_mfma_f32_16x16x32_bf16 v[56:59], a[236:239], v[104:107], v[56:59]
    ds_read_b64_tr_b16 a[222:223], v2 offset:29344
    v_add_f32 v13, v37, v13
    v_mfma_f32_16x16x32_bf16 v[60:63], a[236:239], v[108:111], v[60:63]
    ds_read_b128 a[196:199], v10 offset:2048
    v_cvt_pk_bf16_f32 v74, v36, v37
    v_mfma_f32_16x16x32_bf16 v[52:55], a[240:243], v[112:115], v[52:55]
    ds_read_b64_tr_b16 a[224:225], v3 offset:25120
    v_add_f32 v13, v38, v13
    v_mfma_f32_16x16x32_bf16 v[56:59], a[240:243], v[116:119], v[56:59]
    ds_read_b64_tr_b16 a[226:227], v3 offset:26144
    v_add_f32 v13, v39, v13
    v_mfma_f32_16x16x32_bf16 v[60:63], a[240:243], v[120:123], v[60:63]
    ds_read_b128 a[200:203], v10 offset:4096
    v_cvt_pk_bf16_f32 v75, v38, v39
    v_mfma_f32_16x16x32_bf16 v[52:55], a[244:247], v[124:127], v[52:55]
    ds_read_b64_tr_b16 a[228:229], v3 offset:25128
    v_add_u32 v4, s99, v4
    v_mfma_f32_16x16x32_bf16 v[56:59], a[244:247], v[128:131], v[56:59]
    ds_read_b64_tr_b16 a[230:231], v3 offset:26152
    v_add_u32 v10, s99, v10
    v_mfma_f32_16x16x32_bf16 v[60:63], a[244:247], v[132:135], v[60:63]
    s_sub_u32 s99, 0, s99
    s_add_u32 m0, s47, s74
    s_waitcnt lgkmcnt(9)
    buffer_load_dwordx4 v5, s[12:15], s43 offen nt lds
    v_mfma_f32_16x16x32_bf16 v[16:19], a[216:219], v[88:91], 0
    ds_read_b128 a[232:235], v1 offset:25376
    v_exp_f32 v40, v40
    v_mfma_f32_16x16x32_bf16 v[20:23], a[216:219], v[92:95], 0
    buffer_load_dwordx4 v247, s[12:15], s43 offen offset:1056 nt lds
    v_mfma_f32_16x16x32_bf16 v[24:27], a[216:219], v[96:99], 0
    s_waitcnt lgkmcnt(7)
    v_exp_f32 v41, v41
    v_mfma_f32_16x16x32_bf16 v[136:139], a[220:223], v[64:67], 0
    ds_read_b64_tr_b16 a[236:237], v3 offset:25376
    v_add_f32 v11, v40, v11
    v_mfma_f32_16x16x32_bf16 v[140:143], a[220:223], v[68:71], 0
    ds_read_b64_tr_b16 a[238:239], v3 offset:26400
    v_add_f32 v11, v41, v11
    v_mfma_f32_16x16x32_bf16 v[144:147], a[220:223], v[72:75], 0
    s_add_u32 m0, s47, s76
    s_waitcnt lgkmcnt(5)
    buffer_load_dwordx4 v5, s[16:19], s43 offen nt lds
    v_mfma_f32_16x16x32_bf16 a[0:3], a[224:227], a[192:195], a[0:3]
    ds_read_b64_tr_b16 a[240:241], v3 offset:25384
    v_cvt_pk_bf16_f32 v76, v40, v41
    v_mfma_f32_16x16x32_bf16 a[4:7], a[224:227], a[196:199], a[4:7]
    ds_read_b64_tr_b16 a[242:243], v3 offset:26408
    v_mfma_f32_16x16x32_bf16 a[8:11], a[224:227], a[200:203], a[8:11]
    s_waitcnt lgkmcnt(5)
    v_exp_f32 v42, v42
    v_mfma_f32_16x16x32_bf16 a[12:15], a[228:231], a[192:195], a[12:15]
    ds_read_b64_tr_b16 a[244:245], v2 offset:25152
    v_add_f32 v11, v42, v11
    v_mfma_f32_16x16x32_bf16 a[16:19], a[228:231], a[196:199], a[16:19]
    ds_read_b64_tr_b16 a[246:247], v2 offset:29376
    v_exp_f32 v43, v43
    v_mfma_f32_16x16x32_bf16 a[20:23], a[228:231], a[200:203], a[20:23]
    s_waitcnt lgkmcnt(6)
    buffer_load_dwordx4 v247, s[16:19], s43 offen offset:1056 nt lds
    v_mfma_f32_16x16x32_bf16 v[16:19], a[232:235], v[100:103], v[16:19]
    ds_read_b64_tr_b16 a[216:217], v3 offset:25632
    v_add_f32 v11, v43, v11
    v_mfma_f32_16x16x32_bf16 v[20:23], a[232:235], v[104:107], v[20:23]
    ds_read_b64_tr_b16 a[218:219], v3 offset:26656
    v_cvt_pk_bf16_f32 v77, v42, v43
    v_mfma_f32_16x16x32_bf16 v[24:27], a[232:235], v[108:111], v[24:27]
    s_waitcnt lgkmcnt(6)
    v_exp_f32 v44, v44
    v_mfma_f32_16x16x32_bf16 a[24:27], a[236:239], a[192:195], a[24:27]
    ds_read_b64_tr_b16 a[220:221], v3 offset:25640
    v_add_f32 v12, v44, v12
    v_mfma_f32_16x16x32_bf16 a[28:31], a[236:239], a[196:199], a[28:31]
    ds_read_b64_tr_b16 a[222:223], v3 offset:26664
    s_add_u32 s43, s43, 8192
    v_mfma_f32_16x16x32_bf16 a[32:35], a[236:239], a[200:203], a[32:35]
    s_add_u32 m0, s47, s78
    s_waitcnt lgkmcnt(6)
    buffer_load_dwordx4 v6, s[20:23], s45 offen nt lds
    v_mfma_f32_16x16x32_bf16 a[36:39], a[240:243], a[192:195], a[36:39]
    ds_read_b128 a[224:227], v1 offset:25632
    s_xor_b32 s47, s47, 50240
    v_mfma_f32_16x16x32_bf16 a[40:43], a[240:243], a[196:199], a[40:43]
    v_exp_f32 v45, v45
    v_mfma_f32_16x16x32_bf16 a[44:47], a[240:243], a[200:203], a[44:47]
    s_waitcnt lgkmcnt(5)
    v_exp_f32 v46, v46
    v_mfma_f32_16x16x32_bf16 v[148:151], a[244:247], v[64:67], 0
    ds_read_b64_tr_b16 a[228:229], v3 offset:25888
    v_exp_f32 v47, v47
    v_mfma_f32_16x16x32_bf16 v[152:155], a[244:247], v[68:71], 0
    ds_read_b64_tr_b16 a[230:231], v3 offset:26912
    v_add_f32 v12, v45, v12
    v_mfma_f32_16x16x32_bf16 v[156:159], a[244:247], v[72:75], 0
    s_waitcnt lgkmcnt(5)
    buffer_load_dwordx4 v7, s[20:23], s45 offen offset:1024 nt lds
    v_mfma_f32_16x16x32_bf16 a[48:51], a[216:219], a[192:195], a[48:51]
    ds_read_b64_tr_b16 a[232:233], v3 offset:25896
    v_cvt_pk_bf16_f32 v80, v44, v45
    v_mfma_f32_16x16x32_bf16 a[52:55], a[216:219], a[196:199], a[52:55]
    ds_read_b64_tr_b16 a[234:235], v3 offset:26920
    v_add_f32 v12, v46, v12
    v_mfma_f32_16x16x32_bf16 a[56:59], a[216:219], a[200:203], a[56:59]
    s_waitcnt lgkmcnt(5)
    v_exp_f32 v48, v48
    v_mfma_f32_16x16x32_bf16 a[60:63], a[220:223], a[192:195], a[60:63]
    ds_read_b64_tr_b16 a[236:237], v2 offset:25376
    v_add_f32 v12, v47, v12
    v_mfma_f32_16x16x32_bf16 a[64:67], a[220:223], a[196:199], a[64:67]
    ds_read_b64_tr_b16 a[238:239], v2 offset:29600
    v_exp_f32 v49, v49
    v_mfma_f32_16x16x32_bf16 a[68:71], a[220:223], a[200:203], a[68:71]
    s_waitcnt lgkmcnt(6)
    v_exp_f32 v50, v50
    v_mfma_f32_16x16x32_bf16 v[16:19], a[224:227], v[112:115], v[16:19]
    ds_read_b64_tr_b16 a[240:241], v2 offset:25408
    v_cvt_pk_bf16_f32 v81, v46, v47
    v_mfma_f32_16x16x32_bf16 v[20:23], a[224:227], v[116:119], v[20:23]
    ds_read_b64_tr_b16 a[242:243], v2 offset:29632
    v_add_f32 v13, v48, v13
    v_mfma_f32_16x16x32_bf16 v[24:27], a[224:227], v[120:123], v[24:27]
    s_add_u32 s45, s45, 262144
    s_mov_b32 m0, s80
    s_waitcnt lgkmcnt(6)
    buffer_load_dwordx4 v8, s[8:11], s44 offen lds
    v_mfma_f32_16x16x32_bf16 a[72:75], a[228:231], a[192:195], a[72:75]
    ds_read_b128 a[244:247], v1 offset:25888
    v_add_f32 v13, v49, v13
    v_mfma_f32_16x16x32_bf16 a[76:79], a[228:231], a[196:199], a[76:79]
    v_exp_f32 v51, v51
    v_mfma_f32_16x16x32_bf16 a[80:83], a[228:231], a[200:203], a[80:83]
    s_waitcnt lgkmcnt(5)
    v_exp_f32 v52, v52
    v_mfma_f32_16x16x32_bf16 a[84:87], a[232:235], a[192:195], a[84:87]
    ds_read_b64_tr_b16 a[216:217], v2 offset:25632
    v_cvt_pk_bf16_f32 v84, v48, v49
    v_mfma_f32_16x16x32_bf16 a[88:91], a[232:235], a[196:199], a[88:91]
    ds_read_b64_tr_b16 a[218:219], v2 offset:29856
    v_add_f32 v13, v50, v13
    v_mfma_f32_16x16x32_bf16 a[92:95], a[232:235], a[200:203], a[92:95]
    s_cmp_ge_u32 s45, 4194304
    s_cselect_b32 s84, 4194048, 0
    s_waitcnt lgkmcnt(5)
    buffer_load_dwordx4 v9, s[8:11], s44 offen offset:1024 lds
    v_mfma_f32_16x16x32_bf16 v[160:163], a[236:239], v[64:67], 0
    ds_read_b64_tr_b16 a[220:221], v2 offset:25664
    v_exp_f32 v53, v53
    v_mfma_f32_16x16x32_bf16 v[164:167], a[236:239], v[68:71], 0
    ds_read_b64_tr_b16 a[222:223], v2 offset:29888
    v_add_f32 v13, v51, v13
    v_mfma_f32_16x16x32_bf16 v[168:171], a[236:239], v[72:75], 0
    s_waitcnt lgkmcnt(5)
    v_exp_f32 v54, v54
    v_mfma_f32_16x16x32_bf16 v[172:175], a[240:243], v[64:67], 0
    ds_read_b64_tr_b16 a[224:225], v2 offset:25888
    v_cvt_pk_bf16_f32 v85, v50, v51
    v_mfma_f32_16x16x32_bf16 v[176:179], a[240:243], v[68:71], 0
    ds_read_b64_tr_b16 a[226:227], v2 offset:30112
    v_add_f32 v11, v52, v11
    v_mfma_f32_16x16x32_bf16 v[180:183], a[240:243], v[72:75], 0
    s_sub_u32 s45, s45, s84
    s_waitcnt lgkmcnt(6)
    buffer_load_dwordx4 v15, s[8:11], s44 offen offset:2048 lds
    v_mfma_f32_16x16x32_bf16 v[16:19], a[244:247], v[124:127], v[16:19]
    ds_read_b64_tr_b16 a[228:229], v2 offset:25920
    v_add_f32 v11, v53, v11
    v_mfma_f32_16x16x32_bf16 v[20:23], a[244:247], v[128:131], v[20:23]
    ds_read_b64_tr_b16 a[230:231], v2 offset:30144
    v_cvt_pk_bf16_f32 v78, v52, v53
    v_mfma_f32_16x16x32_bf16 v[24:27], a[244:247], v[132:135], v[24:27]
    s_waitcnt lgkmcnt(6)
    v_exp_f32 v55, v55
    v_mfma_f32_16x16x32_bf16 v[184:187], a[216:219], v[64:67], 0
    ds_read_b128 a[232:235], v1 offset:29344
    v_add_f32 v11, v54, v11
    v_mfma_f32_16x16x32_bf16 v[188:191], a[216:219], v[68:71], 0
    v_exp_f32 v56, v56
    v_mfma_f32_16x16x32_bf16 v[192:195], a[216:219], v[72:75], 0
    s_waitcnt lgkmcnt(5)
    v_exp_f32 v57, v57
    v_mfma_f32_16x16x32_bf16 v[196:199], a[220:223], v[64:67], 0
    ds_read_b128 a[236:239], v1 offset:29600
    v_add_f32 v11, v55, v11
    v_mfma_f32_16x16x32_bf16 v[200:203], a[220:223], v[68:71], 0
    v_exp_f32 v58, v58
    v_mfma_f32_16x16x32_bf16 v[204:207], a[220:223], v[72:75], 0
    s_waitcnt lgkmcnt(4)
    v_exp_f32 v59, v59
    v_mfma_f32_16x16x32_bf16 v[208:211], a[224:227], v[64:67], 0
    ds_read_b128 a[240:243], v1 offset:29856
    v_cvt_pk_bf16_f32 v79, v54, v55
    v_mfma_f32_16x16x32_bf16 v[212:215], a[224:227], v[68:71], 0
    v_exp_f32 v60, v60
    v_mfma_f32_16x16x32_bf16 v[216:219], a[224:227], v[72:75], 0
    s_waitcnt lgkmcnt(3)
    v_exp_f32 v61, v61
    v_mfma_f32_16x16x32_bf16 v[220:223], a[228:231], v[64:67], 0
    ds_read_b128 a[244:247], v1 offset:30112
    v_add_f32 v12, v56, v12
    v_mfma_f32_16x16x32_bf16 v[224:227], a[228:231], v[68:71], 0
    v_exp_f32 v62, v62
    v_mfma_f32_16x16x32_bf16 v[228:231], a[228:231], v[72:75], 0
    s_waitcnt lgkmcnt(3)
    v_exp_f32 v63, v63
    v_add_f32 v12, v57, v12
    v_cvt_pk_bf16_f32 v82, v56, v57
    v_add_f32 v12, v58, v12
    v_add_u32 v1, s83, v1
    v_add_u32 v2, s83, v2
    v_add_u32 v3, s83, v3
    s_sub_u32 s83, 0, s83
    s_mov_b32 s90, 6
L_B:
    v_mfma_f32_16x16x32_bf16 v[28:31], a[232:235], v[88:91], 0
    s_waitcnt vmcnt(15)
    s_barrier
    s_waitcnt lgkmcnt(0)
    v_mfma_f32_16x16x32_bf16 v[32:35], a[232:235], v[92:95], 0
    ds_read_b128 a[216:219], v1 offset:0
    v_add_f32 v12, v59, v12
    v_mfma_f32_16x16x32_bf16 v[36:39], a[232:235], v[96:99], 0
    ds_read_b128 a[192:195], v4 offset:0
    v_cvt_pk_bf16_f32 v83, v58, v59
    v_mfma_f32_16x16x32_bf16 v[28:31], a[236:239], v[100:103], v[28:31]
    ds_read_b64_tr_b16 a[220:221], v2 offset:0
    v_add_f32 v13, v60, v13
    v_mfma_f32_16x16x32_bf16 v[32:35], a[236:239], v[104:107], v[32:35]
    ds_read_b64_tr_b16 a[222:223], v2 offset:4224
    v_add_f32 v13, v61, v13
    v_mfma_f32_16x16x32_bf16 v[36:39], a[236:239], v[108:111], v[36:39]
    ds_read_b128 a[196:199], v4 offset:2048
    v_cvt_pk_bf16_f32 v86, v60, v61
    v_mfma_f32_16x16x32_bf16 v[28:31], a[240:243], v[112:115], v[28:31]
    ds_read_b64_tr_b16 a[224:225], v3 offset:0
    v_add_f32 v13, v62, v13
    v_mfma_f32_16x16x32_bf16 v[32:35], a[240:243], v[116:119], v[32:35]
    ds_read_b64_tr_b16 a[226:227], v3 offset:1024
    v_add_f32 v13, v63, v13
    v_mfma_f32_16x16x32_bf16 v[36:39], a[240:243], v[120:123], v[36:39]
    ds_read_b128 a[200:203], v4 offset:4096
    v_cvt_pk_bf16_f32 v87, v62, v63
    v_mfma_f32_16x16x32_bf16 v[28:31], a[244:247], v[124:127], v[28:31]
    ds_read_b64_tr_b16 a[228:229], v3 offset:8
    v_mfma_f32_16x16x32_bf16 v[32:35], a[244:247], v[128:131], v[32:35]
    ds_read_b64_tr_b16 a[230:231], v3 offset:1032
    v_mfma_f32_16x16x32_bf16 v[36:39], a[244:247], v[132:135], v[36:39]
    s_add_u32 m0, s80, 3072
    s_waitcnt lgkmcnt(9)
    buffer_load_dwordx4 v244, s[8:11], s44 offen lds
    v_mfma_f32_16x16x32_bf16 v[40:43], a[216:219], v[88:91], 0
    ds_read_b128 a[232:235], v1 offset:256
    v_exp_f32 v16, v16
    v_mfma_f32_16x16x32_bf16 v[44:47], a[216:219], v[92:95], 0
    s_xor_b32 s80, s80, s81
    buffer_load_dwordx4 v245, s[8:11], s44 offen offset:1024 lds
    v_mfma_f32_16x16x32_bf16 v[48:51], a[216:219], v[96:99], 0
    s_waitcnt lgkmcnt(7)
    v_exp_f32 v17, v17
    v_mfma_f32_16x16x32_bf16 v[136:139], a[220:223], v[76:79], v[136:139]
    ds_read_b64_tr_b16 a[236:237], v3 offset:256
    v_add_f32 v11, v16, v11
    v_mfma_f32_16x16x32_bf16 v[140:143], a[220:223], v[80:83], v[140:143]
    ds_read_b64_tr_b16 a[238:239], v3 offset:1280
    v_add_f32 v11, v17, v11
    v_mfma_f32_16x16x32_bf16 v[144:147], a[220:223], v[84:87], v[144:147]
    s_waitcnt lgkmcnt(5)
    buffer_load_dwordx4 v246, s[8:11], s44 offen offset:2048 lds
    v_mfma_f32_16x16x32_bf16 a[0:3], a[224:227], a[192:195], a[0:3]
    ds_read_b64_tr_b16 a[240:241], v3 offset:264
    v_cvt_pk_bf16_f32 v64, v16, v17
    v_mfma_f32_16x16x32_bf16 a[4:7], a[224:227], a[196:199], a[4:7]
    ds_read_b64_tr_b16 a[242:243], v3 offset:1288
    s_add_u32 s44, s44, 128
    v_mfma_f32_16x16x32_bf16 a[8:11], a[224:227], a[200:203], a[8:11]
    s_waitcnt lgkmcnt(5)
    v_exp_f32 v18, v18
    v_mfma_f32_16x16x32_bf16 a[12:15], a[228:231], a[192:195], a[12:15]
    ds_read_b64_tr_b16 a[244:245], v2 offset:32
    v_add_f32 v11, v18, v11
    v_mfma_f32_16x16x32_bf16 a[16:19], a[228:231], a[196:199], a[16:19]
    ds_read_b64_tr_b16 a[246:247], v2 offset:4256
    v_exp_f32 v19, v19
    v_mfma_f32_16x16x32_bf16 a[20:23], a[228:231], a[200:203], a[20:23]
    s_and_b32 s44, s44, 1023
    s_add_u32 m0, s46, s74
    s_waitcnt lgkmcnt(6)
    buffer_load_dwordx4 v5, s[12:15], s43 offen nt lds
    v_mfma_f32_16x16x32_bf16 v[40:43], a[232:235], v[100:103], v[40:43]
    ds_read_b64_tr_b16 a[216:217], v3 offset:512
    v_add_f32 v11, v19, v11
    v_mfma_f32_16x16x32_bf16 v[44:47], a[232:235], v[104:107], v[44:47]
    ds_read_b64_tr_b16 a[218:219], v3 offset:1536
    v_cvt_pk_bf16_f32 v65, v18, v19
    v_mfma_f32_16x16x32_bf16 v[48:51], a[232:235], v[108:111], v[48:51]
    s_waitcnt lgkmcnt(6)
    v_exp_f32 v20, v20
    v_mfma_f32_16x16x32_bf16 a[24:27], a[236:239], a[192:195], a[24:27]
    ds_read_b64_tr_b16 a[220:221], v3 offset:520
    v_add_f32 v12, v20, v12
    v_mfma_f32_16x16x32_bf16 a[28:31], a[236:239], a[196:199], a[28:31]
    ds_read_b64_tr_b16 a[222:223], v3 offset:1544
    v_mfma_f32_16x16x32_bf16 a[32:35], a[236:239], a[200:203], a[32:35]
    s_waitcnt lgkmcnt(6)
    buffer_load_dwordx4 v247, s[12:15], s43 offen offset:1056 nt lds
    v_mfma_f32_16x16x32_bf16 a[36:39], a[240:243], a[192:195], a[36:39]
    ds_read_b128 a[224:227], v1 offset:512
    v_mfma_f32_16x16x32_bf16 a[40:43], a[240:243], a[196:199], a[40:43]
    v_exp_f32 v21, v21
    v_mfma_f32_16x16x32_bf16 a[44:47], a[240:243], a[200:203], a[44:47]
    s_waitcnt lgkmcnt(5)
    v_exp_f32 v22, v22
    v_mfma_f32_16x16x32_bf16 v[148:151], a[244:247], v[76:79], v[148:151]
    ds_read_b64_tr_b16 a[228:229], v3 offset:768
    v_exp_f32 v23, v23
    v_mfma_f32_16x16x32_bf16 v[152:155], a[244:247], v[80:83], v[152:155]
    ds_read_b64_tr_b16 a[230:231], v3 offset:1792
    v_add_f32 v12, v21, v12
    v_mfma_f32_16x16x32_bf16 v[156:159], a[244:247], v[84:87], v[156:159]
    s_add_u32 m0, s46, s76
    s_waitcnt lgkmcnt(5)
    buffer_load_dwordx4 v5, s[16:19], s43 offen nt lds
    v_mfma_f32_16x16x32_bf16 a[48:51], a[216:219], a[192:195], a[48:51]
    ds_read_b64_tr_b16 a[232:233], v3 offset:776
    v_cvt_pk_bf16_f32 v68, v20, v21
    v_mfma_f32_16x16x32_bf16 a[52:55], a[216:219], a[196:199], a[52:55]
    ds_read_b64_tr_b16 a[234:235], v3 offset:1800
    v_add_f32 v12, v22, v12
    v_mfma_f32_16x16x32_bf16 a[56:59], a[216:219], a[200:203], a[56:59]
    s_waitcnt lgkmcnt(5)
    v_exp_f32 v24, v24
    v_mfma_f32_16x16x32_bf16 a[60:63], a[220:223], a[192:195], a[60:63]
    ds_read_b64_tr_b16 a[236:237], v2 offset:256
    v_add_f32 v12, v23, v12
    v_mfma_f32_16x16x32_bf16 a[64:67], a[220:223], a[196:199], a[64:67]
    ds_read_b64_tr_b16 a[238:239], v2 offset:4480
    v_exp_f32 v25, v25
    v_mfma_f32_16x16x32_bf16 a[68:71], a[220:223], a[200:203], a[68:71]
    s_waitcnt lgkmcnt(6)
    v_exp_f32 v26, v26
    v_mfma_f32_16x16x32_bf16 v[40:43], a[224:227], v[112:115], v[40:43]
    ds_read_b64_tr_b16 a[240:241], v2 offset:288
    v_cvt_pk_bf16_f32 v69, v22, v23
    v_mfma_f32_16x16x32_bf16 v[44:47], a[224:227], v[116:119], v[44:47]
    ds_read_b64_tr_b16 a[242:243], v2 offset:4512
    v_add_f32 v13, v24, v13
    v_mfma_f32_16x16x32_bf16 v[48:51], a[224:227], v[120:123], v[48:51]
    s_waitcnt lgkmcnt(6)
    buffer_load_dwordx4 v247, s[16:19], s43 offen offset:1056 nt lds
    v_mfma_f32_16x16x32_bf16 a[72:75], a[228:231], a[192:195], a[72:75]
    ds_read_b128 a[244:247], v1 offset:768
    v_add_f32 v13, v25, v13
    v_mfma_f32_16x16x32_bf16 a[76:79], a[228:231], a[196:199], a[76:79]
    v_exp_f32 v27, v27
    v_mfma_f32_16x16x32_bf16 a[80:83], a[228:231], a[200:203], a[80:83]
    s_waitcnt lgkmcnt(5)
    v_exp_f32 v28, v28
    v_mfma_f32_16x16x32_bf16 a[84:87], a[232:235], a[192:195], a[84:87]
    ds_read_b64_tr_b16 a[216:217], v2 offset:512
    v_cvt_pk_bf16_f32 v72, v24, v25
    v_mfma_f32_16x16x32_bf16 a[88:91], a[232:235], a[196:199], a[88:91]
    ds_read_b64_tr_b16 a[218:219], v2 offset:4736
    v_add_f32 v13, v26, v13
    v_mfma_f32_16x16x32_bf16 a[92:95], a[232:235], a[200:203], a[92:95]
    s_add_u32 s43, s43, 8192
    s_add_u32 m0, s46, s78
    s_waitcnt lgkmcnt(5)
    buffer_load_dwordx4 v6, s[20:23], s45 offen nt lds
    v_mfma_f32_16x16x32_bf16 v[160:163], a[236:239], v[76:79], v[160:163]
    ds_read_b64_tr_b16 a[220:221], v2 offset:544
    v_exp_f32 v29, v29
    v_mfma_f32_16x16x32_bf16 v[164:167], a[236:239], v[80:83], v[164:167]
    ds_read_b64_tr_b16 a[222:223], v2 offset:4768
    v_add_f32 v13, v27, v13
    v_mfma_f32_16x16x32_bf16 v[168:171], a[236:239], v[84:87], v[168:171]
    s_waitcnt lgkmcnt(5)
    v_exp_f32 v30, v30
    v_mfma_f32_16x16x32_bf16 v[172:175], a[240:243], v[76:79], v[172:175]
    ds_read_b64_tr_b16 a[224:225], v2 offset:768
    v_cvt_pk_bf16_f32 v73, v26, v27
    v_mfma_f32_16x16x32_bf16 v[176:179], a[240:243], v[80:83], v[176:179]
    ds_read_b64_tr_b16 a[226:227], v2 offset:4992
    v_add_f32 v11, v28, v11
    v_mfma_f32_16x16x32_bf16 v[180:183], a[240:243], v[84:87], v[180:183]
    s_xor_b32 s46, s46, 83008
    s_waitcnt lgkmcnt(6)
    buffer_load_dwordx4 v7, s[20:23], s45 offen offset:1024 nt lds
    v_mfma_f32_16x16x32_bf16 v[40:43], a[244:247], v[124:127], v[40:43]
    ds_read_b64_tr_b16 a[228:229], v2 offset:800
    v_add_f32 v11, v29, v11
    v_mfma_f32_16x16x32_bf16 v[44:47], a[244:247], v[128:131], v[44:47]
    ds_read_b64_tr_b16 a[230:231], v2 offset:5024
    v_cvt_pk_bf16_f32 v66, v28, v29
    v_mfma_f32_16x16x32_bf16 v[48:51], a[244:247], v[132:135], v[48:51]
    s_waitcnt lgkmcnt(6)
    v_exp_f32 v31, v31
    v_mfma_f32_16x16x32_bf16 v[184:187], a[216:219], v[76:79], v[184:187]
    ds_read_b128 a[232:235], v1 offset:4224
    v_add_f32 v11, v30, v11
    v_mfma_f32_16x16x32_bf16 v[188:191], a[216:219], v[80:83], v[188:191]
    v_exp_f32 v32, v32
    v_mfma_f32_16x16x32_bf16 v[192:195], a[216:219], v[84:87], v[192:195]
    s_waitcnt lgkmcnt(5)
    v_exp_f32 v33, v33
    v_mfma_f32_16x16x32_bf16 v[196:199], a[220:223], v[76:79], v[196:199]
    ds_read_b128 a[236:239], v1 offset:4480
    v_add_f32 v11, v31, v11
    v_mfma_f32_16x16x32_bf16 v[200:203], a[220:223], v[80:83], v[200:203]
    v_exp_f32 v34, v34
    v_mfma_f32_16x16x32_bf16 v[204:207], a[220:223], v[84:87], v[204:207]
    s_waitcnt lgkmcnt(4)
    v_exp_f32 v35, v35
    v_mfma_f32_16x16x32_bf16 v[208:211], a[224:227], v[76:79], v[208:211]
    ds_read_b128 a[240:243], v1 offset:4736
    v_cvt_pk_bf16_f32 v67, v30, v31
    v_mfma_f32_16x16x32_bf16 v[212:215], a[224:227], v[80:83], v[212:215]
    v_exp_f32 v36, v36
    v_mfma_f32_16x16x32_bf16 v[216:219], a[224:227], v[84:87], v[216:219]
    s_waitcnt lgkmcnt(3)
    v_exp_f32 v37, v37
    v_mfma_f32_16x16x32_bf16 v[220:223], a[228:231], v[76:79], v[220:223]
    ds_read_b128 a[244:247], v1 offset:4992
    v_add_f32 v12, v32, v12
    v_mfma_f32_16x16x32_bf16 v[224:227], a[228:231], v[80:83], v[224:227]
    v_exp_f32 v38, v38
    v_mfma_f32_16x16x32_bf16 v[228:231], a[228:231], v[84:87], v[228:231]
    s_waitcnt lgkmcnt(3)
    v_exp_f32 v39, v39
    v_add_f32 v12, v33, v12
    v_cvt_pk_bf16_f32 v70, v32, v33
    v_add_f32 v12, v34, v12
    s_add_u32 s45, s45, 262144
    s_cmp_ge_u32 s45, 4194304
    s_cselect_b32 s84, 4194048, 0
    s_sub_u32 s45, s45, s84
    v_mfma_f32_16x16x32_bf16 v[52:55], a[232:235], v[88:91], 0
    s_waitcnt vmcnt(18)
    s_barrier
    s_waitcnt lgkmcnt(0)
    v_mfma_f32_16x16x32_bf16 v[56:59], a[232:235], v[92:95], 0
    ds_read_b128 a[216:219], v1 offset:25120
    v_add_f32 v12, v35, v12
    v_mfma_f32_16x16x32_bf16 v[60:63], a[232:235], v[96:99], 0
    ds_read_b128 a[192:195], v10 offset:0
    v_cvt_pk_bf16_f32 v71, v34, v35
    v_mfma_f32_16x16x32_bf16 v[52:55], a[236:239], v[100:103], v[52:55]
    ds_read_b64_tr_b16 a[220:221], v2 offset:25120
    v_add_f32 v13, v36, v13
    v_mfma_f32_16x16x32_bf16 v[56:59], a[236:239], v[104:107], v[56:59]
    ds_read_b64_tr_b16 a[222:223], v2 offset:29344
    v_add_f32 v13, v37, v13
    v_mfma_f32_16x16x32_bf16 v[60:63], a[236:239], v[108:111], v[60:63]
    ds_read_b128 a[196:199], v10 offset:2048
    v_cvt_pk_bf16_f32 v74, v36, v37
    v_mfma_f32_16x16x32_bf16 v[52:55], a[240:243], v[112:115], v[52:55]
    ds_read_b64_tr_b16 a[224:225], v3 offset:25120
    v_add_f32 v13, v38, v13
    v_mfma_f32_16x16x32_bf16 v[56:59], a[240:243], v[116:119], v[56:59]
    ds_read_b64_tr_b16 a[226:227], v3 offset:26144
    v_add_f32 v13, v39, v13
    v_mfma_f32_16x16x32_bf16 v[60:63], a[240:243], v[120:123], v[60:63]
    ds_read_b128 a[200:203], v10 offset:4096
    v_cvt_pk_bf16_f32 v75, v38, v39
    v_mfma_f32_16x16x32_bf16 v[52:55], a[244:247], v[124:127], v[52:55]
    ds_read_b64_tr_b16 a[228:229], v3 offset:25128
    v_add_u32 v4, s99, v4
    v_mfma_f32_16x16x32_bf16 v[56:59], a[244:247], v[128:131], v[56:59]
    ds_read_b64_tr_b16 a[230:231], v3 offset:26152
    v_add_u32 v10, s99, v10
    v_mfma_f32_16x16x32_bf16 v[60:63], a[244:247], v[132:135], v[60:63]
    s_sub_u32 s99, 0, s99
    s_add_u32 m0, s47, s74
    s_waitcnt lgkmcnt(9)
    buffer_load_dwordx4 v5, s[12:15], s43 offen nt lds
    v_mfma_f32_16x16x32_bf16 v[16:19], a[216:219], v[88:91], 0
    ds_read_b128 a[232:235], v1 offset:25376
    v_exp_f32 v40, v40
    v_mfma_f32_16x16x32_bf16 v[20:23], a[216:219], v[92:95], 0
    buffer_load_dwordx4 v247, s[12:15], s43 offen offset:1056 nt lds
    v_mfma_f32_16x16x32_bf16 v[24:27], a[216:219], v[96:99], 0
    s_waitcnt lgkmcnt(7)
    v_exp_f32 v41, v41
    v_mfma_f32_16x16x32_bf16 v[136:139], a[220:223], v[64:67], v[136:139]
    ds_read_b64_tr_b16 a[236:237], v3 offset:25376
    v_add_f32 v11, v40, v11
    v_mfma_f32_16x16x32_bf16 v[140:143], a[220:223], v[68:71], v[140:143]
    ds_read_b64_tr_b16 a[238:239], v3 offset:26400
    v_add_f32 v11, v41, v11
    v_mfma_f32_16x16x32_bf16 v[144:147], a[220:223], v[72:75], v[144:147]
    s_add_u32 m0, s47, s76
    s_waitcnt lgkmcnt(5)
    buffer_load_dwordx4 v5, s[16:19], s43 offen nt lds
    v_mfma_f32_16x16x32_bf16 a[0:3], a[224:227], a[192:195], a[0:3]
    ds_read_b64_tr_b16 a[240:241], v3 offset:25384
    v_cvt_pk_bf16_f32 v76, v40, v41
    v_mfma_f32_16x16x32_bf16 a[4:7], a[224:227], a[196:199], a[4:7]
    ds_read_b64_tr_b16 a[242:243], v3 offset:26408
    v_mfma_f32_16x16x32_bf16 a[8:11], a[224:227], a[200:203], a[8:11]
    s_waitcnt lgkmcnt(5)
    v_exp_f32 v42, v42
    v_mfma_f32_16x16x32_bf16 a[12:15], a[228:231], a[192:195], a[12:15]
    ds_read_b64_tr_b16 a[244:245], v2 offset:25152
    v_add_f32 v11, v42, v11
    v_mfma_f32_16x16x32_bf16 a[16:19], a[228:231], a[196:199], a[16:19]
    ds_read_b64_tr_b16 a[246:247], v2 offset:29376
    v_exp_f32 v43, v43
    v_mfma_f32_16x16x32_bf16 a[20:23], a[228:231], a[200:203], a[20:23]
    s_waitcnt lgkmcnt(6)
    buffer_load_dwordx4 v247, s[16:19], s43 offen offset:1056 nt lds
    v_mfma_f32_16x16x32_bf16 v[16:19], a[232:235], v[100:103], v[16:19]
    ds_read_b64_tr_b16 a[216:217], v3 offset:25632
    v_add_f32 v11, v43, v11
    v_mfma_f32_16x16x32_bf16 v[20:23], a[232:235], v[104:107], v[20:23]
    ds_read_b64_tr_b16 a[218:219], v3 offset:26656
    v_cvt_pk_bf16_f32 v77, v42, v43
    v_mfma_f32_16x16x32_bf16 v[24:27], a[232:235], v[108:111], v[24:27]
    s_waitcnt lgkmcnt(6)
    v_exp_f32 v44, v44
    v_mfma_f32_16x16x32_bf16 a[24:27], a[236:239], a[192:195], a[24:27]
    ds_read_b64_tr_b16 a[220:221], v3 offset:25640
    v_add_f32 v12, v44, v12
    v_mfma_f32_16x16x32_bf16 a[28:31], a[236:239], a[196:199], a[28:31]
    ds_read_b64_tr_b16 a[222:223], v3 offset:26664
    s_add_u32 s43, s43, 8192
    v_mfma_f32_16x16x32_bf16 a[32:35], a[236:239], a[200:203], a[32:35]
    s_add_u32 m0, s47, s78
    s_waitcnt lgkmcnt(6)
    buffer_load_dwordx4 v6, s[20:23], s45 offen nt lds
    v_mfma_f32_16x16x32_bf16 a[36:39], a[240:243], a[192:195], a[36:39]
    ds_read_b128 a[224:227], v1 offset:25632
    s_xor_b32 s47, s47, 50240
    v_mfma_f32_16x16x32_bf16 a[40:43], a[240:243], a[196:199], a[40:43]
    v_exp_f32 v45, v45
    v_mfma_f32_16x16x32_bf16 a[44:47], a[240:243], a[200:203], a[44:47]
    s_waitcnt lgkmcnt(5)
    v_exp_f32 v46, v46
    v_mfma_f32_16x16x32_bf16 v[148:151], a[244:247], v[64:67], v[148:151]
    ds_read_b64_tr_b16 a[228:229], v3 offset:25888
    v_exp_f32 v47, v47
    v_mfma_f32_16x16x32_bf16 v[152:155], a[244:247], v[68:71], v[152:155]
    ds_read_b64_tr_b16 a[230:231], v3 offset:26912
    v_add_f32 v12, v45, v12
    v_mfma_f32_16x16x32_bf16 v[156:159], a[244:247], v[72:75], v[156:159]
    s_waitcnt lgkmcnt(5)
    buffer_load_dwordx4 v7, s[20:23], s45 offen offset:1024 nt lds
    v_mfma_f32_16x16x32_bf16 a[48:51], a[216:219], a[192:195], a[48:51]
    ds_read_b64_tr_b16 a[232:233], v3 offset:25896
    v_cvt_pk_bf16_f32 v80, v44, v45
    v_mfma_f32_16x16x32_bf16 a[52:55], a[216:219], a[196:199], a[52:55]
    ds_read_b64_tr_b16 a[234:235], v3 offset:26920
    v_add_f32 v12, v46, v12
    v_mfma_f32_16x16x32_bf16 a[56:59], a[216:219], a[200:203], a[56:59]
    s_waitcnt lgkmcnt(5)
    v_exp_f32 v48, v48
    v_mfma_f32_16x16x32_bf16 a[60:63], a[220:223], a[192:195], a[60:63]
    ds_read_b64_tr_b16 a[236:237], v2 offset:25376
    v_add_f32 v12, v47, v12
    v_mfma_f32_16x16x32_bf16 a[64:67], a[220:223], a[196:199], a[64:67]
    ds_read_b64_tr_b16 a[238:239], v2 offset:29600
    v_exp_f32 v49, v49
    v_mfma_f32_16x16x32_bf16 a[68:71], a[220:223], a[200:203], a[68:71]
    s_waitcnt lgkmcnt(6)
    v_exp_f32 v50, v50
    v_mfma_f32_16x16x32_bf16 v[16:19], a[224:227], v[112:115], v[16:19]
    ds_read_b64_tr_b16 a[240:241], v2 offset:25408
    v_cvt_pk_bf16_f32 v81, v46, v47
    v_mfma_f32_16x16x32_bf16 v[20:23], a[224:227], v[116:119], v[20:23]
    ds_read_b64_tr_b16 a[242:243], v2 offset:29632
    v_add_f32 v13, v48, v13
    v_mfma_f32_16x16x32_bf16 v[24:27], a[224:227], v[120:123], v[24:27]
    s_add_u32 s45, s45, 262144
    s_mov_b32 m0, s80
    s_waitcnt lgkmcnt(6)
    buffer_load_dwordx4 v8, s[8:11], s44 offen lds
    v_mfma_f32_16x16x32_bf16 a[72:75], a[228:231], a[192:195], a[72:75]
    ds_read_b128 a[244:247], v1 offset:25888
    v_add_f32 v13, v49, v13
    v_mfma_f32_16x16x32_bf16 a[76:79], a[228:231], a[196:199], a[76:79]
    v_exp_f32 v51, v51
    v_mfma_f32_16x16x32_bf16 a[80:83], a[228:231], a[200:203], a[80:83]
    s_waitcnt lgkmcnt(5)
    v_exp_f32 v52, v52
    v_mfma_f32_16x16x32_bf16 a[84:87], a[232:235], a[192:195], a[84:87]
    ds_read_b64_tr_b16 a[216:217], v2 offset:25632
    v_cvt_pk_bf16_f32 v84, v48, v49
    v_mfma_f32_16x16x32_bf16 a[88:91], a[232:235], a[196:199], a[88:91]
    ds_read_b64_tr_b16 a[218:219], v2 offset:29856
    v_add_f32 v13, v50, v13
    v_mfma_f32_16x16x32_bf16 a[92:95], a[232:235], a[200:203], a[92:95]
    s_cmp_ge_u32 s45, 4194304
    s_cselect_b32 s84, 4194048, 0
    s_waitcnt lgkmcnt(5)
    buffer_load_dwordx4 v9, s[8:11], s44 offen offset:1024 lds
    v_mfma_f32_16x16x32_bf16 v[160:163], a[236:239], v[64:67], v[160:163]
    ds_read_b64_tr_b16 a[220:221], v2 offset:25664
    v_exp_f32 v53, v53
    v_mfma_f32_16x16x32_bf16 v[164:167], a[236:239], v[68:71], v[164:167]
    ds_read_b64_tr_b16 a[222:223], v2 offset:29888
    v_add_f32 v13, v51, v13
    v_mfma_f32_16x16x32_bf16 v[168:171], a[236:239], v[72:75], v[168:171]
    s_waitcnt lgkmcnt(5)
    v_exp_f32 v54, v54
    v_mfma_f32_16x16x32_bf16 v[172:175], a[240:243], v[64:67], v[172:175]
    ds_read_b64_tr_b16 a[224:225], v2 offset:25888
    v_cvt_pk_bf16_f32 v85, v50, v51
    v_mfma_f32_16x16x32_bf16 v[176:179], a[240:243], v[68:71], v[176:179]
    ds_read_b64_tr_b16 a[226:227], v2 offset:30112
    v_add_f32 v11, v52, v11
    v_mfma_f32_16x16x32_bf16 v[180:183], a[240:243], v[72:75], v[180:183]
    s_sub_u32 s45, s45, s84
    s_waitcnt lgkmcnt(6)
    buffer_load_dwordx4 v15, s[8:11], s44 offen offset:2048 lds
    v_mfma_f32_16x16x32_bf16 v[16:19], a[244:247], v[124:127], v[16:19]
    ds_read_b64_tr_b16 a[228:229], v2 offset:25920
    v_add_f32 v11, v53, v11
    v_mfma_f32_16x16x32_bf16 v[20:23], a[244:247], v[128:131], v[20:23]
    ds_read_b64_tr_b16 a[230:231], v2 offset:30144
    v_cvt_pk_bf16_f32 v78, v52, v53
    v_mfma_f32_16x16x32_bf16 v[24:27], a[244:247], v[132:135], v[24:27]
    s_waitcnt lgkmcnt(6)
    v_exp_f32 v55, v55
    v_mfma_f32_16x16x32_bf16 v[184:187], a[216:219], v[64:67], v[184:187]
    ds_read_b128 a[232:235], v1 offset:29344
    v_add_f32 v11, v54, v11
    v_mfma_f32_16x16x32_bf16 v[188:191], a[216:219], v[68:71], v[188:191]
    v_exp_f32 v56, v56
    v_mfma_f32_16x16x32_bf16 v[192:195], a[216:219], v[72:75], v[192:195]
    s_waitcnt lgkmcnt(5)
    v_exp_f32 v57, v57
    v_mfma_f32_16x16x32_bf16 v[196:199], a[220:223], v[64:67], v[196:199]
    ds_read_b128 a[236:239], v1 offset:29600
    v_add_f32 v11, v55, v11
    v_mfma_f32_16x16x32_bf16 v[200:203], a[220:223], v[68:71], v[200:203]
    v_exp_f32 v58, v58
    v_mfma_f32_16x16x32_bf16 v[204:207], a[220:223], v[72:75], v[204:207]
    s_waitcnt lgkmcnt(4)
    v_exp_f32 v59, v59
    v_mfma_f32_16x16x32_bf16 v[208:211], a[224:227], v[64:67], v[208:211]
    ds_read_b128 a[240:243], v1 offset:29856
    v_cvt_pk_bf16_f32 v79, v54, v55
    v_mfma_f32_16x16x32_bf16 v[212:215], a[224:227], v[68:71], v[212:215]
    v_exp_f32 v60, v60
    v_mfma_f32_16x16x32_bf16 v[216:219], a[224:227], v[72:75], v[216:219]
    s_waitcnt lgkmcnt(3)
    v_exp_f32 v61, v61
    v_mfma_f32_16x16x32_bf16 v[220:223], a[228:231], v[64:67], v[220:223]
    ds_read_b128 a[244:247], v1 offset:30112
    v_add_f32 v12, v56, v12
    v_mfma_f32_16x16x32_bf16 v[224:227], a[228:231], v[68:71], v[224:227]
    v_exp_f32 v62, v62
    v_mfma_f32_16x16x32_bf16 v[228:231], a[228:231], v[72:75], v[228:231]
    s_waitcnt lgkmcnt(3)
    v_exp_f32 v63, v63
    v_add_f32 v12, v57, v12
    v_cvt_pk_bf16_f32 v82, v56, v57
    v_add_f32 v12, v58, v12
    v_add_u32 v1, s83, v1
    v_add_u32 v2, s83, v2
    v_add_u32 v3, s83, v3
    s_sub_u32 s83, 0, s83
    s_sub_u32 s90, s90, 1
    s_cmp_lg_u32 s90, 0
    s_cbranch_scc1 L_B
    v_mfma_f32_16x16x32_bf16 v[28:31], a[232:235], v[88:91], 0
    s_waitcnt vmcnt(15)
    s_barrier
    s_waitcnt lgkmcnt(0)
    v_mfma_f32_16x16x32_bf16 v[32:35], a[232:235], v[92:95], 0
    ds_read_b128 a[216:219], v1 offset:0
    v_add_f32 v12, v59, v12
    v_mfma_f32_16x16x32_bf16 v[36:39], a[232:235], v[96:99], 0
    ds_read_b128 a[192:195], v4 offset:0
    v_cvt_pk_bf16_f32 v83, v58, v59
    v_mfma_f32_16x16x32_bf16 v[28:31], a[236:239], v[100:103], v[28:31]
    ds_read_b64_tr_b16 a[220:221], v2 offset:0
    v_add_f32 v13, v60, v13
    v_mfma_f32_16x16x32_bf16 v[32:35], a[236:239], v[104:107], v[32:35]
    ds_read_b64_tr_b16 a[222:223], v2 offset:4224
    v_add_f32 v13, v61, v13
    v_mfma_f32_16x16x32_bf16 v[36:39], a[236:239], v[108:111], v[36:39]
    ds_read_b128 a[196:199], v4 offset:2048
    v_cvt_pk_bf16_f32 v86, v60, v61
    v_mfma_f32_16x16x32_bf16 v[28:31], a[240:243], v[112:115], v[28:31]
    ds_read_b64_tr_b16 a[224:225], v3 offset:0
    v_add_f32 v13, v62, v13
    v_mfma_f32_16x16x32_bf16 v[32:35], a[240:243], v[116:119], v[32:35]
    ds_read_b64_tr_b16 a[226:227], v3 offset:1024
    v_add_f32 v13, v63, v13
    v_mfma_f32_16x16x32_bf16 v[36:39], a[240:243], v[120:123], v[36:39]
    ds_read_b128 a[200:203], v4 offset:4096
    v_cvt_pk_bf16_f32 v87, v62, v63
    v_mfma_f32_16x16x32_bf16 v[28:31], a[244:247], v[124:127], v[28:31]
    ds_read_b64_tr_b16 a[228:229], v3 offset:8
    v_mfma_f32_16x16x32_bf16 v[32:35], a[244:247], v[128:131], v[32:35]
    ds_read_b64_tr_b16 a[230:231], v3 offset:1032
    v_mfma_f32_16x16x32_bf16 v[36:39], a[244:247], v[132:135], v[36:39]
    s_add_u32 m0, s80, 3072
    s_waitcnt lgkmcnt(9)
    buffer_load_dwordx4 v244, s[8:11], s44 offen lds
    v_mfma_f32_16x16x32_bf16 v[40:43], a[216:219], v[88:91], 0
    ds_read_b128 a[232:235], v1 offset:256
    v_exp_f32 v16, v16
    v_mfma_f32_16x16x32_bf16 v[44:47], a[216:219], v[92:95], 0
    s_xor_b32 s80, s80, s81
    buffer_load_dwordx4 v245, s[8:11], s44 offen offset:1024 lds
    v_mfma_f32_16x16x32_bf16 v[48:51], a[216:219], v[96:99], 0
    s_waitcnt lgkmcnt(7)
    v_exp_f32 v17, v17
    v_mfma_f32_16x16x32_bf16 v[136:139], a[220:223], v[76:79], v[136:139]
    ds_read_b64_tr_b16 a[236:237], v3 offset:256
    v_add_f32 v11, v16, v11
    v_mfma_f32_16x16x32_bf16 v[140:143], a[220:223], v[80:83], v[140:143]
    ds_read_b64_tr_b16 a[238:239], v3 offset:1280
    v_add_f32 v11, v17, v11
    v_mfma_f32_16x16x32_bf16 v[144:147], a[220:223], v[84:87], v[144:147]
    s_waitcnt lgkmcnt(5)
    buffer_load_dwordx4 v246, s[8:11], s44 offen offset:2048 lds
    v_mfma_f32_16x16x32_bf16 a[0:3], a[224:227], a[192:195], a[0:3]
    ds_read_b64_tr_b16 a[240:241], v3 offset:264
    v_cvt_pk_bf16_f32 v64, v16, v17
    v_mfma_f32_16x16x32_bf16 a[4:7], a[224:227], a[196:199], a[4:7]
    ds_read_b64_tr_b16 a[242:243], v3 offset:1288
    s_add_u32 s44, s44, 128
    v_mfma_f32_16x16x32_bf16 a[8:11], a[224:227], a[200:203], a[8:11]
    s_waitcnt lgkmcnt(5)
    v_exp_f32 v18, v18
    v_mfma_f32_16x16x32_bf16 a[12:15], a[228:231], a[192:195], a[12:15]
    ds_read_b64_tr_b16 a[244:245], v2 offset:32
    v_add_f32 v11, v18, v11
    v_mfma_f32_16x16x32_bf16 a[16:19], a[228:231], a[196:199], a[16:19]
    ds_read_b64_tr_b16 a[246:247], v2 offset:4256
    v_exp_f32 v19, v19
    v_mfma_f32_16x16x32_bf16 a[20:23], a[228:231], a[200:203], a[20:23]
    s_and_b32 s44, s44, 1023
    s_add_u32 m0, s46, s74
    s_waitcnt lgkmcnt(6)
    buffer_load_dwordx4 v5, s[12:15], s43 offen nt lds
    v_mfma_f32_16x16x32_bf16 v[40:43], a[232:235], v[100:103], v[40:43]
    ds_read_b64_tr_b16 a[216:217], v3 offset:512
    v_add_f32 v11, v19, v11
    v_mfma_f32_16x16x32_bf16 v[44:47], a[232:235], v[104:107], v[44:47]
    ds_read_b64_tr_b16 a[218:219], v3 offset:1536
    v_cvt_pk_bf16_f32 v65, v18, v19
    v_mfma_f32_16x16x32_bf16 v[48:51], a[232:235], v[108:111], v[48:51]
    s_waitcnt lgkmcnt(6)
    v_exp_f32 v20, v20
    v_mfma_f32_16x16x32_bf16 a[24:27], a[236:239], a[192:195], a[24:27]
    ds_read_b64_tr_b16 a[220:221], v3 offset:520
    v_add_f32 v12, v20, v12
    v_mfma_f32_16x16x32_bf16 a[28:31], a[236:239], a[196:199], a[28:31]
    ds_read_b64_tr_b16 a[222:223], v3 offset:1544
    v_mfma_f32_16x16x32_bf16 a[32:35], a[236:239], a[200:203], a[32:35]
    s_waitcnt lgkmcnt(6)
    buffer_load_dwordx4 v247, s[12:15], s43 offen offset:1056 nt lds
    v_mfma_f32_16x16x32_bf16 a[36:39], a[240:243], a[192:195], a[36:39]
    ds_read_b128 a[224:227], v1 offset:512
    v_mfma_f32_16x16x32_bf16 a[40:43], a[240:243], a[196:199], a[40:43]
    v_exp_f32 v21, v21
    v_mfma_f32_16x16x32_bf16 a[44:47], a[240:243], a[200:203], a[44:47]
    s_waitcnt lgkmcnt(5)
    v_exp_f32 v22, v22
    v_mfma_f32_16x16x32_bf16 v[148:151], a[244:247], v[76:79], v[148:151]
    ds_read_b64_tr_b16 a[228:229], v3 offset:768
    v_exp_f32 v23, v23
    v_mfma_f32_16x16x32_bf16 v[152:155], a[244:247], v[80:83], v[152:155]
    ds_read_b64_tr_b16 a[230:231], v3 offset:1792
    v_add_f32 v12, v21, v12
    v_mfma_f32_16x16x32_bf16 v[156:159], a[244:247], v[84:87], v[156:159]
    s_add_u32 m0, s46, s76
    s_waitcnt lgkmcnt(5)
    buffer_load_dwordx4 v5, s[16:19], s43 offen nt lds
    v_mfma_f32_16x16x32_bf16 a[48:51], a[216:219], a[192:195], a[48:51]
    ds_read_b64_tr_b16 a[232:233], v3 offset:776
    v_cvt_pk_bf16_f32 v68, v20, v21
    v_mfma_f32_16x16x32_bf16 a[52:55], a[216:219], a[196:199], a[52:55]
    ds_read_b64_tr_b16 a[234:235], v3 offset:1800
    v_add_f32 v12, v22, v12
    v_mfma_f32_16x16x32_bf16 a[56:59], a[216:219], a[200:203], a[56:59]
    s_waitcnt lgkmcnt(5)
    v_exp_f32 v24, v24
    v_mfma_f32_16x16x32_bf16 a[60:63], a[220:223], a[192:195], a[60:63]
    ds_read_b64_tr_b16 a[236:237], v2 offset:256
    v_add_f32 v12, v23, v12
    v_mfma_f32_16x16x32_bf16 a[64:67], a[220:223], a[196:199], a[64:67]
    ds_read_b64_tr_b16 a[238:239], v2 offset:4480
    v_exp_f32 v25, v25
    v_mfma_f32_16x16x32_bf16 a[68:71], a[220:223], a[200:203], a[68:71]
    s_waitcnt lgkmcnt(6)
    v_exp_f32 v26, v26
    v_mfma_f32_16x16x32_bf16 v[40:43], a[224:227], v[112:115], v[40:43]
    ds_read_b64_tr_b16 a[240:241], v2 offset:288
    v_cvt_pk_bf16_f32 v69, v22, v23
    v_mfma_f32_16x16x32_bf16 v[44:47], a[224:227], v[116:119], v[44:47]
    ds_read_b64_tr_b16 a[242:243], v2 offset:4512
    v_add_f32 v13, v24, v13
    v_mfma_f32_16x16x32_bf16 v[48:51], a[224:227], v[120:123], v[48:51]
    s_waitcnt lgkmcnt(6)
    buffer_load_dwordx4 v247, s[16:19], s43 offen offset:1056 nt lds
    v_mfma_f32_16x16x32_bf16 a[72:75], a[228:231], a[192:195], a[72:75]
    ds_read_b128 a[244:247], v1 offset:768
    v_add_f32 v13, v25, v13
    v_mfma_f32_16x16x32_bf16 a[76:79], a[228:231], a[196:199], a[76:79]
    v_exp_f32 v27, v27
    v_mfma_f32_16x16x32_bf16 a[80:83], a[228:231], a[200:203], a[80:83]
    s_waitcnt lgkmcnt(5)
    v_exp_f32 v28, v28
    v_mfma_f32_16x16x32_bf16 a[84:87], a[232:235], a[192:195], a[84:87]
    ds_read_b64_tr_b16 a[216:217], v2 offset:512
    v_cvt_pk_bf16_f32 v72, v24, v25
    v_mfma_f32_16x16x32_bf16 a[88:91], a[232:235], a[196:199], a[88:91]
    ds_read_b64_tr_b16 a[218:219], v2 offset:4736
    v_add_f32 v13, v26, v13
    v_mfma_f32_16x16x32_bf16 a[92:95], a[232:235], a[200:203], a[92:95]
    s_add_u32 s43, s43, 8192
    s_add_u32 m0, s46, s78
    s_waitcnt lgkmcnt(5)
    buffer_load_dwordx4 v6, s[20:23], s45 offen nt lds
    v_mfma_f32_16x16x32_bf16 v[160:163], a[236:239], v[76:79], v[160:163]
    ds_read_b64_tr_b16 a[220:221], v2 offset:544
    v_exp_f32 v29, v29
    v_mfma_f32_16x16x32_bf16 v[164:167], a[236:239], v[80:83], v[164:167]
    ds_read_b64_tr_b16 a[222:223], v2 offset:4768
    v_add_f32 v13, v27, v13
    v_mfma_f32_16x16x32_bf16 v[168:171], a[236:239], v[84:87], v[168:171]
    s_waitcnt lgkmcnt(5)
    v_exp_f32 v30, v30
    v_mfma_f32_16x16x32_bf16 v[172:175], a[240:243], v[76:79], v[172:175]
    ds_read_b64_tr_b16 a[224:225], v2 offset:768
    v_cvt_pk_bf16_f32 v73, v26, v27
    v_mfma_f32_16x16x32_bf16 v[176:179], a[240:243], v[80:83], v[176:179]
    ds_read_b64_tr_b16 a[226:227], v2 offset:4992
    v_add_f32 v11, v28, v11
    v_mfma_f32_16x16x32_bf16 v[180:183], a[240:243], v[84:87], v[180:183]
    s_xor_b32 s46, s46, 83008
    s_waitcnt lgkmcnt(6)
    buffer_load_dwordx4 v7, s[20:23], s45 offen offset:1024 nt lds
    v_mfma_f32_16x16x32_bf16 v[40:43], a[244:247], v[124:127], v[40:43]
    ds_read_b64_tr_b16 a[228:229], v2 offset:800
    v_add_f32 v11, v29, v11
    v_mfma_f32_16x16x32_bf16 v[44:47], a[244:247], v[128:131], v[44:47]
    ds_read_b64_tr_b16 a[230:231], v2 offset:5024
    v_cvt_pk_bf16_f32 v66, v28, v29
    v_mfma_f32_16x16x32_bf16 v[48:51], a[244:247], v[132:135], v[48:51]
    s_waitcnt lgkmcnt(6)
    v_exp_f32 v31, v31
    v_mfma_f32_16x16x32_bf16 v[184:187], a[216:219], v[76:79], v[184:187]
    ds_read_b128 a[232:235], v1 offset:4224
    v_add_f32 v11, v30, v11
    v_mfma_f32_16x16x32_bf16 v[188:191], a[216:219], v[80:83], v[188:191]
    v_exp_f32 v32, v32
    v_mfma_f32_16x16x32_bf16 v[192:195], a[216:219], v[84:87], v[192:195]
    s_waitcnt lgkmcnt(5)
    v_exp_f32 v33, v33
    v_mfma_f32_16x16x32_bf16 v[196:199], a[220:223], v[76:79], v[196:199]
    ds_read_b128 a[236:239], v1 offset:4480
    v_add_f32 v11, v31, v11
    v_mfma_f32_16x16x32_bf16 v[200:203], a[220:223], v[80:83], v[200:203]
    v_exp_f32 v34, v34
    v_mfma_f32_16x16x32_bf16 v[204:207], a[220:223], v[84:87], v[204:207]
    s_waitcnt lgkmcnt(4)
    v_exp_f32 v35, v35
    v_mfma_f32_16x16x32_bf16 v[208:211], a[224:227], v[76:79], v[208:211]
    ds_read_b128 a[240:243], v1 offset:4736
    v_cvt_pk_bf16_f32 v67, v30, v31
    v_mfma_f32_16x16x32_bf16 v[212:215], a[224:227], v[80:83], v[212:215]
    v_exp_f32 v36, v36
    v_mfma_f32_16x16x32_bf16 v[216:219], a[224:227], v[84:87], v[216:219]
    s_waitcnt lgkmcnt(3)
    v_exp_f32 v37, v37
    v_mfma_f32_16x16x32_bf16 v[220:223], a[228:231], v[76:79], v[220:223]
    ds_read_b128 a[244:247], v1 offset:4992
    v_add_f32 v12, v32, v12
    v_mfma_f32_16x16x32_bf16 v[224:227], a[228:231], v[80:83], v[224:227]
    v_exp_f32 v38, v38
    v_mfma_f32_16x16x32_bf16 v[228:231], a[228:231], v[84:87], v[228:231]
    s_waitcnt lgkmcnt(3)
    v_exp_f32 v39, v39
    v_add_f32 v12, v33, v12
    v_cvt_pk_bf16_f32 v70, v32, v33
    v_add_f32 v12, v34, v12
    s_add_u32 s45, s45, 262144
    s_cmp_ge_u32 s45, 4194304
    s_cselect_b32 s84, 4194048, 0
    s_sub_u32 s45, s45, s84
    v_mfma_f32_16x16x32_bf16 v[52:55], a[232:235], v[88:91], 0
    s_waitcnt vmcnt(18)
    s_barrier
    s_waitcnt lgkmcnt(0)
    v_mfma_f32_16x16x32_bf16 v[56:59], a[232:235], v[92:95], 0
    ds_read_b64_tr_b16 a[216:217], v3 offset:25120
    v_add_f32 v12, v35, v12
    v_cvt_pk_bf16_f32 v71, v34, v35
    v_add_f32 v13, v36, v13
    v_add_f32 v13, v37, v13
    v_cvt_pk_bf16_f32 v74, v36, v37
    v_mfma_f32_16x16x32_bf16 v[60:63], a[232:235], v[96:99], 0
    ds_read_b64_tr_b16 a[218:219], v3 offset:26144
    v_add_f32 v13, v38, v13
    v_add_f32 v13, v39, v13
    v_cvt_pk_bf16_f32 v75, v38, v39
    v_mfma_f32_16x16x32_bf16 v[52:55], a[236:239], v[100:103], v[52:55]
    ds_read_b128 a[192:195], v10 offset:0
    v_exp_f32 v40, v40
    v_exp_f32 v41, v41
    v_mfma_f32_16x16x32_bf16 v[56:59], a[236:239], v[104:107], v[56:59]
    ds_read_b64_tr_b16 a[220:221], v3 offset:25128
    v_add_f32 v11, v40, v11
    v_exp_f32 v42, v42
    v_mfma_f32_16x16x32_bf16 v[60:63], a[236:239], v[108:111], v[60:63]
    ds_read_b64_tr_b16 a[222:223], v3 offset:26152
    v_add_f32 v11, v41, v11
    v_exp_f32 v43, v43
    v_mfma_f32_16x16x32_bf16 v[52:55], a[240:243], v[112:115], v[52:55]
    ds_read_b128 a[196:199], v10 offset:2048
    v_cvt_pk_bf16_f32 v76, v40, v41
    v_exp_f32 v44, v44
    v_mfma_f32_16x16x32_bf16 v[56:59], a[240:243], v[116:119], v[56:59]
    ds_read_b64_tr_b16 a[224:225], v3 offset:25376
    v_add_f32 v11, v42, v11
    v_exp_f32 v45, v45
    v_mfma_f32_16x16x32_bf16 v[60:63], a[240:243], v[120:123], v[60:63]
    ds_read_b64_tr_b16 a[226:227], v3 offset:26400
    v_add_f32 v11, v43, v11
    v_exp_f32 v46, v46
    v_mfma_f32_16x16x32_bf16 v[52:55], a[244:247], v[124:127], v[52:55]
    ds_read_b128 a[200:203], v10 offset:4096
    v_cvt_pk_bf16_f32 v77, v42, v43
    v_exp_f32 v47, v47
    v_exp_f32 v48, v48
    v_mfma_f32_16x16x32_bf16 v[56:59], a[244:247], v[128:131], v[56:59]
    ds_read_b64_tr_b16 a[228:229], v3 offset:25384
    v_add_f32 v12, v44, v12
    v_exp_f32 v49, v49
    v_mfma_f32_16x16x32_bf16 v[60:63], a[244:247], v[132:135], v[60:63]
    ds_read_b64_tr_b16 a[230:231], v3 offset:26408
    v_add_f32 v12, v45, v12
    v_exp_f32 v50, v50
    s_waitcnt lgkmcnt(8)
    v_mfma_f32_16x16x32_bf16 a[0:3], a[216:219], a[192:195], a[0:3]
    ds_read_b64_tr_b16 a[232:233], v3 offset:25632
    v_cvt_pk_bf16_f32 v80, v44, v45
    v_add_f32 v12, v46, v12
    s_waitcnt lgkmcnt(6)
    v_mfma_f32_16x16x32_bf16 a[4:7], a[216:219], a[196:199], a[4:7]
    ds_read_b64_tr_b16 a[234:235], v3 offset:26656
    v_add_f32 v12, v47, v12
    v_exp_f32 v51, v51
    v_cvt_pk_bf16_f32 v81, v46, v47
    s_waitcnt lgkmcnt(4)
    v_mfma_f32_16x16x32_bf16 a[8:11], a[216:219], a[200:203], a[8:11]
    s_add_u32 m0, s47, s74
    s_nop 0
    buffer_load_dwordx4 v5, s[12:15], s43 offen nt lds
    v_exp_f32 v52, v52
    v_add_f32 v13, v48, v13
    v_mfma_f32_16x16x32_bf16 a[12:15], a[220:223], a[192:195], a[12:15]
    ds_read_b64_tr_b16 a[236:237], v3 offset:25640
    v_add_f32 v13, v49, v13
    v_exp_f32 v53, v53
    v_mfma_f32_16x16x32_bf16 a[16:19], a[220:223], a[196:199], a[16:19]
    ds_read_b64_tr_b16 a[238:239], v3 offset:26664
    v_cvt_pk_bf16_f32 v84, v48, v49
    v_exp_f32 v54, v54
    v_mfma_f32_16x16x32_bf16 a[20:23], a[220:223], a[200:203], a[20:23]
    buffer_load_dwordx4 v247, s[12:15], s43 offen offset:1056 nt lds
    v_add_f32 v13, v50, v13
    v_exp_f32 v55, v55
    v_mfma_f32_16x16x32_bf16 a[24:27], a[224:227], a[192:195], a[24:27]
    ds_read_b64_tr_b16 a[240:241], v3 offset:25888
    v_add_f32 v13, v51, v13
    v_cvt_pk_bf16_f32 v85, v50, v51
    v_exp_f32 v56, v56
    v_mfma_f32_16x16x32_bf16 a[28:31], a[224:227], a[196:199], a[28:31]
    ds_read_b64_tr_b16 a[242:243], v3 offset:26912
    v_add_f32 v11, v52, v11
    v_exp_f32 v57, v57
    v_mfma_f32_16x16x32_bf16 a[32:35], a[224:227], a[200:203], a[32:35]
    s_add_u32 m0, s47, s76
    s_waitcnt lgkmcnt(6)
    buffer_load_dwordx4 v5, s[16:19], s43 offen nt lds
    v_add_f32 v11, v53, v11
    v_exp_f32 v58, v58
    v_mfma_f32_16x16x32_bf16 a[36:39], a[228:231], a[192:195], a[36:39]
    ds_read_b64_tr_b16 a[244:245], v3 offset:25896
    v_cvt_pk_bf16_f32 v78, v52, v53
    v_add_f32 v11, v54, v11
    v_exp_f32 v59, v59
    v_mfma_f32_16x16x32_bf16 a[40:43], a[228:231], a[196:199], a[40:43]
    ds_read_b64_tr_b16 a[246:247], v3 offset:26920
    v_add_f32 v11, v55, v11
    v_cvt_pk_bf16_f32 v79, v54, v55
    v_exp_f32 v60, v60
    v_mfma_f32_16x16x32_bf16 a[44:47], a[228:231], a[200:203], a[44:47]
    s_waitcnt lgkmcnt(6)
    buffer_load_dwordx4 v247, s[16:19], s43 offen offset:1056 nt lds
    v_add_f32 v12, v56, v12
    v_exp_f32 v61, v61
    v_mfma_f32_16x16x32_bf16 a[48:51], a[232:235], a[192:195], a[48:51]
    s_add_u32 s43, s43, 8192
    s_add_u32 m0, s47, s78
    s_nop 0
    buffer_load_dwordx4 v6, s[20:23], s45 offen nt lds
    v_add_f32 v12, v57, v12
    v_exp_f32 v62, v62
    v_mfma_f32_16x16x32_bf16 a[52:55], a[232:235], a[196:199], a[52:55]
    s_xor_b32 s47, s47, 50240
    buffer_load_dwordx4 v7, s[20:23], s45 offen offset:1024 nt lds
    v_cvt_pk_bf16_f32 v82, v56, v57
    v_add_f32 v12, v58, v12
    v_mfma_f32_16x16x32_bf16 a[56:59], a[232:235], a[200:203], a[56:59]
    s_add_u32 s45, s45, 262144
    s_mov_b32 m0, s80
    s_waitcnt lgkmcnt(4)
    buffer_load_dwordx4 v8, s[8:11], s44 offen lds
    v_exp_f32 v63, v63
    v_add_f32 v12, v59, v12
    v_mfma_f32_16x16x32_bf16 a[60:63], a[236:239], a[192:195], a[60:63]
    s_cmp_ge_u32 s45, 4194304
    s_cselect_b32 s84, 4194048, 0
    buffer_load_dwordx4 v9, s[8:11], s44 offen offset:1024 lds
    v_cvt_pk_bf16_f32 v83, v58, v59
    v_add_f32 v13, v60, v13
    v_add_f32 v13, v61, v13
    v_cvt_pk_bf16_f32 v86, v60, v61
    v_mfma_f32_16x16x32_bf16 a[64:67], a[236:239], a[196:199], a[64:67]
    s_sub_u32 s45, s45, s84
    buffer_load_dwordx4 v15, s[8:11], s44 offen offset:2048 lds
    v_add_f32 v13, v62, v13
    v_add_f32 v13, v63, v13
    v_cvt_pk_bf16_f32 v87, v62, v63
    v_mfma_f32_16x16x32_bf16 a[68:71], a[236:239], a[200:203], a[68:71]
    s_waitcnt lgkmcnt(2)
    v_mov_b32 v240, v11
    s_nop 1
    v_permlane16_swap_b32 v11, v240
    v_add_f32 v11, v11, v240
    v_mfma_f32_16x16x32_bf16 a[72:75], a[240:243], a[192:195], a[72:75]
    v_mov_b32 v240, v11
    s_nop 1
    v_permlane32_swap_b32 v11, v240
    v_add_f32 v11, v11, v240
    v_mfma_f32_16x16x32_bf16 a[76:79], a[240:243], a[196:199], a[76:79]
    v_rcp_f32 v248, v11
    v_mov_b32 v241, v12
    s_nop 1
    v_permlane16_swap_b32 v12, v241
    v_mfma_f32_16x16x32_bf16 a[80:83], a[240:243], a[200:203], a[80:83]
    s_waitcnt lgkmcnt(0)
    v_add_f32 v12, v12, v241
    v_mov_b32 v241, v12
    s_nop 1
    v_permlane32_swap_b32 v12, v241
    v_mfma_f32_16x16x32_bf16 a[84:87], a[244:247], a[192:195], a[84:87]
    v_add_f32 v12, v12, v241
    v_mov_b32 v242, v13
    v_rcp_f32 v249, v12
    v_mfma_f32_16x16x32_bf16 a[88:91], a[244:247], a[196:199], a[88:91]
    v_permlane16_swap_b32 v13, v242
    v_add_f32 v13, v13, v242
    v_mfma_f32_16x16x32_bf16 a[92:95], a[244:247], a[200:203], a[92:95]
    v_mov_b32 v242, v13
    s_nop 1
    v_permlane32_swap_b32 v13, v242
    v_add_f32 v13, v13, v242
    v_rcp_f32 v250, v13
    v_min3_f32 v232, v11, v12, v13
    v_max3_f32 v233, v11, v12, v13
    v_cmp_gt_f32 vcc, 729808896, v232
    s_nop 3
    s_mov_b64 s[84:85], vcc
    v_cmp_lt_f32 vcc, 1400897536, v233
    s_nop 3
    s_or_b64 s[84:85], s[84:85], vcc
    s_cbranch_scc1 L_slow
L_retC:
    ds_read_b64_tr_b16 a[216:217], v2 offset:25120
    ds_read_b64_tr_b16 a[218:219], v2 offset:29344
    ds_read_b64_tr_b16 a[220:221], v2 offset:25152
    ds_read_b64_tr_b16 a[222:223], v2 offset:29376
    ds_read_b64_tr_b16 a[224:225], v2 offset:25376
    ds_read_b64_tr_b16 a[226:227], v2 offset:29600
    ds_read_b64_tr_b16 a[228:229], v2 offset:25408
    ds_read_b64_tr_b16 a[230:231], v2 offset:29632
    s_waitcnt lgkmcnt(6)
    v_mfma_f32_16x16x32_bf16 v[136:139], a[216:219], v[64:67], v[136:139]
    ds_read_b64_tr_b16 a[232:233], v2 offset:25632
    v_accvgpr_read_b32 v232, a0
    v_accvgpr_read_b32 v233, a1
    v_accvgpr_read_b32 v234, a2
    v_accvgpr_read_b32 v235, a3
    v_mul_f32 v232, s88, v232
    v_mfma_f32_16x16x32_bf16 v[140:143], a[216:219], v[68:71], v[140:143]
    ds_read_b64_tr_b16 a[234:235], v2 offset:29856
    v_mul_f32 v233, s88, v233
    v_mul_f32 v234, s88, v234
    v_mul_f32 v235, s88, v235
    v_cvt_pk_bf16_f32 v88, v232, v233
    v_cvt_pk_bf16_f32 v89, v234, v235
    v_accvgpr_read_b32 v236, a12
    v_mfma_f32_16x16x32_bf16 v[144:147], a[216:219], v[72:75], v[144:147]
    s_waitcnt lgkmcnt(6)
    v_accvgpr_read_b32 v237, a13
    v_accvgpr_read_b32 v238, a14
    v_accvgpr_read_b32 v239, a15
    v_mul_f32 v236, s88, v236
    v_mul_f32 v237, s88, v237
    v_mul_f32 v238, s88, v238
    v_mfma_f32_16x16x32_bf16 v[148:151], a[220:223], v[64:67], v[148:151]
    ds_read_b64_tr_b16 a[236:237], v2 offset:25664
    v_mul_f32 v239, s88, v239
    v_cvt_pk_bf16_f32 v90, v236, v237
    v_cvt_pk_bf16_f32 v91, v238, v239
    v_accvgpr_read_b32 v240, a4
    v_accvgpr_read_b32 v241, a5
    v_accvgpr_read_b32 v242, a6
    v_mfma_f32_16x16x32_bf16 v[152:155], a[220:223], v[68:71], v[152:155]
    ds_read_b64_tr_b16 a[238:239], v2 offset:29888
    v_accvgpr_read_b32 v243, a7
    v_mul_f32 v240, s88, v240
    v_mul_f32 v241, s88, v241
    v_mul_f32 v242, s88, v242
    v_mul_f32 v243, s88, v243
    v_cvt_pk_bf16_f32 v92, v240, v241
    v_mfma_f32_16x16x32_bf16 v[156:159], a[220:223], v[72:75], v[156:159]
    s_waitcnt lgkmcnt(6)
    v_cvt_pk_bf16_f32 v93, v242, v243
    v_accvgpr_read_b32 v232, a16
    v_accvgpr_read_b32 v233, a17
    v_accvgpr_read_b32 v234, a18
    v_accvgpr_read_b32 v235, a19
    v_mul_f32 v232, s88, v232
    v_mfma_f32_16x16x32_bf16 v[160:163], a[224:227], v[64:67], v[160:163]
    ds_read_b64_tr_b16 a[240:241], v2 offset:25888
    v_mul_f32 v233, s88, v233
    v_mul_f32 v234, s88, v234
    v_mul_f32 v235, s88, v235
    v_cvt_pk_bf16_f32 v94, v232, v233
    v_cvt_pk_bf16_f32 v95, v234, v235
    v_accvgpr_read_b32 v236, a8
    v_accvgpr_read_b32 v237, a9
    v_mfma_f32_16x16x32_bf16 v[164:167], a[224:227], v[68:71], v[164:167]
    ds_read_b64_tr_b16 a[242:243], v2 offset:30112
    v_accvgpr_read_b32 v238, a10
    v_accvgpr_read_b32 v239, a11
    v_mul_f32 v236, s88, v236
    v_mul_f32 v237, s88, v237
    v_mul_f32 v238, s88, v238
    v_mul_f32 v239, s88, v239
    v_mfma_f32_16x16x32_bf16 v[168:171], a[224:227], v[72:75], v[168:171]
    s_waitcnt lgkmcnt(6)
    v_cvt_pk_bf16_f32 v96, v236, v237
    v_cvt_pk_bf16_f32 v97, v238, v239
    v_accvgpr_read_b32 v240, a20
    v_accvgpr_read_b32 v241, a21
    v_accvgpr_read_b32 v242, a22
    v_accvgpr_read_b32 v243, a23
    v_mfma_f32_16x16x32_bf16 v[172:175], a[228:231], v[64:67], v[172:175]
    ds_read_b64_tr_b16 a[244:245], v2 offset:25920
    v_mul_f32 v240, s88, v240
    v_mul_f32 v241, s88, v241
    v_mul_f32 v242, s88, v242
    v_mul_f32 v243, s88, v243
    v_cvt_pk_bf16_f32 v98, v240, v241
    v_cvt_pk_bf16_f32 v99, v242, v243
    v_mfma_f32_16x16x32_bf16 v[176:179], a[228:231], v[68:71], v[176:179]
    ds_read_b64_tr_b16 a[246:247], v2 offset:30144
    v_accvgpr_read_b32 v232, a24
    v_accvgpr_read_b32 v233, a25
    v_accvgpr_read_b32 v234, a26
    v_accvgpr_read_b32 v235, a27
    v_mul_f32 v232, s88, v232
    v_mul_f32 v233, s88, v233
    v_mfma_f32_16x16x32_bf16 v[180:183], a[228:231], v[72:75], v[180:183]
    s_waitcnt lgkmcnt(6)
    v_mul_f32 v234, s88, v234
    v_mul_f32 v235, s88, v235
    v_cvt_pk_bf16_f32 v100, v232, v233
    v_cvt_pk_bf16_f32 v101, v234, v235
    v_accvgpr_read_b32 v236, a36
    v_accvgpr_read_b32 v237, a37
    v_mfma_f32_16x16x32_bf16 v[184:187], a[232:235], v[64:67], v[184:187]
    ds_read_b128 a[216:219], v1 offset:25120
    v_accvgpr_read_b32 v238, a38
    v_accvgpr_read_b32 v239, a39
    v_mul_f32 v236, s88, v236
    v_mul_f32 v237, s88, v237
    v_mul_f32 v238, s88, v238
    v_mul_f32 v239, s88, v239
    v_mfma_f32_16x16x32_bf16 v[188:191], a[232:235], v[68:71], v[188:191]
    v_cvt_pk_bf16_f32 v102, v236, v237
    v_cvt_pk_bf16_f32 v103, v238, v239
    v_accvgpr_read_b32 v240, a28
    v_accvgpr_read_b32 v241, a29
    v_accvgpr_read_b32 v242, a30
    v_accvgpr_read_b32 v243, a31
    v_mul_f32 v240, s88, v240
    v_mfma_f32_16x16x32_bf16 v[192:195], a[232:235], v[72:75], v[192:195]
    s_waitcnt lgkmcnt(5)
    v_mul_f32 v241, s88, v241
    v_mul_f32 v242, s88, v242
    v_mul_f32 v243, s88, v243
    v_cvt_pk_bf16_f32 v104, v240, v241
    v_cvt_pk_bf16_f32 v105, v242, v243
    v_accvgpr_read_b32 v232, a40
    v_mfma_f32_16x16x32_bf16 v[196:199], a[236:239], v[64:67], v[196:199]
    ds_read_b128 a[220:223], v1 offset:29344
    v_accvgpr_read_b32 v233, a41
    v_accvgpr_read_b32 v234, a42
    v_accvgpr_read_b32 v235, a43
    v_mul_f32 v232, s88, v232
    v_mul_f32 v233, s88, v233
    v_mul_f32 v234, s88, v234
    v_mfma_f32_16x16x32_bf16 v[200:203], a[236:239], v[68:71], v[200:203]
    v_mul_f32 v235, s88, v235
    v_cvt_pk_bf16_f32 v106, v232, v233
    v_cvt_pk_bf16_f32 v107, v234, v235
    v_accvgpr_read_b32 v236, a32
    v_accvgpr_read_b32 v237, a33
    v_accvgpr_read_b32 v238, a34
    v_mfma_f32_16x16x32_bf16 v[204:207], a[236:239], v[72:75], v[204:207]
    s_waitcnt lgkmcnt(4)
    v_accvgpr_read_b32 v239, a35
    v_mul_f32 v236, s88, v236
    v_mul_f32 v237, s88, v237
    v_mul_f32 v238, s88, v238
    v_mul_f32 v239, s88, v239
    v_cvt_pk_bf16_f32 v108, v236, v237
    v_mfma_f32_16x16x32_bf16 v[208:211], a[240:243], v[64:67], v[208:211]
    ds_read_b128 a[224:227], v1 offset:25376
    v_cvt_pk_bf16_f32 v109, v238, v239
    v_accvgpr_read_b32 v240, a44
    v_accvgpr_read_b32 v241, a45
    v_accvgpr_read_b32 v242, a46
    v_accvgpr_read_b32 v243, a47
    v_mul_f32 v240, s88, v240
    v_mfma_f32_16x16x32_bf16 v[212:215], a[240:243], v[68:71], v[212:215]
    v_mul_f32 v241, s88, v241
    v_mul_f32 v242, s88, v242
    v_mul_f32 v243, s88, v243
    v_cvt_pk_bf16_f32 v110, v240, v241
    v_cvt_pk_bf16_f32 v111, v242, v243
    v_accvgpr_read_b32 v232, a48
    v_accvgpr_read_b32 v233, a49
    v_mfma_f32_16x16x32_bf16 v[216:219], a[240:243], v[72:75], v[216:219]
    s_waitcnt lgkmcnt(3)
    v_accvgpr_read_b32 v234, a50
    v_accvgpr_read_b32 v235, a51
    v_mul_f32 v232, s88, v232
    v_mul_f32 v233, s88, v233
    v_mul_f32 v234, s88, v234
    v_mul_f32 v235, s88, v235
    v_mfma_f32_16x16x32_bf16 v[220:223], a[244:247], v[64:67], v[220:223]
    ds_read_b128 a[228:231], v1 offset:29600
    v_cvt_pk_bf16_f32 v112, v232, v233
    v_cvt_pk_bf16_f32 v113, v234, v235
    v_accvgpr_read_b32 v236, a60
    v_accvgpr_read_b32 v237, a61
    v_accvgpr_read_b32 v238, a62
    v_accvgpr_read_b32 v239, a63
    v_mfma_f32_16x16x32_bf16 v[224:227], a[244:247], v[68:71], v[224:227]
    v_mul_f32 v236, s88, v236
    v_mul_f32 v237, s88, v237
    v_mul_f32 v238, s88, v238
    v_mul_f32 v239, s88, v239
    v_cvt_pk_bf16_f32 v114, v236, v237
    v_cvt_pk_bf16_f32 v115, v238, v239
    v_mfma_f32_16x16x32_bf16 v[228:231], a[244:247], v[72:75], v[228:231]
    s_waitcnt lgkmcnt(3)
    v_accvgpr_read_b32 v240, a52
    v_accvgpr_read_b32 v241, a53
    v_accvgpr_read_b32 v242, a54
    v_accvgpr_read_b32 v243, a55
    v_mul_f32 v240, s88, v240
    v_mul_f32 v241, s88, v241
    v_mfma_f32_16x16x32_bf16 v[16:19], a[216:219], v[88:91], 0
    ds_read_b128 a[232:235], v1 offset:25632
    v_mul_f32 v242, s88, v242
    v_mul_f32 v243, s88, v243
    v_cvt_pk_bf16_f32 v116, v240, v241
    v_cvt_pk_bf16_f32 v117, v242, v243
    v_accvgpr_read_b32 v232, a64
    v_accvgpr_read_b32 v233, a65
    v_mfma_f32_16x16x32_bf16 v[20:23], a[216:219], v[92:95], 0
    v_accvgpr_read_b32 v234, a66
    v_accvgpr_read_b32 v235, a67
    v_mul_f32 v232, s88, v232
    v_mul_f32 v233, s88, v233
    v_mul_f32 v234, s88, v234
    v_mul_f32 v235, s88, v235
    v_mfma_f32_16x16x32_bf16 v[24:27], a[216:219], v[96:99], 0
    s_waitcnt lgkmcnt(3)
    v_cvt_pk_bf16_f32 v118, v232, v233
    v_cvt_pk_bf16_f32 v119, v234, v235
    v_accvgpr_read_b32 v236, a56
    v_accvgpr_read_b32 v237, a57
    v_accvgpr_read_b32 v238, a58
    v_accvgpr_read_b32 v239, a59
    v_mul_f32 v236, s88, v236
    v_mfma_f32_16x16x32_bf16 v[28:31], a[220:223], v[88:91], 0
    ds_read_b128 a[236:239], v1 offset:29856
    v_mul_f32 v237, s88, v237
    v_mul_f32 v238, s88, v238
    v_mul_f32 v239, s88, v239
    v_cvt_pk_bf16_f32 v120, v236, v237
    v_cvt_pk_bf16_f32 v121, v238, v239
    v_accvgpr_read_b32 v240, a68
    v_mfma_f32_16x16x32_bf16 v[32:35], a[220:223], v[92:95], 0
    v_accvgpr_read_b32 v241, a69
    v_accvgpr_read_b32 v242, a70
    v_accvgpr_read_b32 v243, a71
    v_mul_f32 v240, s88, v240
    v_mul_f32 v241, s88, v241
    v_mul_f32 v242, s88, v242
    v_mfma_f32_16x16x32_bf16 v[36:39], a[220:223], v[96:99], 0
    s_waitcnt lgkmcnt(3)
    v_mul_f32 v243, s88, v243
    v_cvt_pk_bf16_f32 v122, v240, v241
    v_cvt_pk_bf16_f32 v123, v242, v243
    v_accvgpr_read_b32 v232, a72
    v_accvgpr_read_b32 v233, a73
    v_accvgpr_read_b32 v234, a74
    v_mfma_f32_16x16x32_bf16 v[16:19], a[224:227], v[100:103], v[16:19]
    ds_read_b128 a[240:243], v1 offset:25888
    v_accvgpr_read_b32 v235, a75
    v_mul_f32 v232, s88, v232
    v_mul_f32 v233, s88, v233
    v_mul_f32 v234, s88, v234
    v_mul_f32 v235, s88, v235
    v_cvt_pk_bf16_f32 v124, v232, v233
    v_mfma_f32_16x16x32_bf16 v[20:23], a[224:227], v[104:107], v[20:23]
    v_cvt_pk_bf16_f32 v125, v234, v235
    v_accvgpr_read_b32 v236, a84
    v_accvgpr_read_b32 v237, a85
    v_accvgpr_read_b32 v238, a86
    v_accvgpr_read_b32 v239, a87
    v_mul_f32 v236, s88, v236
    v_mfma_f32_16x16x32_bf16 v[24:27], a[224:227], v[108:111], v[24:27]
    s_waitcnt lgkmcnt(3)
    v_mul_f32 v237, s88, v237
    v_mul_f32 v238, s88, v238
    v_mul_f32 v239, s88, v239
    v_cvt_pk_bf16_f32 v126, v236, v237
    v_cvt_pk_bf16_f32 v127, v238, v239
    v_accvgpr_read_b32 v240, a76
    v_accvgpr_read_b32 v241, a77
    v_mfma_f32_16x16x32_bf16 v[28:31], a[228:231], v[100:103], v[28:31]
    ds_read_b128 a[244:247], v1 offset:30112
    v_accvgpr_read_b32 v242, a78
    v_accvgpr_read_b32 v243, a79
    v_mul_f32 v240, s88, v240
    v_mul_f32 v241, s88, v241
    v_mul_f32 v242, s88, v242
    v_mul_f32 v243, s88, v243
    v_mfma_f32_16x16x32_bf16 v[32:35], a[228:231], v[104:107], v[32:35]
    v_cvt_pk_bf16_f32 v128, v240, v241
    v_cvt_pk_bf16_f32 v129, v242, v243
    v_accvgpr_read_b32 v232, a88
    v_accvgpr_read_b32 v233, a89
    v_accvgpr_read_b32 v234, a90
    v_accvgpr_read_b32 v235, a91
    v_mfma_f32_16x16x32_bf16 v[36:39], a[228:231], v[108:111], v[36:39]
    s_waitcnt lgkmcnt(3)
    v_mul_f32 v232, s88, v232
    v_mul_f32 v233, s88, v233
    v_mul_f32 v234, s88, v234
    v_mul_f32 v235, s88, v235
    v_cvt_pk_bf16_f32 v130, v232, v233
    v_cvt_pk_bf16_f32 v131, v234, v235
    v_mfma_f32_16x16x32_bf16 v[16:19], a[232:235], v[112:115], v[16:19]
    v_accvgpr_read_b32 v236, a80
    v_accvgpr_read_b32 v237, a81
    v_accvgpr_read_b32 v238, a82
    v_accvgpr_read_b32 v239, a83
    v_mul_f32 v236, s88, v236
    v_mul_f32 v237, s88, v237
    v_mfma_f32_16x16x32_bf16 v[20:23], a[232:235], v[116:119], v[20:23]
    v_mul_f32 v238, s88, v238
    v_mul_f32 v239, s88, v239
    v_cvt_pk_bf16_f32 v132, v236, v237
    v_cvt_pk_bf16_f32 v133, v238, v239
    v_accvgpr_read_b32 v240, a92
    v_accvgpr_read_b32 v241, a93
    v_mfma_f32_16x16x32_bf16 v[24:27], a[232:235], v[120:123], v[24:27]
    s_waitcnt lgkmcnt(2)
    v_accvgpr_read_b32 v242, a94
    v_accvgpr_read_b32 v243, a95
    v_mul_f32 v240, s88, v240
    v_mul_f32 v241, s88, v241
    v_mul_f32 v242, s88, v242
    v_mul_f32 v243, s88, v243
    v_cvt_pk_bf16_f32 v134, v240, v241
    v_cvt_pk_bf16_f32 v135, v242, v243
    v_add_u32 v1, s83, v1
    v_add_u32 v2, s83, v2
    v_add_u32 v3, s83, v3
    v_add_u32 v4, s99, v4
    v_add_u32 v10, s99, v10
    s_sub_u32 s83, 0, s83
    s_sub_u32 s99, 0, s99
    s_add_u32 s91, s91, 1
    s_cmp_lt_u32 s91, 3
    s_cbranch_scc1 L_A12
    v_mfma_f32_16x16x32_bf16 v[28:31], a[236:239], v[112:115], v[28:31]
    s_waitcnt vmcnt(15)
    s_barrier
    s_waitcnt lgkmcnt(0)
    v_mfma_f32_16x16x32_bf16 v[32:35], a[236:239], v[116:119], v[32:35]
    ds_read_b64_tr_b16 a[216:217], v2 offset:0
    v_mfma_f32_16x16x32_bf16 v[36:39], a[236:239], v[120:123], v[36:39]
    ds_read_b64_tr_b16 a[218:219], v2 offset:4224
    v_mfma_f32_16x16x32_bf16 v[16:19], a[240:243], v[124:127], v[16:19]
    ds_read_b64_tr_b16 a[220:221], v2 offset:32
    v_mfma_f32_16x16x32_bf16 v[20:23], a[240:243], v[128:131], v[20:23]
    ds_read_b64_tr_b16 a[222:223], v2 offset:4256
    v_mfma_f32_16x16x32_bf16 v[24:27], a[240:243], v[132:135], v[24:27]
    ds_read_b64_tr_b16 a[224:225], v2 offset:256
    v_mfma_f32_16x16x32_bf16 v[28:31], a[244:247], v[124:127], v[28:31]
    ds_read_b64_tr_b16 a[226:227], v2 offset:4480
    s_nop 0
    v_exp_f32 v16, v16
    v_exp_f32 v17, v17
    v_exp_f32 v18, v18
    v_exp_f32 v19, v19
    v_mfma_f32_16x16x32_bf16 v[32:35], a[244:247], v[128:131], v[32:35]
    ds_read_b64_tr_b16 a[228:229], v2 offset:288
    v_mov_b32 v11, v16
    v_exp_f32 v20, v20
    v_exp_f32 v21, v21
    v_add_f32 v11, v17, v11
    v_exp_f32 v22, v22
    v_cvt_pk_bf16_f32 v64, v16, v17
    v_add_f32 v11, v18, v11
    v_exp_f32 v23, v23
    v_add_f32 v11, v19, v11
    v_cvt_pk_bf16_f32 v65, v18, v19
    v_mfma_f32_16x16x32_bf16 v[36:39], a[244:247], v[132:135], v[36:39]
    ds_read_b64_tr_b16 a[230:231], v2 offset:4512
    v_mov_b32 v12, v20
    v_exp_f32 v24, v24
    v_exp_f32 v25, v25
    v_add_f32 v12, v21, v12
    v_exp_f32 v26, v26
    v_cvt_pk_bf16_f32 v68, v20, v21
    v_add_f32 v12, v22, v12
    v_exp_f32 v27, v27
    v_add_f32 v12, v23, v12
    v_cvt_pk_bf16_f32 v69, v22, v23
    s_waitcnt lgkmcnt(6)
    v_mfma_f32_16x16x32_bf16 v[136:139], a[216:219], v[76:79], v[136:139]
    ds_read_b64_tr_b16 a[232:233], v2 offset:512
    v_mov_b32 v13, v24
    v_exp_f32 v28, v28
    v_exp_f32 v29, v29
    v_add_f32 v13, v25, v13
    v_exp_f32 v30, v30
    v_cvt_pk_bf16_f32 v72, v24, v25
    v_add_f32 v13, v26, v13
    v_exp_f32 v31, v31
    v_add_f32 v13, v27, v13
    v_cvt_pk_bf16_f32 v73, v26, v27
    v_mfma_f32_16x16x32_bf16 v[140:143], a[216:219], v[80:83], v[140:143]
    ds_read_b64_tr_b16 a[234:235], v2 offset:4736
    v_add_f32 v11, v28, v11
    v_exp_f32 v32, v32
    v_exp_f32 v33, v33
    v_add_f32 v11, v29, v11
    v_exp_f32 v34, v34
    v_cvt_pk_bf16_f32 v66, v28, v29
    v_add_f32 v11, v30, v11
    v_exp_f32 v35, v35
    v_add_f32 v11, v31, v11
    v_cvt_pk_bf16_f32 v67, v30, v31
    v_mfma_f32_16x16x32_bf16 v[144:147], a[216:219], v[84:87], v[144:147]
    s_add_u32 m0, s46, s74
    s_waitcnt lgkmcnt(6)
    buffer_load_dwordx4 v5, s[12:15], s43 offen nt lds
    v_exp_f32 v36, v36
    v_add_f32 v12, v32, v12
    v_exp_f32 v37, v37
    v_add_f32 v12, v33, v12
    v_mfma_f32_16x16x32_bf16 v[148:151], a[220:223], v[76:79], v[148:151]
    ds_read_b64_tr_b16 a[236:237], v2 offset:544
    v_mul_f32 v232, v136, v248
    v_mul_f32 v233, v137, v248
    v_mul_f32 v234, v138, v248
    v_mul_f32 v235, v139, v248
    v_cvt_pk_bf16_f32 v236, v232, v233
    v_cvt_pk_bf16_f32 v237, v234, v235
    v_mfma_f32_16x16x32_bf16 v[152:155], a[220:223], v[80:83], v[152:155]
    ds_read_b64_tr_b16 a[238:239], v2 offset:4768
    v_accvgpr_write_b32 a0, v236
    v_accvgpr_write_b32 a1, v237
    v_mul_f32 v238, v140, v249
    v_mul_f32 v239, v141, v249
    v_mul_f32 v240, v142, v249
    v_mul_f32 v241, v143, v249
    v_mfma_f32_16x16x32_bf16 v[156:159], a[220:223], v[84:87], v[156:159]
    s_waitcnt lgkmcnt(6)
    buffer_load_dwordx4 v247, s[12:15], s43 offen offset:1056 nt lds
    v_cvt_pk_bf16_f32 v242, v238, v239
    v_cvt_pk_bf16_f32 v243, v240, v241
    v_accvgpr_write_b32 a4, v242
    v_accvgpr_write_b32 a5, v243
    v_mul_f32 v232, v144, v250
    v_mul_f32 v233, v145, v250
    v_mfma_f32_16x16x32_bf16 v[160:163], a[224:227], v[76:79], v[160:163]
    ds_read_b64_tr_b16 a[240:241], v2 offset:768
    v_mul_f32 v234, v146, v250
    v_mul_f32 v235, v147, v250
    v_cvt_pk_bf16_f32 v236, v232, v233
    v_cvt_pk_bf16_f32 v237, v234, v235
    v_accvgpr_write_b32 a8, v236
    v_accvgpr_write_b32 a9, v237
    v_mfma_f32_16x16x32_bf16 v[164:167], a[224:227], v[80:83], v[164:167]
    ds_read_b64_tr_b16 a[242:243], v2 offset:4992
    v_mul_f32 v238, v148, v248
    v_mul_f32 v239, v149, v248
    v_mul_f32 v240, v150, v248
    v_mul_f32 v241, v151, v248
    v_cvt_pk_bf16_f32 v242, v238, v239
    v_cvt_pk_bf16_f32 v243, v240, v241
    v_mfma_f32_16x16x32_bf16 v[168:171], a[224:227], v[84:87], v[168:171]
    s_waitcnt lgkmcnt(6)
    v_exp_f32 v38, v38
    v_accvgpr_write_b32 a2, v242
    v_accvgpr_write_b32 a3, v243
    v_mul_f32 v232, v152, v249
    v_mul_f32 v233, v153, v249
    v_mfma_f32_16x16x32_bf16 v[172:175], a[228:231], v[76:79], v[172:175]
    ds_read_b64_tr_b16 a[244:245], v2 offset:800
    v_mul_f32 v234, v154, v249
    v_mul_f32 v235, v155, v249
    v_cvt_pk_bf16_f32 v236, v232, v233
    v_cvt_pk_bf16_f32 v237, v234, v235
    v_accvgpr_write_b32 a6, v236
    v_accvgpr_write_b32 a7, v237
    v_mfma_f32_16x16x32_bf16 v[176:179], a[228:231], v[80:83], v[176:179]
    ds_read_b64_tr_b16 a[246:247], v2 offset:5024
    v_mul_f32 v238, v156, v250
    v_mul_f32 v239, v157, v250
    v_mul_f32 v240, v158, v250
    v_mul_f32 v241, v159, v250
    v_cvt_pk_bf16_f32 v242, v238, v239
    v_cvt_pk_bf16_f32 v243, v240, v241
    v_mfma_f32_16x16x32_bf16 v[180:183], a[228:231], v[84:87], v[180:183]
    s_waitcnt lgkmcnt(6)
    v_exp_f32 v39, v39
    v_accvgpr_write_b32 a10, v242
    v_accvgpr_write_b32 a11, v243
    v_mul_f32 v232, v160, v248
    v_mul_f32 v233, v161, v248
    v_mfma_f32_16x16x32_bf16 v[184:187], a[232:235], v[76:79], v[184:187]
    ds_read_b128 a[216:219], v1 offset:0
    v_mul_f32 v234, v162, v248
    v_mul_f32 v235, v163, v248
    v_cvt_pk_bf16_f32 v236, v232, v233
    v_cvt_pk_bf16_f32 v237, v234, v235
    v_accvgpr_write_b32 a12, v236
    v_accvgpr_write_b32 a13, v237
    v_mfma_f32_16x16x32_bf16 v[188:191], a[232:235], v[80:83], v[188:191]
    s_add_u32 m0, s46, s76
    s_nop 0
    buffer_load_dwordx4 v5, s[16:19], s43 offen nt lds
    v_mul_f32 v238, v164, v249
    v_mul_f32 v239, v165, v249
    v_mul_f32 v240, v166, v249
    v_mul_f32 v241, v167, v249
    v_cvt_pk_bf16_f32 v242, v238, v239
    v_mfma_f32_16x16x32_bf16 v[192:195], a[232:235], v[84:87], v[192:195]
    s_waitcnt lgkmcnt(5)
    v_cvt_pk_bf16_f32 v243, v240, v241
    v_accvgpr_write_b32 a16, v242
    v_accvgpr_write_b32 a17, v243
    v_mul_f32 v232, v168, v250
    v_mul_f32 v233, v169, v250
    v_mul_f32 v234, v170, v250
    v_mfma_f32_16x16x32_bf16 v[196:199], a[236:239], v[76:79], v[196:199]
    ds_read_b128 a[220:223], v1 offset:256
    v_mul_f32 v235, v171, v250
    v_cvt_pk_bf16_f32 v236, v232, v233
    v_cvt_pk_bf16_f32 v237, v234, v235
    v_accvgpr_write_b32 a20, v236
    v_accvgpr_write_b32 a21, v237
    v_mul_f32 v238, v172, v248
    v_mfma_f32_16x16x32_bf16 v[200:203], a[236:239], v[80:83], v[200:203]
    v_mul_f32 v239, v173, v248
    v_mul_f32 v240, v174, v248
    v_mul_f32 v241, v175, v248
    v_cvt_pk_bf16_f32 v242, v238, v239
    v_cvt_pk_bf16_f32 v243, v240, v241
    v_accvgpr_write_b32 a14, v242
    v_mfma_f32_16x16x32_bf16 v[204:207], a[236:239], v[84:87], v[204:207]
    s_waitcnt lgkmcnt(4)
    v_accvgpr_write_b32 a15, v243
    v_mul_f32 v232, v176, v249
    v_mul_f32 v233, v177, v249
    v_mul_f32 v234, v178, v249
    v_mul_f32 v235, v179, v249
    v_cvt_pk_bf16_f32 v236, v232, v233
    v_mfma_f32_16x16x32_bf16 v[208:211], a[240:243], v[76:79], v[208:211]
    ds_read_b128 a[224:227], v1 offset:512
    v_cvt_pk_bf16_f32 v237, v234, v235
    v_accvgpr_write_b32 a18, v236
    v_accvgpr_write_b32 a19, v237
    v_mul_f32 v238, v180, v250
    v_mul_f32 v239, v181, v250
    v_mul_f32 v240, v182, v250
    v_mfma_f32_16x16x32_bf16 v[212:215], a[240:243], v[80:83], v[212:215]
    v_mul_f32 v241, v183, v250
    v_cvt_pk_bf16_f32 v242, v238, v239
    v_cvt_pk_bf16_f32 v243, v240, v241
    v_accvgpr_write_b32 a22, v242
    v_accvgpr_write_b32 a23, v243
    v_mul_f32 v232, v184, v248
    v_mfma_f32_16x16x32_bf16 v[216:219], a[240:243], v[84:87], v[216:219]
    s_waitcnt lgkmcnt(3)
    v_mul_f32 v233, v185, v248
    v_mul_f32 v234, v186, v248
    v_mul_f32 v235, v187, v248
    v_cvt_pk_bf16_f32 v236, v232, v233
    v_cvt_pk_bf16_f32 v237, v234, v235
    v_accvgpr_write_b32 a24, v236
    v_mfma_f32_16x16x32_bf16 v[220:223], a[244:247], v[76:79], v[220:223]
    ds_read_b128 a[228:231], v1 offset:768
    v_accvgpr_write_b32 a25, v237
    v_mul_f32 v238, v188, v249
    v_mul_f32 v239, v189, v249
    v_mul_f32 v240, v190, v249
    v_mul_f32 v241, v191, v249
    v_cvt_pk_bf16_f32 v242, v238, v239
    v_mfma_f32_16x16x32_bf16 v[224:227], a[244:247], v[80:83], v[224:227]
    s_xor_b32 s46, s46, 83008
    buffer_load_dwordx4 v247, s[16:19], s43 offen offset:1056 nt lds
    v_cvt_pk_bf16_f32 v243, v240, v241
    v_accvgpr_write_b32 a28, v242
    v_accvgpr_write_b32 a29, v243
    v_mul_f32 v232, v192, v250
    v_mul_f32 v233, v193, v250
    v_mul_f32 v234, v194, v250
    v_mfma_f32_16x16x32_bf16 v[228:231], a[244:247], v[84:87], v[228:231]
    s_waitcnt lgkmcnt(3)
    v_mul_f32 v235, v195, v250
    v_cvt_pk_bf16_f32 v236, v232, v233
    v_cvt_pk_bf16_f32 v237, v234, v235
    v_accvgpr_write_b32 a32, v236
    v_accvgpr_write_b32 a33, v237
    v_mul_f32 v238, v196, v248
    v_mfma_f32_16x16x32_bf16 v[40:43], a[216:219], v[88:91], 0
    ds_read_b128 a[232:235], v1 offset:4224
    v_mul_f32 v239, v197, v248
    v_mul_f32 v240, v198, v248
    v_mul_f32 v241, v199, v248
    v_cvt_pk_bf16_f32 v242, v238, v239
    v_cvt_pk_bf16_f32 v243, v240, v241
    v_accvgpr_write_b32 a26, v242
    v_mfma_f32_16x16x32_bf16 v[44:47], a[216:219], v[92:95], 0
    v_accvgpr_write_b32 a27, v243
    v_mul_f32 v232, v200, v249
    v_mul_f32 v233, v201, v249
    v_mul_f32 v234, v202, v249
    v_mul_f32 v235, v203, v249
    v_cvt_pk_bf16_f32 v236, v232, v233
    v_mfma_f32_16x16x32_bf16 v[48:51], a[216:219], v[96:99], 0
    s_waitcnt lgkmcnt(3)
    v_cvt_pk_bf16_f32 v237, v234, v235
    v_accvgpr_write_b32 a30, v236
    v_accvgpr_write_b32 a31, v237
    v_mul_f32 v238, v204, v250
    v_mul_f32 v239, v205, v250
    v_mul_f32 v240, v206, v250
    v_mfma_f32_16x16x32_bf16 v[40:43], a[220:223], v[100:103], v[40:43]
    ds_read_b128 a[236:239], v1 offset:4480
    v_mul_f32 v241, v207, v250
    v_cvt_pk_bf16_f32 v242, v238, v239
    v_cvt_pk_bf16_f32 v243, v240, v241
    v_accvgpr_write_b32 a34, v242
    v_accvgpr_write_b32 a35, v243
    v_mul_f32 v232, v208, v248
    v_mfma_f32_16x16x32_bf16 v[44:47], a[220:223], v[104:107], v[44:47]
    v_mul_f32 v233, v209, v248
    v_mul_f32 v234, v210, v248
    v_cvt_pk_bf16_f32 v70, v32, v33
    v_mul_f32 v235, v211, v248
    v_cvt_pk_bf16_f32 v236, v232, v233
    v_cvt_pk_bf16_f32 v237, v234, v235
    v_mfma_f32_16x16x32_bf16 v[48:51], a[220:223], v[108:111], v[48:51]
    s_waitcnt lgkmcnt(3)
    v_add_f32 v12, v34, v12
    v_accvgpr_write_b32 a36, v236
    v_accvgpr_write_b32 a37, v237
    v_mul_f32 v238, v212, v249
    v_mul_f32 v239, v213, v249
    v_mul_f32 v240, v214, v249
    v_mfma_f32_16x16x32_bf16 v[40:43], a[224:227], v[112:115], v[40:43]
    ds_read_b128 a[240:243], v1 offset:4736
    v_mul_f32 v241, v215, v249
    v_cvt_pk_bf16_f32 v242, v238, v239
    v_cvt_pk_bf16_f32 v243, v240, v241
    v_accvgpr_write_b32 a40, v242
    v_accvgpr_write_b32 a41, v243
    v_mul_f32 v232, v216, v250
    v_mfma_f32_16x16x32_bf16 v[44:47], a[224:227], v[116:119], v[44:47]
    v_mul_f32 v233, v217, v250
    v_mul_f32 v234, v218, v250
    v_mul_f32 v235, v219, v250
    v_cvt_pk_bf16_f32 v236, v232, v233
    v_cvt_pk_bf16_f32 v237, v234, v235
    v_accvgpr_write_b32 a44, v236
    v_mfma_f32_16x16x32_bf16 v[48:51], a[224:227], v[120:123], v[48:51]
    s_waitcnt lgkmcnt(3)
    v_accvgpr_write_b32 a45, v237
    v_mul_f32 v238, v220, v248
    v_mul_f32 v239, v221, v248
    v_mul_f32 v240, v222, v248
    v_mul_f32 v241, v223, v248
    v_cvt_pk_bf16_f32 v242, v238, v239
    v_mfma_f32_16x16x32_bf16 v[40:43], a[228:231], v[124:127], v[40:43]
    ds_read_b128 a[244:247], v1 offset:4992
    v_cvt_pk_bf16_f32 v243, v240, v241
    v_accvgpr_write_b32 a38, v242
    v_accvgpr_write_b32 a39, v243
    v_mul_f32 v232, v224, v249
    v_mul_f32 v233, v225, v249
    v_mul_f32 v234, v226, v249
    v_mfma_f32_16x16x32_bf16 v[44:47], a[228:231], v[128:131], v[44:47]
    v_mul_f32 v235, v227, v249
    v_cvt_pk_bf16_f32 v236, v232, v233
    v_cvt_pk_bf16_f32 v237, v234, v235
    v_accvgpr_write_b32 a42, v236
    v_accvgpr_write_b32 a43, v237
    v_mul_f32 v238, v228, v250
    v_mfma_f32_16x16x32_bf16 v[48:51], a[228:231], v[132:135], v[48:51]
    s_waitcnt lgkmcnt(3)
    v_mul_f32 v239, v229, v250
    v_mul_f32 v240, v230, v250
    v_mul_f32 v241, v231, v250
    v_cvt_pk_bf16_f32 v242, v238, v239
    v_cvt_pk_bf16_f32 v243, v240, v241
    v_accvgpr_write_b32 a46, v242
    v_accvgpr_write_b32 a47, v243
    s_add_u32 s43, s43, 8192
    v_mfma_f32_16x16x32_bf16 v[52:55], a[232:235], v[88:91], 0
    s_waitcnt vmcnt(13)
    s_barrier
    s_waitcnt lgkmcnt(2)
    v_mfma_f32_16x16x32_bf16 v[56:59], a[232:235], v[92:95], 0
    ds_read_b64_tr_b16 a[216:217], v2 offset:25120
    v_add_f32 v12, v35, v12
    v_mfma_f32_16x16x32_bf16 v[60:63], a[232:235], v[96:99], 0
    ds_read_b64_tr_b16 a[218:219], v2 offset:29344
    v_cvt_pk_bf16_f32 v71, v34, v35
    v_mfma_f32_16x16x32_bf16 v[52:55], a[236:239], v[100:103], v[52:55]
    ds_read_b128 a[220:223], v1 offset:25120
    v_add_f32 v13, v36, v13
    v_mfma_f32_16x16x32_bf16 v[56:59], a[236:239], v[104:107], v[56:59]
    s_add_u32 m0, s47, s74
    s_nop 0
    buffer_load_dwordx4 v5, s[12:15], s43 offen nt lds
    v_mfma_f32_16x16x32_bf16 v[60:63], a[236:239], v[108:111], v[60:63]
    s_waitcnt lgkmcnt(4)
    v_exp_f32 v40, v40
    v_mfma_f32_16x16x32_bf16 v[52:55], a[240:243], v[112:115], v[52:55]
    ds_read_b64_tr_b16 a[224:225], v2 offset:25152
    v_add_f32 v13, v37, v13
    v_mfma_f32_16x16x32_bf16 v[56:59], a[240:243], v[116:119], v[56:59]
    ds_read_b64_tr_b16 a[226:227], v2 offset:29376
    v_cvt_pk_bf16_f32 v74, v36, v37
    v_mfma_f32_16x16x32_bf16 v[60:63], a[240:243], v[120:123], v[60:63]
    s_waitcnt lgkmcnt(5)
    v_exp_f32 v41, v41
    v_mfma_f32_16x16x32_bf16 v[52:55], a[244:247], v[124:127], v[52:55]
    ds_read_b128 a[228:231], v1 offset:25376
    v_add_f32 v13, v38, v13
    v_mfma_f32_16x16x32_bf16 v[56:59], a[244:247], v[128:131], v[56:59]
    v_exp_f32 v42, v42
    v_mfma_f32_16x16x32_bf16 v[60:63], a[244:247], v[132:135], v[60:63]
    s_waitcnt lgkmcnt(4)
    v_exp_f32 v43, v43
    v_mfma_f32_16x16x32_bf16 v[136:139], a[216:219], v[64:67], 0
    ds_read_b64_tr_b16 a[232:233], v2 offset:25376
    v_exp_f32 v44, v44
    v_mfma_f32_16x16x32_bf16 v[140:143], a[216:219], v[68:71], 0
    ds_read_b64_tr_b16 a[234:235], v2 offset:29600
    v_add_f32 v13, v39, v13
    v_cvt_pk_bf16_f32 v75, v38, v39
    s_nop 1
    v_mfma_f32_16x16x32_bf16 v[144:147], a[216:219], v[72:75], 0
    s_waitcnt lgkmcnt(5)
    buffer_load_dwordx4 v247, s[12:15], s43 offen offset:1056 nt lds
    v_mfma_f32_16x16x32_bf16 v[16:19], a[220:223], v[88:91], 0
    ds_read_b128 a[236:239], v1 offset:25632
    v_add_f32 v11, v40, v11
    v_mfma_f32_16x16x32_bf16 v[20:23], a[220:223], v[92:95], 0
    v_exp_f32 v45, v45
    v_mfma_f32_16x16x32_bf16 v[24:27], a[220:223], v[96:99], 0
    s_waitcnt lgkmcnt(4)
    v_exp_f32 v46, v46
    v_mfma_f32_16x16x32_bf16 v[148:151], a[224:227], v[64:67], 0
    ds_read_b64_tr_b16 a[240:241], v2 offset:25408
    v_exp_f32 v47, v47
    v_mfma_f32_16x16x32_bf16 v[152:155], a[224:227], v[68:71], 0
    ds_read_b64_tr_b16 a[242:243], v2 offset:29632
    v_add_f32 v11, v41, v11
    v_mfma_f32_16x16x32_bf16 v[156:159], a[224:227], v[72:75], 0
    s_waitcnt lgkmcnt(5)
    v_exp_f32 v48, v48
    v_mfma_f32_16x16x32_bf16 v[16:19], a[228:231], v[100:103], v[16:19]
    ds_read_b128 a[244:247], v1 offset:25888
    v_cvt_pk_bf16_f32 v76, v40, v41
    v_mfma_f32_16x16x32_bf16 v[20:23], a[228:231], v[104:107], v[20:23]
    s_add_u32 m0, s47, s76
    s_nop 0
    buffer_load_dwordx4 v5, s[16:19], s43 offen nt lds
    v_mfma_f32_16x16x32_bf16 v[24:27], a[228:231], v[108:111], v[24:27]
    s_waitcnt lgkmcnt(4)
    v_exp_f32 v49, v49
    v_mfma_f32_16x16x32_bf16 v[160:163], a[232:235], v[64:67], 0
    ds_read_b64_tr_b16 a[216:217], v2 offset:25632
    v_exp_f32 v50, v50
    v_mfma_f32_16x16x32_bf16 v[164:167], a[232:235], v[68:71], 0
    ds_read_b64_tr_b16 a[218:219], v2 offset:29856
    v_add_f32 v11, v42, v11
    v_mfma_f32_16x16x32_bf16 v[168:171], a[232:235], v[72:75], 0
    s_waitcnt lgkmcnt(5)
    v_exp_f32 v51, v51
    v_mfma_f32_16x16x32_bf16 v[16:19], a[236:239], v[112:115], v[16:19]
    ds_read_b64_tr_b16 a[220:221], v2 offset:25664
    v_add_f32 v11, v43, v11
    v_mfma_f32_16x16x32_bf16 v[20:23], a[236:239], v[116:119], v[20:23]
    ds_read_b64_tr_b16 a[222:223], v2 offset:29888
    v_exp_f32 v52, v52
    v_mfma_f32_16x16x32_bf16 v[24:27], a[236:239], v[120:123], v[24:27]
    s_waitcnt lgkmcnt(5)
    v_exp_f32 v53, v53
    v_mfma_f32_16x16x32_bf16 v[172:175], a[240:243], v[64:67], 0
    ds_read_b64_tr_b16 a[224:225], v2 offset:25888
    v_cvt_pk_bf16_f32 v77, v42, v43
    v_mfma_f32_16x16x32_bf16 v[176:179], a[240:243], v[68:71], 0
    ds_read_b64_tr_b16 a[226:227], v2 offset:30112
    v_add_f32 v12, v44, v12
    v_mfma_f32_16x16x32_bf16 v[180:183], a[240:243], v[72:75], 0
    s_xor_b32 s47, s47, 50240
    s_waitcnt lgkmcnt(6)
    buffer_load_dwordx4 v247, s[16:19], s43 offen offset:1056 nt lds
    v_mfma_f32_16x16x32_bf16 v[16:19], a[244:247], v[124:127], v[16:19]
    ds_read_b64_tr_b16 a[228:229], v2 offset:25920
    v_exp_f32 v54, v54
    v_mfma_f32_16x16x32_bf16 v[20:23], a[244:247], v[128:131], v[20:23]
    ds_read_b64_tr_b16 a[230:231], v2 offset:30144
    v_add_f32 v12, v45, v12
    v_mfma_f32_16x16x32_bf16 v[24:27], a[244:247], v[132:135], v[24:27]
    s_waitcnt lgkmcnt(6)
    v_exp_f32 v55, v55
    v_mfma_f32_16x16x32_bf16 v[184:187], a[216:219], v[64:67], 0
    ds_read_b128 a[232:235], v1 offset:29344
    v_cvt_pk_bf16_f32 v80, v44, v45
    v_mfma_f32_16x16x32_bf16 v[188:191], a[216:219], v[68:71], 0
    v_exp_f32 v56, v56
    v_mfma_f32_16x16x32_bf16 v[192:195], a[216:219], v[72:75], 0
    s_waitcnt lgkmcnt(5)
    v_exp_f32 v57, v57
    v_mfma_f32_16x16x32_bf16 v[196:199], a[220:223], v[64:67], 0
    ds_read_b128 a[236:239], v1 offset:29600
    v_add_f32 v12, v46, v12
    v_mfma_f32_16x16x32_bf16 v[200:203], a[220:223], v[68:71], 0
    v_exp_f32 v58, v58
    v_mfma_f32_16x16x32_bf16 v[204:207], a[220:223], v[72:75], 0
    s_waitcnt lgkmcnt(4)
    v_exp_f32 v59, v59
    v_mfma_f32_16x16x32_bf16 v[208:211], a[224:227], v[64:67], 0
    ds_read_b128 a[240:243], v1 offset:29856
    v_add_f32 v12, v47, v12
    v_mfma_f32_16x16x32_bf16 v[212:215], a[224:227], v[68:71], 0
    v_exp_f32 v60, v60
    v_mfma_f32_16x16x32_bf16 v[216:219], a[224:227], v[72:75], 0
    s_waitcnt lgkmcnt(3)
    v_exp_f32 v61, v61
    v_mfma_f32_16x16x32_bf16 v[220:223], a[228:231], v[64:67], 0
    ds_read_b128 a[244:247], v1 offset:30112
    v_cvt_pk_bf16_f32 v81, v46, v47
    v_mfma_f32_16x16x32_bf16 v[224:227], a[228:231], v[68:71], 0
    v_exp_f32 v62, v62
    v_mfma_f32_16x16x32_bf16 v[228:231], a[228:231], v[72:75], 0
    s_waitcnt lgkmcnt(3)
    v_exp_f32 v63, v63
    v_add_f32 v13, v48, v13
    v_add_f32 v13, v49, v13
    v_cvt_pk_bf16_f32 v84, v48, v49
    v_add_f32 v13, v50, v13
    v_add_f32 v13, v51, v13
    v_cvt_pk_bf16_f32 v85, v50, v51
    v_add_f32 v11, v52, v11
    v_add_f32 v11, v53, v11
    v_cvt_pk_bf16_f32 v78, v52, v53
    v_add_f32 v11, v54, v11
    v_add_f32 v11, v55, v11
    v_cvt_pk_bf16_f32 v79, v54, v55
    v_add_f32 v12, v56, v12
    v_add_f32 v12, v57, v12
    v_cvt_pk_bf16_f32 v82, v56, v57
    v_add_f32 v12, v58, v12
    s_add_u32 s43, s43, 8192
    v_add_u32 v1, s83, v1
    v_add_u32 v2, s83, v2
    s_sub_u32 s83, 0, s83
    s_mov_b32 s90, 6
L_B3:
    v_mfma_f32_16x16x32_bf16 v[28:31], a[232:235], v[88:91], 0
    s_waitcnt vmcnt(8)
    s_barrier
    s_waitcnt lgkmcnt(2)
    v_mfma_f32_16x16x32_bf16 v[32:35], a[232:235], v[92:95], 0
    ds_read_b64_tr_b16 a[216:217], v2 offset:0
    v_add_f32 v12, v59, v12
    v_mfma_f32_16x16x32_bf16 v[36:39], a[232:235], v[96:99], 0
    ds_read_b64_tr_b16 a[218:219], v2 offset:4224
    v_cvt_pk_bf16_f32 v83, v58, v59
    v_mfma_f32_16x16x32_bf16 v[28:31], a[236:239], v[100:103], v[28:31]
    ds_read_b128 a[220:223], v1 offset:0
    v_add_f32 v13, v60, v13
    v_mfma_f32_16x16x32_bf16 v[32:35], a[236:239], v[104:107], v[32:35]
    s_add_u32 m0, s46, s74
    s_nop 0
    buffer_load_dwordx4 v5, s[12:15], s43 offen nt lds
    v_mfma_f32_16x16x32_bf16 v[36:39], a[236:239], v[108:111], v[36:39]
    s_waitcnt lgkmcnt(4)
    v_exp_f32 v16, v16
    v_mfma_f32_16x16x32_bf16 v[28:31], a[240:243], v[112:115], v[28:31]
    ds_read_b64_tr_b16 a[224:225], v2 offset:32
    v_add_f32 v13, v61, v13
    v_mfma_f32_16x16x32_bf16 v[32:35], a[240:243], v[116:119], v[32:35]
    ds_read_b64_tr_b16 a[226:227], v2 offset:4256
    v_cvt_pk_bf16_f32 v86, v60, v61
    v_mfma_f32_16x16x32_bf16 v[36:39], a[240:243], v[120:123], v[36:39]
    s_waitcnt lgkmcnt(5)
    v_exp_f32 v17, v17
    v_mfma_f32_16x16x32_bf16 v[28:31], a[244:247], v[124:127], v[28:31]
    ds_read_b128 a[228:231], v1 offset:256
    v_add_f32 v13, v62, v13
    v_mfma_f32_16x16x32_bf16 v[32:35], a[244:247], v[128:131], v[32:35]
    v_exp_f32 v18, v18
    v_mfma_f32_16x16x32_bf16 v[36:39], a[244:247], v[132:135], v[36:39]
    s_waitcnt lgkmcnt(4)
    v_exp_f32 v19, v19
    v_mfma_f32_16x16x32_bf16 v[136:139], a[216:219], v[76:79], v[136:139]
    ds_read_b64_tr_b16 a[232:233], v2 offset:256
    v_exp_f32 v20, v20
    v_mfma_f32_16x16x32_bf16 v[140:143], a[216:219], v[80:83], v[140:143]
    ds_read_b64_tr_b16 a[234:235], v2 offset:4480
    v_add_f32 v13, v63, v13
    v_cvt_pk_bf16_f32 v87, v62, v63
    s_nop 1
    v_mfma_f32_16x16x32_bf16 v[144:147], a[216:219], v[84:87], v[144:147]
    s_waitcnt lgkmcnt(5)
    buffer_load_dwordx4 v247, s[12:15], s43 offen offset:1056 nt lds
    v_mfma_f32_16x16x32_bf16 v[40:43], a[220:223], v[88:91], 0
    ds_read_b128 a[236:239], v1 offset:512
    v_add_f32 v11, v16, v11
    v_mfma_f32_16x16x32_bf16 v[44:47], a[220:223], v[92:95], 0
    v_exp_f32 v21, v21
    v_mfma_f32_16x16x32_bf16 v[48:51], a[220:223], v[96:99], 0
    s_waitcnt lgkmcnt(4)
    v_exp_f32 v22, v22
    v_mfma_f32_16x16x32_bf16 v[148:151], a[224:227], v[76:79], v[148:151]
    ds_read_b64_tr_b16 a[240:241], v2 offset:288
    v_exp_f32 v23, v23
    v_mfma_f32_16x16x32_bf16 v[152:155], a[224:227], v[80:83], v[152:155]
    ds_read_b64_tr_b16 a[242:243], v2 offset:4512
    v_add_f32 v11, v17, v11
    v_mfma_f32_16x16x32_bf16 v[156:159], a[224:227], v[84:87], v[156:159]
    s_waitcnt lgkmcnt(5)
    v_exp_f32 v24, v24
    v_mfma_f32_16x16x32_bf16 v[40:43], a[228:231], v[100:103], v[40:43]
    ds_read_b128 a[244:247], v1 offset:768
    v_cvt_pk_bf16_f32 v64, v16, v17
    v_mfma_f32_16x16x32_bf16 v[44:47], a[228:231], v[104:107], v[44:47]
    s_add_u32 m0, s46, s76
    s_nop 0
    buffer_load_dwordx4 v5, s[16:19], s43 offen nt lds
    v_mfma_f32_16x16x32_bf16 v[48:51], a[228:231], v[108:111], v[48:51]
    s_waitcnt lgkmcnt(4)
    v_exp_f32 v25, v25
    v_mfma_f32_16x16x32_bf16 v[160:163], a[232:235], v[76:79], v[160:163]
    ds_read_b64_tr_b16 a[216:217], v2 offset:512
    v_exp_f32 v26, v26
    v_mfma_f32_16x16x32_bf16 v[164:167], a[232:235], v[80:83], v[164:167]
    ds_read_b64_tr_b16 a[218:219], v2 offset:4736
    v_add_f32 v11, v18, v11
    v_mfma_f32_16x16x32_bf16 v[168:171], a[232:235], v[84:87], v[168:171]
    s_waitcnt lgkmcnt(5)
    v_exp_f32 v27, v27
    v_mfma_f32_16x16x32_bf16 v[40:43], a[236:239], v[112:115], v[40:43]
    ds_read_b64_tr_b16 a[220:221], v2 offset:544
    v_add_f32 v11, v19, v11
    v_mfma_f32_16x16x32_bf16 v[44:47], a[236:239], v[116:119], v[44:47]
    ds_read_b64_tr_b16 a[222:223], v2 offset:4768
    v_exp_f32 v28, v28
    v_mfma_f32_16x16x32_bf16 v[48:51], a[236:239], v[120:123], v[48:51]
    s_waitcnt lgkmcnt(5)
    v_exp_f32 v29, v29
    v_mfma_f32_16x16x32_bf16 v[172:175], a[240:243], v[76:79], v[172:175]
    ds_read_b64_tr_b16 a[224:225], v2 offset:768
    v_cvt_pk_bf16_f32 v65, v18, v19
    v_mfma_f32_16x16x32_bf16 v[176:179], a[240:243], v[80:83], v[176:179]
    ds_read_b64_tr_b16 a[226:227], v2 offset:4992
    v_add_f32 v12, v20, v12
    v_mfma_f32_16x16x32_bf16 v[180:183], a[240:243], v[84:87], v[180:183]
    s_xor_b32 s46, s46, 83008
    s_waitcnt lgkmcnt(6)
    buffer_load_dwordx4 v247, s[16:19], s43 offen offset:1056 nt lds
    v_mfma_f32_16x16x32_bf16 v[40:43], a[244:247], v[124:127], v[40:43]
    ds_read_b64_tr_b16 a[228:229], v2 offset:800
    v_exp_f32 v30, v30
    v_mfma_f32_16x16x32_bf16 v[44:47], a[244:247], v[128:131], v[44:47]
    ds_read_b64_tr_b16 a[230:231], v2 offset:5024
    v_add_f32 v12, v21, v12
    v_mfma_f32_16x16x32_bf16 v[48:51], a[244:247], v[132:135], v[48:51]
    s_waitcnt lgkmcnt(6)
    v_exp_f32 v31, v31
    v_mfma_f32_16x16x32_bf16 v[184:187], a[216:219], v[76:79], v[184:187]
    ds_read_b128 a[232:235], v1 offset:4224
    v_cvt_pk_bf16_f32 v68, v20, v21
    v_mfma_f32_16x16x32_bf16 v[188:191], a[216:219], v[80:83], v[188:191]
    v_exp_f32 v32, v32
    v_mfma_f32_16x16x32_bf16 v[192:195], a[216:219], v[84:87], v[192:195]
    s_waitcnt lgkmcnt(5)
    v_exp_f32 v33, v33
    v_mfma_f32_16x16x32_bf16 v[196:199], a[220:223], v[76:79], v[196:199]
    ds_read_b128 a[236:239], v1 offset:4480
    v_add_f32 v12, v22, v12
    v_mfma_f32_16x16x32_bf16 v[200:203], a[220:223], v[80:83], v[200:203]
    v_exp_f32 v34, v34
    v_mfma_f32_16x16x32_bf16 v[204:207], a[220:223], v[84:87], v[204:207]
    s_waitcnt lgkmcnt(4)
    v_exp_f32 v35, v35
    v_mfma_f32_16x16x32_bf16 v[208:211], a[224:227], v[76:79], v[208:211]
    ds_read_b128 a[240:243], v1 offset:4736
    v_add_f32 v12, v23, v12
    v_mfma_f32_16x16x32_bf16 v[212:215], a[224:227], v[80:83], v[212:215]
    v_exp_f32 v36, v36
    v_mfma_f32_16x16x32_bf16 v[216:219], a[224:227], v[84:87], v[216:219]
    s_waitcnt lgkmcnt(3)
    v_exp_f32 v37, v37
    v_mfma_f32_16x16x32_bf16 v[220:223], a[228:231], v[76:79], v[220:223]
    ds_read_b128 a[244:247], v1 offset:4992
    v_cvt_pk_bf16_f32 v69, v22, v23
    v_mfma_f32_16x16x32_bf16 v[224:227], a[228:231], v[80:83], v[224:227]
    v_exp_f32 v38, v38
    v_mfma_f32_16x16x32_bf16 v[228:231], a[228:231], v[84:87], v[228:231]
    s_waitcnt lgkmcnt(3)
    v_exp_f32 v39, v39
    v_add_f32 v13, v24, v13
    v_add_f32 v13, v25, v13
    v_cvt_pk_bf16_f32 v72, v24, v25
    v_add_f32 v13, v26, v13
    v_add_f32 v13, v27, v13
    v_cvt_pk_bf16_f32 v73, v26, v27
    v_add_f32 v11, v28, v11
    v_add_f32 v11, v29, v11
    v_cvt_pk_bf16_f32 v66, v28, v29
    v_add_f32 v11, v30, v11
    v_add_f32 v11, v31, v11
    v_cvt_pk_bf16_f32 v67, v30, v31
    v_add_f32 v12, v32, v12
    v_add_f32 v12, v33, v12
    v_cvt_pk_bf16_f32 v70, v32, v33
    v_add_f32 v12, v34, v12
    s_add_u32 s43, s43, 8192
    v_mfma_f32_16x16x32_bf16 v[52:55], a[232:235], v[88:91], 0
    s_waitcnt vmcnt(8)
    s_barrier
    s_waitcnt lgkmcnt(2)
    v_mfma_f32_16x16x32_bf16 v[56:59], a[232:235], v[92:95], 0
    ds_read_b64_tr_b16 a[216:217], v2 offset:25120
    v_add_f32 v12, v35, v12
    v_mfma_f32_16x16x32_bf16 v[60:63], a[232:235], v[96:99], 0
    ds_read_b64_tr_b16 a[218:219], v2 offset:29344
    v_cvt_pk_bf16_f32 v71, v34, v35
    v_mfma_f32_16x16x32_bf16 v[52:55], a[236:239], v[100:103], v[52:55]
    ds_read_b128 a[220:223], v1 offset:25120
    v_add_f32 v13, v36, v13
    v_mfma_f32_16x16x32_bf16 v[56:59], a[236:239], v[104:107], v[56:59]
    s_add_u32 m0, s47, s74
    s_nop 0
    buffer_load_dwordx4 v5, s[12:15], s43 offen nt lds
    v_mfma_f32_16x16x32_bf16 v[60:63], a[236:239], v[108:111], v[60:63]
    s_waitcnt lgkmcnt(4)
    v_exp_f32 v40, v40
    v_mfma_f32_16x16x32_bf16 v[52:55], a[240:243], v[112:115], v[52:55]
    ds_read_b64_tr_b16 a[224:225], v2 offset:25152
    v_add_f32 v13, v37, v13
    v_mfma_f32_16x16x32_bf16 v[56:59], a[240:243], v[116:119], v[56:59]
    ds_read_b64_tr_b16 a[226:227], v2 offset:29376
    v_cvt_pk_bf16_f32 v74, v36, v37
    v_mfma_f32_16x16x32_bf16 v[60:63], a[240:243], v[120:123], v[60:63]
    s_waitcnt lgkmcnt(5)
    v_exp_f32 v41, v41
    v_mfma_f32_16x16x32_bf16 v[52:55], a[244:247], v[124:127], v[52:55]
    ds_read_b128 a[228:231], v1 offset:25376
    v_add_f32 v13, v38, v13
    v_mfma_f32_16x16x32_bf16 v[56:59], a[244:247], v[128:131], v[56:59]
    v_exp_f32 v42, v42
    v_mfma_f32_16x16x32_bf16 v[60:63], a[244:247], v[132:135], v[60:63]
    s_waitcnt lgkmcnt(4)
    v_exp_f32 v43, v43
    v_mfma_f32_16x16x32_bf16 v[136:139], a[216:219], v[64:67], v[136:139]
    ds_read_b64_tr_b16 a[232:233], v2 offset:25376
    v_exp_f32 v44, v44
    v_mfma_f32_16x16x32_bf16 v[140:143], a[216:219], v[68:71], v[140:143]
    ds_read_b64_tr_b16 a[234:235], v2 offset:29600
    v_add_f32 v13, v39, v13
    v_cvt_pk_bf16_f32 v75, v38, v39
    s_nop 1
    v_mfma_f32_16x16x32_bf16 v[144:147], a[216:219], v[72:75], v[144:147]
    s_waitcnt lgkmcnt(5)
    buffer_load_dwordx4 v247, s[12:15], s43 offen offset:1056 nt lds
    v_mfma_f32_16x16x32_bf16 v[16:19], a[220:223], v[88:91], 0
    ds_read_b128 a[236:239], v1 offset:25632
    v_add_f32 v11, v40, v11
    v_mfma_f32_16x16x32_bf16 v[20:23], a[220:223], v[92:95], 0
    v_exp_f32 v45, v45
    v_mfma_f32_16x16x32_bf16 v[24:27], a[220:223], v[96:99], 0
    s_waitcnt lgkmcnt(4)
    v_exp_f32 v46, v46
    v_mfma_f32_16x16x32_bf16 v[148:151], a[224:227], v[64:67], v[148:151]
    ds_read_b64_tr_b16 a[240:241], v2 offset:25408
    v_exp_f32 v47, v47
    v_mfma_f32_16x16x32_bf16 v[152:155], a[224:227], v[68:71], v[152:155]
    ds_read_b64_tr_b16 a[242:243], v2 offset:29632
    v_add_f32 v11, v41, v11
    v_mfma_f32_16x16x32_bf16 v[156:159], a[224:227], v[72:75], v[156:159]
    s_waitcnt lgkmcnt(5)
    v_exp_f32 v48, v48
    v_mfma_f32_16x16x32_bf16 v[16:19], a[228:231], v[100:103], v[16:19]
    ds_read_b128 a[244:247], v1 offset:25888
    v_cvt_pk_bf16_f32 v76, v40, v41
    v_mfma_f32_16x16x32_bf16 v[20:23], a[228:231], v[104:107], v[20:23]
    s_add_u32 m0, s47, s76
    s_nop 0
    buffer_load_dwordx4 v5, s[16:19], s43 offen nt lds
    v_mfma_f32_16x16x32_bf16 v[24:27], a[228:231], v[108:111], v[24:27]
    s_waitcnt lgkmcnt(4)
    v_exp_f32 v49, v49
    v_mfma_f32_16x16x32_bf16 v[160:163], a[232:235], v[64:67], v[160:163]
    ds_read_b64_tr_b16 a[216:217], v2 offset:25632
    v_exp_f32 v50, v50
    v_mfma_f32_16x16x32_bf16 v[164:167], a[232:235], v[68:71], v[164:167]
    ds_read_b64_tr_b16 a[218:219], v2 offset:29856
    v_add_f32 v11, v42, v11
    v_mfma_f32_16x16x32_bf16 v[168:171], a[232:235], v[72:75], v[168:171]
    s_waitcnt lgkmcnt(5)
    v_exp_f32 v51, v51
    v_mfma_f32_16x16x32_bf16 v[16:19], a[236:239], v[112:115], v[16:19]
    ds_read_b64_tr_b16 a[220:221], v2 offset:25664
    v_add_f32 v11, v43, v11
    v_mfma_f32_16x16x32_bf16 v[20:23], a[236:239], v[116:119], v[20:23]
    ds_read_b64_tr_b16 a[222:223], v2 offset:29888
    v_exp_f32 v52, v52
    v_mfma_f32_16x16x32_bf16 v[24:27], a[236:239], v[120:123], v[24:27]
    s_waitcnt lgkmcnt(5)
    v_exp_f32 v53, v53
    v_mfma_f32_16x16x32_bf16 v[172:175], a[240:243], v[64:67], v[172:175]
    ds_read_b64_tr_b16 a[224:225], v2 offset:25888
    v_cvt_pk_bf16_f32 v77, v42, v43
    v_mfma_f32_16x16x32_bf16 v[176:179], a[240:243], v[68:71], v[176:179]
    ds_read_b64_tr_b16 a[226:227], v2 offset:30112
    v_add_f32 v12, v44, v12
    v_mfma_f32_16x16x32_bf16 v[180:183], a[240:243], v[72:75], v[180:183]
    s_xor_b32 s47, s47, 50240
    s_waitcnt lgkmcnt(6)
    buffer_load_dwordx4 v247, s[16:19], s43 offen offset:1056 nt lds
    v_mfma_f32_16x16x32_bf16 v[16:19], a[244:247], v[124:127], v[16:19]
    ds_read_b64_tr_b16 a[228:229], v2 offset:25920
    v_exp_f32 v54, v54
    v_mfma_f32_16x16x32_bf16 v[20:23], a[244:247], v[128:131], v[20:23]
    ds_read_b64_tr_b16 a[230:231], v2 offset:30144
    v_add_f32 v12, v45, v12
    v_mfma_f32_16x16x32_bf16 v[24:27], a[244:247], v[132:135], v[24:27]
    s_waitcnt lgkmcnt(6)
    v_exp_f32 v55, v55
    v_mfma_f32_16x16x32_bf16 v[184:187], a[216:219], v[64:67], v[184:187]
    ds_read_b128 a[232:235], v1 offset:29344
    v_cvt_pk_bf16_f32 v80, v44, v45
    v_mfma_f32_16x16x32_bf16 v[188:191], a[216:219], v[68:71], v[188:191]
    v_exp_f32 v56, v56
    v_mfma_f32_16x16x32_bf16 v[192:195], a[216:219], v[72:75], v[192:195]
    s_waitcnt lgkmcnt(5)
    v_exp_f32 v57, v57
    v_mfma_f32_16x16x32_bf16 v[196:199], a[220:223], v[64:67], v[196:199]
    ds_read_b128 a[236:239], v1 offset:29600
    v_add_f32 v12, v46, v12
    v_mfma_f32_16x16x32_bf16 v[200:203], a[220:223], v[68:71], v[200:203]
    v_exp_f32 v58, v58
    v_mfma_f32_16x16x32_bf16 v[204:207], a[220:223], v[72:75], v[204:207]
    s_waitcnt lgkmcnt(4)
    v_exp_f32 v59, v59
    v_mfma_f32_16x16x32_bf16 v[208:211], a[224:227], v[64:67], v[208:211]
    ds_read_b128 a[240:243], v1 offset:29856
    v_add_f32 v12, v47, v12
    v_mfma_f32_16x16x32_bf16 v[212:215], a[224:227], v[68:71], v[212:215]
    v_exp_f32 v60, v60
    v_mfma_f32_16x16x32_bf16 v[216:219], a[224:227], v[72:75], v[216:219]
    s_waitcnt lgkmcnt(3)
    v_exp_f32 v61, v61
    v_mfma_f32_16x16x32_bf16 v[220:223], a[228:231], v[64:67], v[220:223]
    ds_read_b128 a[244:247], v1 offset:30112
    v_cvt_pk_bf16_f32 v81, v46, v47
    v_mfma_f32_16x16x32_bf16 v[224:227], a[228:231], v[68:71], v[224:227]
    v_exp_f32 v62, v62
    v_mfma_f32_16x16x32_bf16 v[228:231], a[228:231], v[72:75], v[228:231]
    s_waitcnt lgkmcnt(3)
    v_exp_f32 v63, v63
    v_add_f32 v13, v48, v13
    v_add_f32 v13, v49, v13
    v_cvt_pk_bf16_f32 v84, v48, v49
    v_add_f32 v13, v50, v13
    v_add_f32 v13, v51, v13
    v_cvt_pk_bf16_f32 v85, v50, v51
    v_add_f32 v11, v52, v11
    v_add_f32 v11, v53, v11
    v_cvt_pk_bf16_f32 v78, v52, v53
    v_add_f32 v11, v54, v11
    v_add_f32 v11, v55, v11
    v_cvt_pk_bf16_f32 v79, v54, v55
    v_add_f32 v12, v56, v12
    v_add_f32 v12, v57, v12
    v_cvt_pk_bf16_f32 v82, v56, v57
    v_add_f32 v12, v58, v12
    s_add_u32 s43, s43, 8192
    v_add_u32 v1, s83, v1
    v_add_u32 v2, s83, v2
    s_sub_u32 s83, 0, s83
    s_sub_u32 s90, s90, 1
    s_cmp_lg_u32 s90, 0
    s_cbranch_scc1 L_B3
L_c3start:
    v_bfe_u32 v242, v14, 2, 3
    v_lshrrev_b32 v243, 6, v0
    v_lshl_add_u32 v243, v243, 4, v242
    v_lshlrev_b32 v6, 10, v243
    v_lshrrev_b32 v243, 5, v14
    v_lshl_add_u32 v6, v243, 6, v6
    v_lshrrev_b32 v242, 2, v242
    v_lshlrev_b32 v242, 1, v242
    v_and_b32 v243, 3, v14
    v_xor_b32 v243, v243, v242
    v_lshl_add_u32 v6, v243, 4, v6
    v_add_u32 v7, 7168, v6
    v_add_u32 v8, 65536, v6
    v_add_u32 v9, 72704, v6
    s_and_b32 s84, s42, 3
    s_mul_i32 s84, s84, 128
    s_mul_i32 s85, s40, 32
    s_add_u32 s84, s84, s85
    v_and_b32 v10, 31, v14
    v_add_u32 v10, s84, v10
    v_lshlrev_b32 v10, 10, v10
    v_mov_b32 v241, 0
    buffer_load_dword v15, v241, s[36:39], 0 offen
    s_lshl_b32 s74, s40, 11
    s_add_u32 s43, s41, 1
    s_and_b32 s43, s43, 7
    s_lshl_b32 s43, s43, 7
    v_mfma_f32_16x16x32_bf16 v[28:31], a[232:235], v[88:91], 0
    s_waitcnt vmcnt(9)
    s_barrier
    s_waitcnt lgkmcnt(2)
    v_mfma_f32_16x16x32_bf16 v[32:35], a[232:235], v[92:95], 0
    ds_read_b64_tr_b16 a[216:217], v2 offset:0
    v_add_f32 v12, v59, v12
    v_mfma_f32_16x16x32_bf16 v[36:39], a[232:235], v[96:99], 0
    ds_read_b64_tr_b16 a[218:219], v2 offset:4224
    v_cvt_pk_bf16_f32 v83, v58, v59
    v_mfma_f32_16x16x32_bf16 v[28:31], a[236:239], v[100:103], v[28:31]
    ds_read_b128 a[220:223], v1 offset:0
    v_add_f32 v13, v60, v13
    v_mfma_f32_16x16x32_bf16 v[32:35], a[236:239], v[104:107], v[32:35]
    s_add_u32 m0, s74, 98304
    s_mov_b32 s72, s43
    buffer_load_dwordx4 v6, s[24:27], s72 offen nt lds
    v_mfma_f32_16x16x32_bf16 v[36:39], a[236:239], v[108:111], v[36:39]
    s_waitcnt lgkmcnt(4)
    v_exp_f32 v16, v16
    v_mfma_f32_16x16x32_bf16 v[28:31], a[240:243], v[112:115], v[28:31]
    ds_read_b64_tr_b16 a[224:225], v2 offset:32
    v_add_f32 v13, v61, v13
    v_mfma_f32_16x16x32_bf16 v[32:35], a[240:243], v[116:119], v[32:35]
    ds_read_b64_tr_b16 a[226:227], v2 offset:4256
    v_cvt_pk_bf16_f32 v86, v60, v61
    v_mfma_f32_16x16x32_bf16 v[36:39], a[240:243], v[120:123], v[36:39]
    s_waitcnt lgkmcnt(5)
    buffer_load_dwordx4 v7, s[24:27], s72 offen offset:1024 nt lds
    v_mfma_f32_16x16x32_bf16 v[28:31], a[244:247], v[124:127], v[28:31]
    ds_read_b128 a[228:231], v1 offset:256
    v_exp_f32 v17, v17
    v_mfma_f32_16x16x32_bf16 v[32:35], a[244:247], v[128:131], v[32:35]
    v_exp_f32 v18, v18
    v_mfma_f32_16x16x32_bf16 v[36:39], a[244:247], v[132:135], v[36:39]
    s_waitcnt lgkmcnt(4)
    v_exp_f32 v19, v19
    v_mfma_f32_16x16x32_bf16 v[136:139], a[216:219], v[76:79], v[136:139]
    ds_read_b64_tr_b16 a[232:233], v2 offset:256
    v_add_f32 v13, v62, v13
    v_mfma_f32_16x16x32_bf16 v[140:143], a[216:219], v[80:83], v[140:143]
    ds_read_b64_tr_b16 a[234:235], v2 offset:4480
    v_exp_f32 v20, v20
    v_cvt_pk_bf16_f32 v87, v62, v63
    s_nop 1
    v_mfma_f32_16x16x32_bf16 v[144:147], a[216:219], v[84:87], v[144:147]
    s_add_u32 m0, s74, 106496
    s_waitcnt lgkmcnt(5)
    buffer_load_dwordx4 v8, s[24:27], s72 offen nt lds
    v_mfma_f32_16x16x32_bf16 v[40:43], a[220:223], v[88:91], 0
    ds_read_b128 a[236:239], v1 offset:512
    v_add_f32 v13, v63, v13
    v_mfma_f32_16x16x32_bf16 v[44:47], a[220:223], v[92:95], 0
    v_exp_f32 v21, v21
    v_mfma_f32_16x16x32_bf16 v[48:51], a[220:223], v[96:99], 0
    s_waitcnt lgkmcnt(4)
    buffer_load_dwordx4 v9, s[24:27], s72 offen offset:1024 nt lds
    v_mfma_f32_16x16x32_bf16 v[148:151], a[224:227], v[76:79], v[148:151]
    ds_read_b64_tr_b16 a[240:241], v2 offset:288
    v_exp_f32 v22, v22
    v_mfma_f32_16x16x32_bf16 v[152:155], a[224:227], v[80:83], v[152:155]
    ds_read_b64_tr_b16 a[242:243], v2 offset:4512
    v_exp_f32 v23, v23
    v_mfma_f32_16x16x32_bf16 v[156:159], a[224:227], v[84:87], v[156:159]
    s_waitcnt lgkmcnt(5)
    v_exp_f32 v24, v24
    v_mfma_f32_16x16x32_bf16 v[40:43], a[228:231], v[100:103], v[40:43]
    ds_read_b128 a[244:247], v1 offset:768
    v_add_f32 v11, v16, v11
    v_mfma_f32_16x16x32_bf16 v[44:47], a[228:231], v[104:107], v[44:47]
    s_add_u32 m0, s74, 114688
    s_add_u32 s72, s43, 131072
    buffer_load_dwordx4 v6, s[24:27], s72 offen nt lds
    v_mfma_f32_16x16x32_bf16 v[48:51], a[228:231], v[108:111], v[48:51]
    s_waitcnt lgkmcnt(4)
    v_exp_f32 v25, v25
    v_mfma_f32_16x16x32_bf16 v[160:163], a[232:235], v[76:79], v[160:163]
    ds_read_b64_tr_b16 a[216:217], v2 offset:512
    v_exp_f32 v26, v26
    v_mfma_f32_16x16x32_bf16 v[164:167], a[232:235], v[80:83], v[164:167]
    ds_read_b64_tr_b16 a[218:219], v2 offset:4736
    v_add_f32 v11, v17, v11
    v_mfma_f32_16x16x32_bf16 v[168:171], a[232:235], v[84:87], v[168:171]
    s_waitcnt lgkmcnt(5)
    v_exp_f32 v27, v27
    v_mfma_f32_16x16x32_bf16 v[40:43], a[236:239], v[112:115], v[40:43]
    ds_read_b64_tr_b16 a[220:221], v2 offset:544
    v_exp_f32 v28, v28
    v_mfma_f32_16x16x32_bf16 v[44:47], a[236:239], v[116:119], v[44:47]
    ds_read_b64_tr_b16 a[222:223], v2 offset:4768
    v_exp_f32 v29, v29
    v_mfma_f32_16x16x32_bf16 v[48:51], a[236:239], v[120:123], v[48:51]
    s_waitcnt lgkmcnt(5)
    buffer_load_dwordx4 v7, s[24:27], s72 offen offset:1024 nt lds
    v_mfma_f32_16x16x32_bf16 v[172:175], a[240:243], v[76:79], v[172:175]
    ds_read_b64_tr_b16 a[224:225], v2 offset:768
    v_cvt_pk_bf16_f32 v64, v16, v17
    v_mfma_f32_16x16x32_bf16 v[176:179], a[240:243], v[80:83], v[176:179]
    ds_read_b64_tr_b16 a[226:227], v2 offset:4992
    v_exp_f32 v30, v30
    v_mfma_f32_16x16x32_bf16 v[180:183], a[240:243], v[84:87], v[180:183]
    s_add_u32 m0, s74, 122880
    s_waitcnt lgkmcnt(6)
    buffer_load_dwordx4 v8, s[24:27], s72 offen nt lds
    v_mfma_f32_16x16x32_bf16 v[40:43], a[244:247], v[124:127], v[40:43]
    ds_read_b64_tr_b16 a[228:229], v2 offset:800
    v_add_f32 v11, v18, v11
    v_mfma_f32_16x16x32_bf16 v[44:47], a[244:247], v[128:131], v[44:47]
    ds_read_b64_tr_b16 a[230:231], v2 offset:5024
    v_exp_f32 v31, v31
    v_mfma_f32_16x16x32_bf16 v[48:51], a[244:247], v[132:135], v[48:51]
    s_waitcnt lgkmcnt(6)
    v_exp_f32 v32, v32
    v_mfma_f32_16x16x32_bf16 v[184:187], a[216:219], v[76:79], v[184:187]
    ds_read_b128 a[232:235], v1 offset:4224
    v_add_f32 v11, v19, v11
    v_mfma_f32_16x16x32_bf16 v[188:191], a[216:219], v[80:83], v[188:191]
    buffer_load_dwordx4 v9, s[24:27], s72 offen offset:1024 nt lds
    v_mfma_f32_16x16x32_bf16 v[192:195], a[216:219], v[84:87], v[192:195]
    s_waitcnt lgkmcnt(5)
    v_exp_f32 v33, v33
    v_mfma_f32_16x16x32_bf16 v[196:199], a[220:223], v[76:79], v[196:199]
    ds_read_b128 a[236:239], v1 offset:4480
    v_cvt_pk_bf16_f32 v65, v18, v19
    v_mfma_f32_16x16x32_bf16 v[200:203], a[220:223], v[80:83], v[200:203]
    v_exp_f32 v34, v34
    v_mfma_f32_16x16x32_bf16 v[204:207], a[220:223], v[84:87], v[204:207]
    s_waitcnt lgkmcnt(4)
    v_exp_f32 v35, v35
    v_mfma_f32_16x16x32_bf16 v[208:211], a[224:227], v[76:79], v[208:211]
    ds_read_b128 a[240:243], v1 offset:4736
    v_add_f32 v12, v20, v12
    v_mfma_f32_16x16x32_bf16 v[212:215], a[224:227], v[80:83], v[212:215]
    v_exp_f32 v36, v36
    v_mfma_f32_16x16x32_bf16 v[216:219], a[224:227], v[84:87], v[216:219]
    s_waitcnt lgkmcnt(3)
    v_exp_f32 v37, v37
    v_mfma_f32_16x16x32_bf16 v[220:223], a[228:231], v[76:79], v[220:223]
    ds_read_b128 a[244:247], v1 offset:4992
    v_add_f32 v12, v21, v12
    v_mfma_f32_16x16x32_bf16 v[224:227], a[228:231], v[80:83], v[224:227]
    v_exp_f32 v38, v38
    v_mfma_f32_16x16x32_bf16 v[228:231], a[228:231], v[84:87], v[228:231]
    s_waitcnt lgkmcnt(3)
    v_exp_f32 v39, v39
    v_cvt_pk_bf16_f32 v68, v20, v21
    v_add_f32 v12, v22, v12
    v_add_f32 v12, v23, v12
    v_cvt_pk_bf16_f32 v69, v22, v23
    v_add_f32 v13, v24, v13
    v_add_f32 v13, v25, v13
    v_cvt_pk_bf16_f32 v72, v24, v25
    v_add_f32 v13, v26, v13
    v_add_f32 v13, v27, v13
    v_cvt_pk_bf16_f32 v73, v26, v27
    v_add_f32 v11, v28, v11
    v_add_f32 v11, v29, v11
    v_cvt_pk_bf16_f32 v66, v28, v29
    v_add_f32 v11, v30, v11
    v_add_f32 v11, v31, v11
    v_cvt_pk_bf16_f32 v67, v30, v31
    v_add_f32 v12, v32, v12
    v_add_f32 v12, v33, v12
    v_cvt_pk_bf16_f32 v70, v32, v33
    v_add_f32 v12, v34, v12
    v_mfma_f32_16x16x32_bf16 v[52:55], a[232:235], v[88:91], 0
    s_waitcnt vmcnt(13)
    s_barrier
    s_waitcnt lgkmcnt(2)
    v_mfma_f32_16x16x32_bf16 v[56:59], a[232:235], v[92:95], 0
    ds_read_b64_tr_b16 a[216:217], v2 offset:25120
    v_add_f32 v12, v35, v12
    v_cvt_pk_bf16_f32 v71, v34, v35
    v_add_f32 v13, v36, v13
    v_add_f32 v13, v37, v13
    v_cvt_pk_bf16_f32 v74, v36, v37
    v_mfma_f32_16x16x32_bf16 v[60:63], a[232:235], v[96:99], 0
    ds_read_b64_tr_b16 a[218:219], v2 offset:29344
    v_add_f32 v13, v38, v13
    v_add_f32 v13, v39, v13
    v_cvt_pk_bf16_f32 v75, v38, v39
    v_mfma_f32_16x16x32_bf16 v[52:55], a[236:239], v[100:103], v[52:55]
    ds_read_b64_tr_b16 a[220:221], v2 offset:25152
    v_exp_f32 v40, v40
    v_exp_f32 v41, v41
    v_mfma_f32_16x16x32_bf16 v[56:59], a[236:239], v[104:107], v[56:59]
    ds_read_b64_tr_b16 a[222:223], v2 offset:29376
    v_add_f32 v11, v40, v11
    v_exp_f32 v42, v42
    v_mfma_f32_16x16x32_bf16 v[60:63], a[236:239], v[108:111], v[60:63]
    s_add_u32 m0, s74, 131072
    s_add_u32 s72, s43, 262144
    s_waitcnt lgkmcnt(5)
    buffer_load_dwordx4 v6, s[24:27], s72 offen nt lds
    v_exp_f32 v43, v43
    v_exp_f32 v44, v44
    v_mfma_f32_16x16x32_bf16 v[52:55], a[240:243], v[112:115], v[52:55]
    ds_read_b64_tr_b16 a[224:225], v2 offset:25376
    v_add_f32 v11, v41, v11
    v_exp_f32 v45, v45
    v_mfma_f32_16x16x32_bf16 v[56:59], a[240:243], v[116:119], v[56:59]
    ds_read_b64_tr_b16 a[226:227], v2 offset:29600
    v_cvt_pk_bf16_f32 v76, v40, v41
    v_exp_f32 v46, v46
    v_mfma_f32_16x16x32_bf16 v[60:63], a[240:243], v[120:123], v[60:63]
    s_waitcnt lgkmcnt(6)
    buffer_load_dwordx4 v7, s[24:27], s72 offen offset:1024 nt lds
    v_add_f32 v11, v42, v11
    v_exp_f32 v47, v47
    v_mfma_f32_16x16x32_bf16 v[52:55], a[244:247], v[124:127], v[52:55]
    ds_read_b64_tr_b16 a[228:229], v2 offset:25408
    v_add_f32 v11, v43, v11
    v_cvt_pk_bf16_f32 v77, v42, v43
    v_exp_f32 v48, v48
    v_mfma_f32_16x16x32_bf16 v[56:59], a[244:247], v[128:131], v[56:59]
    ds_read_b64_tr_b16 a[230:231], v2 offset:29632
    v_add_f32 v12, v44, v12
    v_exp_f32 v49, v49
    v_mfma_f32_16x16x32_bf16 v[60:63], a[244:247], v[132:135], v[60:63]
    s_add_u32 m0, s74, 139264
    s_waitcnt lgkmcnt(6)
    buffer_load_dwordx4 v8, s[24:27], s72 offen nt lds
    v_add_f32 v12, v45, v12
    v_exp_f32 v50, v50
    v_mfma_f32_16x16x32_bf16 v[136:139], a[216:219], v[64:67], v[136:139]
    ds_read_b64_tr_b16 a[232:233], v2 offset:25632
    v_cvt_pk_bf16_f32 v80, v44, v45
    v_add_f32 v12, v46, v12
    v_mfma_f32_16x16x32_bf16 v[140:143], a[216:219], v[68:71], v[140:143]
    ds_read_b64_tr_b16 a[234:235], v2 offset:29856
    v_add_f32 v12, v47, v12
    v_exp_f32 v51, v51
    v_cvt_pk_bf16_f32 v81, v46, v47
    v_mfma_f32_16x16x32_bf16 v[144:147], a[216:219], v[72:75], v[144:147]
    s_waitcnt lgkmcnt(6)
    buffer_load_dwordx4 v9, s[24:27], s72 offen offset:1024 nt lds
    v_exp_f32 v52, v52
    v_add_f32 v13, v48, v13
    v_mfma_f32_16x16x32_bf16 v[148:151], a[220:223], v[64:67], v[148:151]
    ds_read_b64_tr_b16 a[236:237], v2 offset:25664
    v_add_f32 v13, v49, v13
    v_exp_f32 v53, v53
    v_mfma_f32_16x16x32_bf16 v[152:155], a[220:223], v[68:71], v[152:155]
    ds_read_b64_tr_b16 a[238:239], v2 offset:29888
    v_cvt_pk_bf16_f32 v84, v48, v49
    v_exp_f32 v54, v54
    v_mfma_f32_16x16x32_bf16 v[156:159], a[220:223], v[72:75], v[156:159]
    s_add_u32 m0, s74, 147456
    s_add_u32 s72, s43, 393216
    s_waitcnt lgkmcnt(6)
    buffer_load_dwordx4 v6, s[24:27], s72 offen nt lds
    v_add_f32 v13, v50, v13
    v_exp_f32 v55, v55
    v_mfma_f32_16x16x32_bf16 v[160:163], a[224:227], v[64:67], v[160:163]
    ds_read_b64_tr_b16 a[240:241], v2 offset:25888
    v_add_f32 v13, v51, v13
    v_cvt_pk_bf16_f32 v85, v50, v51
    v_exp_f32 v56, v56
    v_mfma_f32_16x16x32_bf16 v[164:167], a[224:227], v[68:71], v[164:167]
    ds_read_b64_tr_b16 a[242:243], v2 offset:30112
    v_add_f32 v11, v52, v11
    v_exp_f32 v57, v57
    v_mfma_f32_16x16x32_bf16 v[168:171], a[224:227], v[72:75], v[168:171]
    s_waitcnt lgkmcnt(6)
    buffer_load_dwordx4 v7, s[24:27], s72 offen offset:1024 nt lds
    v_add_f32 v11, v53, v11
    v_exp_f32 v58, v58
    v_mfma_f32_16x16x32_bf16 v[172:175], a[228:231], v[64:67], v[172:175]
    ds_read_b64_tr_b16 a[244:245], v2 offset:25920
    v_cvt_pk_bf16_f32 v78, v52, v53
    v_add_f32 v11, v54, v11
    v_exp_f32 v59, v59
    v_mfma_f32_16x16x32_bf16 v[176:179], a[228:231], v[68:71], v[176:179]
    ds_read_b64_tr_b16 a[246:247], v2 offset:30144
    v_add_f32 v11, v55, v11
    v_cvt_pk_bf16_f32 v79, v54, v55
    v_exp_f32 v60, v60
    v_mfma_f32_16x16x32_bf16 v[180:183], a[228:231], v[72:75], v[180:183]
    s_waitcnt lgkmcnt(6)
    v_exp_f32 v61, v61
    v_mfma_f32_16x16x32_bf16 v[184:187], a[232:235], v[64:67], v[184:187]
    s_add_u32 m0, s74, 155648
    s_nop 0
    buffer_load_dwordx4 v8, s[24:27], s72 offen nt lds
    v_add_f32 v12, v56, v12
    v_add_f32 v12, v57, v12
    v_exp_f32 v62, v62
    v_mfma_f32_16x16x32_bf16 v[188:191], a[232:235], v[68:71], v[188:191]
    v_exp_f32 v63, v63
    v_mfma_f32_16x16x32_bf16 v[192:195], a[232:235], v[72:75], v[192:195]
    s_waitcnt lgkmcnt(4)
    v_cvt_pk_bf16_f32 v82, v56, v57
    v_add_f32 v12, v58, v12
    v_add_f32 v12, v59, v12
    v_mfma_f32_16x16x32_bf16 v[196:199], a[236:239], v[64:67], v[196:199]
    buffer_load_dwordx4 v9, s[24:27], s72 offen offset:1024 nt lds
    v_cvt_pk_bf16_f32 v83, v58, v59
    v_add_f32 v13, v60, v13
    v_add_f32 v13, v61, v13
    v_cvt_pk_bf16_f32 v86, v60, v61
    v_mfma_f32_16x16x32_bf16 v[200:203], a[236:239], v[68:71], v[200:203]
    v_add_f32 v13, v62, v13
    v_add_f32 v13, v63, v13
    v_cvt_pk_bf16_f32 v87, v62, v63
    v_mfma_f32_16x16x32_bf16 v[204:207], a[236:239], v[72:75], v[204:207]
    s_waitcnt lgkmcnt(2)
    v_mov_b32 v240, v11
    s_nop 1
    v_permlane16_swap_b32 v11, v240
    v_add_f32 v11, v11, v240
    v_mfma_f32_16x16x32_bf16 v[208:211], a[240:243], v[64:67], v[208:211]
    v_mov_b32 v240, v11
    s_nop 1
    v_permlane32_swap_b32 v11, v240
    v_add_f32 v11, v11, v240
    v_mfma_f32_16x16x32_bf16 v[212:215], a[240:243], v[68:71], v[212:215]
    v_rcp_f32 v248, v11
    v_mov_b32 v241, v12
    s_nop 1
    v_permlane16_swap_b32 v12, v241
    v_mfma_f32_16x16x32_bf16 v[216:219], a[240:243], v[72:75], v[216:219]
    s_waitcnt lgkmcnt(0)
    v_add_f32 v12, v12, v241
    v_mov_b32 v241, v12
    s_nop 1
    v_permlane32_swap_b32 v12, v241
    v_mfma_f32_16x16x32_bf16 v[220:223], a[244:247], v[64:67], v[220:223]
    v_add_f32 v12, v12, v241
    v_mov_b32 v242, v13
    v_rcp_f32 v249, v12
    v_mfma_f32_16x16x32_bf16 v[224:227], a[244:247], v[68:71], v[224:227]
    v_permlane16_swap_b32 v13, v242
    v_add_f32 v13, v13, v242
    v_mfma_f32_16x16x32_bf16 v[228:231], a[244:247], v[72:75], v[228:231]
    v_mov_b32 v242, v13
    s_nop 1
    v_permlane32_swap_b32 v13, v242
    v_add_f32 v13, v13, v242
    v_rcp_f32 v250, v13
    v_min3_f32 v232, v11, v12, v13
    v_max3_f32 v233, v11, v12, v13
    v_cmp_gt_f32 vcc, 729808896, v232
    s_nop 3
    s_mov_b64 s[84:85], vcc
    v_cmp_lt_f32 vcc, 1400897536, v233
    s_nop 3
    s_or_b64 s[84:85], s[84:85], vcc
    s_cbranch_scc1 L_slow
L_retC3:
    v_add_u32 v1, s83, v1
    v_add_u32 v2, s83, v2
    s_sub_u32 s83, 0, s83
    s_waitcnt vmcnt(16)
    s_barrier
    ds_read_b64_tr_b16 a[216:217], v2 offset:0
    ds_read_b64_tr_b16 a[218:219], v2 offset:4224
    ds_read_b64_tr_b16 a[220:221], v2 offset:32
    ds_read_b64_tr_b16 a[222:223], v2 offset:4256
    ds_read_b64_tr_b16 a[224:225], v2 offset:256
    ds_read_b64_tr_b16 a[226:227], v2 offset:4480
    ds_read_b64_tr_b16 a[228:229], v2 offset:288
    ds_read_b64_tr_b16 a[230:231], v2 offset:4512
    s_waitcnt lgkmcnt(6)
    v_mfma_f32_16x16x32_bf16 v[136:139], a[216:219], v[76:79], v[136:139]
    ds_read_b64_tr_b16 a[232:233], v2 offset:512
    v_mfma_f32_16x16x32_bf16 v[140:143], a[216:219], v[80:83], v[140:143]
    ds_read_b64_tr_b16 a[234:235], v2 offset:4736
    v_mfma_f32_16x16x32_bf16 v[144:147], a[216:219], v[84:87], v[144:147]
    s_add_u32 s43, s43, 128
    s_and_b32 s43, s43, 1023
    s_add_u32 m0, s74, 32768
    s_mov_b32 s72, s43
    s_waitcnt lgkmcnt(6)
    buffer_load_dwordx4 v6, s[24:27], s72 offen nt lds
    v_mfma_f32_16x16x32_bf16 v[148:151], a[220:223], v[76:79], v[148:151]
    ds_read_b64_tr_b16 a[236:237], v2 offset:544
    v_mul_f32 v232, v136, v248
    v_mul_f32 v233, v137, v248
    v_mul_f32 v234, v138, v248
    v_mul_f32 v235, v139, v248
    v_cvt_pk_bf16_f32 v236, v232, v233
    v_cvt_pk_bf16_f32 v237, v234, v235
    v_accvgpr_write_b32 a48, v236
    v_accvgpr_write_b32 a49, v237
    v_mfma_f32_16x16x32_bf16 v[152:155], a[220:223], v[80:83], v[152:155]
    ds_read_b64_tr_b16 a[238:239], v2 offset:4768
    v_mul_f32 v238, v140, v249
    v_mul_f32 v239, v141, v249
    v_mul_f32 v240, v142, v249
    v_mul_f32 v241, v143, v249
    v_cvt_pk_bf16_f32 v242, v238, v239
    v_cvt_pk_bf16_f32 v243, v240, v241
    v_accvgpr_write_b32 a52, v242
    v_accvgpr_write_b32 a53, v243
    v_mfma_f32_16x16x32_bf16 v[156:159], a[220:223], v[84:87], v[156:159]
    s_waitcnt lgkmcnt(6)
    buffer_load_dwordx4 v7, s[24:27], s72 offen offset:1024 nt lds
    v_mul_f32 v232, v144, v250
    v_mul_f32 v233, v145, v250
    v_mul_f32 v234, v146, v250
    v_mul_f32 v235, v147, v250
    v_cvt_pk_bf16_f32 v236, v232, v233
    v_cvt_pk_bf16_f32 v237, v234, v235
    v_accvgpr_write_b32 a56, v236
    v_accvgpr_write_b32 a57, v237
    v_mfma_f32_16x16x32_bf16 v[160:163], a[224:227], v[76:79], v[160:163]
    ds_read_b64_tr_b16 a[240:241], v2 offset:768
    v_mul_f32 v238, v148, v248
    v_mul_f32 v239, v149, v248
    v_mul_f32 v240, v150, v248
    v_mul_f32 v241, v151, v248
    v_cvt_pk_bf16_f32 v242, v238, v239
    v_cvt_pk_bf16_f32 v243, v240, v241
    v_accvgpr_write_b32 a50, v242
    v_accvgpr_write_b32 a51, v243
    v_mfma_f32_16x16x32_bf16 v[164:167], a[224:227], v[80:83], v[164:167]
    ds_read_b64_tr_b16 a[242:243], v2 offset:4992
    v_mul_f32 v232, v152, v249
    v_mul_f32 v233, v153, v249
    v_mul_f32 v234, v154, v249
    v_mul_f32 v235, v155, v249
    v_cvt_pk_bf16_f32 v236, v232, v233
    v_cvt_pk_bf16_f32 v237, v234, v235
    v_accvgpr_write_b32 a54, v236
    v_accvgpr_write_b32 a55, v237
    v_mfma_f32_16x16x32_bf16 v[168:171], a[224:227], v[84:87], v[168:171]
    s_waitcnt lgkmcnt(6)
    v_mul_f32 v238, v156, v250
    v_mul_f32 v239, v157, v250
    v_mul_f32 v240, v158, v250
    v_mul_f32 v241, v159, v250
    v_cvt_pk_bf16_f32 v242, v238, v239
    v_cvt_pk_bf16_f32 v243, v240, v241
    v_accvgpr_write_b32 a58, v242
    v_accvgpr_write_b32 a59, v243
    v_mfma_f32_16x16x32_bf16 v[172:175], a[228:231], v[76:79], v[172:175]
    ds_read_b64_tr_b16 a[244:245], v2 offset:800
    v_mul_f32 v232, v160, v248
    v_mul_f32 v233, v161, v248
    v_mul_f32 v234, v162, v248
    v_mul_f32 v235, v163, v248
    v_cvt_pk_bf16_f32 v236, v232, v233
    v_cvt_pk_bf16_f32 v237, v234, v235
    v_accvgpr_write_b32 a60, v236
    v_accvgpr_write_b32 a61, v237
    v_mfma_f32_16x16x32_bf16 v[176:179], a[228:231], v[80:83], v[176:179]
    ds_read_b64_tr_b16 a[246:247], v2 offset:5024
    v_mul_f32 v238, v164, v249
    v_mul_f32 v239, v165, v249
    v_mul_f32 v240, v166, v249
    v_mul_f32 v241, v167, v249
    v_cvt_pk_bf16_f32 v242, v238, v239
    v_cvt_pk_bf16_f32 v243, v240, v241
    v_accvgpr_write_b32 a64, v242
    v_accvgpr_write_b32 a65, v243
    v_mfma_f32_16x16x32_bf16 v[180:183], a[228:231], v[84:87], v[180:183]
    s_add_u32 m0, s74, 40960
    s_waitcnt lgkmcnt(6)
    buffer_load_dwordx4 v8, s[24:27], s72 offen nt lds
    v_mul_f32 v232, v168, v250
    v_mul_f32 v233, v169, v250
    v_mul_f32 v234, v170, v250
    v_mul_f32 v235, v171, v250
    v_cvt_pk_bf16_f32 v236, v232, v233
    v_cvt_pk_bf16_f32 v237, v234, v235
    v_accvgpr_write_b32 a68, v236
    v_accvgpr_write_b32 a69, v237
    v_mfma_f32_16x16x32_bf16 v[184:187], a[232:235], v[76:79], v[184:187]
    v_mul_f32 v238, v172, v248
    v_mul_f32 v239, v173, v248
    v_mul_f32 v240, v174, v248
    v_mul_f32 v241, v175, v248
    v_cvt_pk_bf16_f32 v242, v238, v239
    v_cvt_pk_bf16_f32 v243, v240, v241
    v_accvgpr_write_b32 a62, v242
    v_accvgpr_write_b32 a63, v243
    v_mfma_f32_16x16x32_bf16 v[188:191], a[232:235], v[80:83], v[188:191]
    v_mul_f32 v232, v176, v249
    v_mul_f32 v233, v177, v249
    v_mul_f32 v234, v178, v249
    v_mul_f32 v235, v179, v249
    v_cvt_pk_bf16_f32 v236, v232, v233
    v_cvt_pk_bf16_f32 v237, v234, v235
    v_accvgpr_write_b32 a66, v236
    v_accvgpr_write_b32 a67, v237
    v_mfma_f32_16x16x32_bf16 v[192:195], a[232:235], v[84:87], v[192:195]
    s_waitcnt lgkmcnt(4)
    v_mul_f32 v238, v180, v250
    v_mul_f32 v239, v181, v250
    v_mul_f32 v240, v182, v250
    v_mul_f32 v241, v183, v250
    v_cvt_pk_bf16_f32 v242, v238, v239
    v_cvt_pk_bf16_f32 v243, v240, v241
    v_accvgpr_write_b32 a70, v242
    v_accvgpr_write_b32 a71, v243
    v_mfma_f32_16x16x32_bf16 v[196:199], a[236:239], v[76:79], v[196:199]
    buffer_load_dwordx4 v9, s[24:27], s72 offen offset:1024 nt lds
    v_mul_f32 v232, v184, v248
    v_mul_f32 v233, v185, v248
    v_mul_f32 v234, v186, v248
    v_mul_f32 v235, v187, v248
    v_cvt_pk_bf16_f32 v236, v232, v233
    v_cvt_pk_bf16_f32 v237, v234, v235
    v_accvgpr_write_b32 a72, v236
    v_accvgpr_write_b32 a73, v237
    v_mfma_f32_16x16x32_bf16 v[200:203], a[236:239], v[80:83], v[200:203]
    v_mul_f32 v238, v188, v249
    v_mul_f32 v239, v189, v249
    v_mul_f32 v240, v190, v249
    v_mul_f32 v241, v191, v249
    v_cvt_pk_bf16_f32 v242, v238, v239
    v_cvt_pk_bf16_f32 v243, v240, v241
    v_accvgpr_write_b32 a76, v242
    v_accvgpr_write_b32 a77, v243
    v_mfma_f32_16x16x32_bf16 v[204:207], a[236:239], v[84:87], v[204:207]
    s_waitcnt lgkmcnt(2)
    v_mul_f32 v232, v192, v250
    v_mul_f32 v233, v193, v250
    v_mul_f32 v234, v194, v250
    v_mul_f32 v235, v195, v250
    v_cvt_pk_bf16_f32 v236, v232, v233
    v_cvt_pk_bf16_f32 v237, v234, v235
    v_accvgpr_write_b32 a80, v236
    v_accvgpr_write_b32 a81, v237
    v_mfma_f32_16x16x32_bf16 v[208:211], a[240:243], v[76:79], v[208:211]
    v_mul_f32 v238, v196, v248
    v_mul_f32 v239, v197, v248
    v_mul_f32 v240, v198, v248
    v_mul_f32 v241, v199, v248
    v_cvt_pk_bf16_f32 v242, v238, v239
    v_cvt_pk_bf16_f32 v243, v240, v241
    v_accvgpr_write_b32 a74, v242
    v_accvgpr_write_b32 a75, v243
    v_mfma_f32_16x16x32_bf16 v[212:215], a[240:243], v[80:83], v[212:215]
    v_mul_f32 v232, v200, v249
    v_mul_f32 v233, v201, v249
    v_mul_f32 v234, v202, v249
    v_mul_f32 v235, v203, v249
    v_cvt_pk_bf16_f32 v236, v232, v233
    v_cvt_pk_bf16_f32 v237, v234, v235
    v_accvgpr_write_b32 a78, v236
    v_accvgpr_write_b32 a79, v237
    v_mfma_f32_16x16x32_bf16 v[216:219], a[240:243], v[84:87], v[216:219]
    s_waitcnt lgkmcnt(0)
    v_mul_f32 v238, v204, v250
    v_mul_f32 v239, v205, v250
    v_mul_f32 v240, v206, v250
    v_mul_f32 v241, v207, v250
    v_cvt_pk_bf16_f32 v242, v238, v239
    v_cvt_pk_bf16_f32 v243, v240, v241
    v_accvgpr_write_b32 a82, v242
    v_accvgpr_write_b32 a83, v243
    v_mfma_f32_16x16x32_bf16 v[220:223], a[244:247], v[76:79], v[220:223]
    v_mul_f32 v232, v208, v248
    v_mul_f32 v233, v209, v248
    v_mul_f32 v234, v210, v248
    v_mul_f32 v235, v211, v248
    v_cvt_pk_bf16_f32 v236, v232, v233
    v_cvt_pk_bf16_f32 v237, v234, v235
    v_accvgpr_write_b32 a84, v236
    v_accvgpr_write_b32 a85, v237
    v_mfma_f32_16x16x32_bf16 v[224:227], a[244:247], v[80:83], v[224:227]
    v_mul_f32 v238, v212, v249
    v_mul_f32 v239, v213, v249
    v_mul_f32 v240, v214, v249
    v_mul_f32 v241, v215, v249
    v_cvt_pk_bf16_f32 v242, v238, v239
    v_cvt_pk_bf16_f32 v243, v240, v241
    v_accvgpr_write_b32 a88, v242
    v_accvgpr_write_b32 a89, v243
    v_mfma_f32_16x16x32_bf16 v[228:231], a[244:247], v[84:87], v[228:231]
    v_mul_f32 v232, v216, v250
    v_mul_f32 v233, v217, v250
    v_mul_f32 v234, v218, v250
    v_mul_f32 v235, v219, v250
    v_cvt_pk_bf16_f32 v236, v232, v233
    v_cvt_pk_bf16_f32 v237, v234, v235
    v_accvgpr_write_b32 a92, v236
    v_accvgpr_write_b32 a93, v237
    v_mul_f32 v238, v220, v248
    v_mul_f32 v239, v221, v248
    v_mul_f32 v240, v222, v248
    v_mul_f32 v241, v223, v248
    v_cvt_pk_bf16_f32 v242, v238, v239
    v_cvt_pk_bf16_f32 v243, v240, v241
    v_accvgpr_write_b32 a86, v242
    v_accvgpr_write_b32 a87, v243
    v_mul_f32 v232, v224, v249
    v_mul_f32 v233, v225, v249
    v_mul_f32 v234, v226, v249
    v_mul_f32 v235, v227, v249
    v_cvt_pk_bf16_f32 v236, v232, v233
    v_cvt_pk_bf16_f32 v237, v234, v235
    v_accvgpr_write_b32 a90, v236
    v_accvgpr_write_b32 a91, v237
    v_mul_f32 v238, v228, v250
    v_mul_f32 v239, v229, v250
    v_mul_f32 v240, v230, v250
    v_mul_f32 v241, v231, v250
    v_cvt_pk_bf16_f32 v242, v238, v239
    v_cvt_pk_bf16_f32 v243, v240, v241
    v_accvgpr_write_b32 a94, v242
    v_accvgpr_write_b32 a95, v243
    v_lshrrev_b32 v242, 5, v14
    v_lshlrev_b32 v242, 10, v242
    v_bfe_u32 v243, v14, 2, 3
    v_lshl_add_u32 v242, v243, 6, v242
    v_and_b32 v243, 3, v14
    v_lshl_add_u32 v242, v243, 3, v242
    v_add_u32 v242, 98304, v242
    v_bfe_u32 v243, v14, 4, 1
    v_lshl_add_u32 v1, v243, 5, v242
    v_xor_b32 v243, 1, v243
    v_lshl_add_u32 v2, v243, 5, v242
    v_lshrrev_b32 v242, 6, v0
    v_mul_u32_u24 v242, 6144, v242
    v_lshl_add_u32 v3, v14, 4, v242
    v_and_b32 v90, 7, v14
    v_lshlrev_b32 v90, 3, v90
    v_mov_b32 v96, 0
    s_mul_i32 s20, s40, 6144
    s_lshl_b32 s21, s40, 10
    s_add_u32 s21, s21, 24576
    v_and_b32 v99, 3, v14
    v_lshlrev_b32 v99, 4, v99
    v_add_u32 v100, s21, v90
    v_lshlrev_b32 v101, 4, v14
    v_add_u32 v101, s20, v101
    v_readfirstlane_b32 s98, v15
    s_nop 3
    s_cmp_lg_u32 s98, 0
    s_cbranch_scc1 L_nonok
    s_mov_b32 s90, 262144
L_nonsp:
    s_sleep 1
    buffer_load_dword v15, v96, s[36:39], 0 offen sc1
    s_waitcnt vmcnt(0)
    s_nop 1
    v_readfirstlane_b32 s98, v15
    s_nop 3
    s_cmp_lg_u32 s98, 0
    s_cbranch_scc1 L_nonok
    s_sub_u32 s90, s90, 1
    s_cmp_lg_u32 s90, 0
    s_cbranch_scc1 L_nonsp
L_nonok:
    v_mov_b32 v92, s98
    s_nop 0
    s_xor_b32 s86, s98, 1540483477
    v_mov_b32 v93, s86
    s_mul_i32 s96, s41, 221184
    s_add_u32 s18, s96, 4096
    s_mov_b32 s19, s96
    s_mov_b32 s97, s41
    s_mov_b32 s82, 1
    s_mov_b32 s81, 0
    s_lshl_b32 s84, s41, 2
    s_add_u32 s84, s84, s40
    s_lshl_b32 s84, s84, 7
    s_add_u32 s78, s84, 1572864
    s_lshl_b32 s84, s41, 3
    s_add_u32 s23, s84, 1572864
    s_mov_b32 s77, 0
    s_mov_b32 s75, s74
    s_mov_b32 s76, s74
    s_mov_b32 s83, 4294901760
    v_mov_b32 v232, 0
    v_mov_b32 v233, 0
    v_mov_b32 v236, 0
    v_mov_b32 v237, 0
    v_lshrrev_b32 v240, 4, v14
    v_bfe_u32 v241, v14, 2, 2
    v_cmp_eq_u32 vcc, v240, v241
    v_and_b32 v240, 1, v14
    v_lshlrev_b32 v240, 4, v240
    v_mov_b32 v241, 16256
    v_lshlrev_b32 v240, v240, v241
    v_cndmask_b32 v240, 0, v240
    v_bfe_u32 v241, v14, 1, 1
    v_cmp_eq_u32 vcc, 0, v241
    s_nop 1
    v_cndmask_b32 v234, 0, v240
    v_sub_u32 v235, v240, v234
L_WOS:
    v_mfma_f32_16x16x32_bf16 v[136:139], a[232:235], a[84:87], v[136:139]
    s_waitcnt vmcnt(16)
    s_barrier
    s_waitcnt lgkmcnt(4)
    v_mfma_f32_16x16x32_bf16 v[140:143], a[232:235], a[88:91], v[140:143]
    ds_read_b64_tr_b16 a[216:217], v1 offset:0
    v_mfma_f32_16x16x32_bf16 v[144:147], a[232:235], a[92:95], v[144:147]
    ds_read_b64_tr_b16 a[218:219], v1 offset:2048
    v_mfma_f32_16x16x32_bf16 v[148:151], a[236:239], a[84:87], v[148:151]
    ds_read_b64_tr_b16 a[220:221], v2 offset:0
    v_cvt_pk_bf16_f32 v184, v136, v137
    v_mfma_f32_16x16x32_bf16 v[152:155], a[236:239], a[88:91], v[152:155]
    ds_read_b64_tr_b16 a[222:223], v2 offset:2048
    v_cvt_pk_bf16_f32 v185, v138, v139
    v_mfma_f32_16x16x32_bf16 v[156:159], a[236:239], a[92:95], v[156:159]
    s_add_u32 m0, s76, 49152
    s_add_u32 s72, s43, 131072
    s_waitcnt lgkmcnt(6)
    buffer_load_dwordx4 v6, s[24:27], s72 offen nt lds
    v_mfma_f32_16x16x32_bf16 v[160:163], a[240:243], a[84:87], v[160:163]
    ds_read_b64_tr_b16 a[224:225], v1 offset:512
    v_cvt_pk_bf16_f32 v188, v140, v141
    v_mfma_f32_16x16x32_bf16 v[164:167], a[240:243], a[88:91], v[164:167]
    ds_read_b64_tr_b16 a[226:227], v1 offset:2560
    v_cvt_pk_bf16_f32 v189, v142, v143
    v_mfma_f32_16x16x32_bf16 v[168:171], a[240:243], a[92:95], v[168:171]
    s_waitcnt lgkmcnt(6)
    v_cvt_pk_bf16_f32 v192, v144, v145
    v_cvt_pk_bf16_f32 v193, v146, v147
    v_mfma_f32_16x16x32_bf16 v[172:175], a[244:247], a[84:87], v[172:175]
    ds_read_b64_tr_b16 a[228:229], v2 offset:512
    v_cvt_pk_bf16_f32 v186, v148, v149
    v_mfma_f32_16x16x32_bf16 v[176:179], a[244:247], a[88:91], v[176:179]
    ds_read_b64_tr_b16 a[230:231], v2 offset:2560
    v_cvt_pk_bf16_f32 v187, v150, v151
    v_mfma_f32_16x16x32_bf16 v[180:183], a[244:247], a[92:95], v[180:183]
    s_waitcnt lgkmcnt(6)
    buffer_load_dwordx4 v7, s[24:27], s72 offen offset:1024 nt lds
    v_mfma_f32_16x16x32_bf16 v[136:139], a[216:219], a[96:99], 0
    ds_read_b64_tr_b16 a[232:233], v1 offset:4096
    v_cvt_pk_bf16_f32 v190, v152, v153
    v_mfma_f32_16x16x32_bf16 v[140:143], a[216:219], a[100:103], 0
    ds_read_b64_tr_b16 a[234:235], v1 offset:6144
    v_cvt_pk_bf16_f32 v191, v154, v155
    v_mfma_f32_16x16x32_bf16 v[144:147], a[216:219], a[104:107], 0
    s_add_u32 m0, s76, 57344
    s_waitcnt lgkmcnt(6)
    buffer_load_dwordx4 v8, s[24:27], s72 offen nt lds
    v_mfma_f32_16x16x32_bf16 v[148:151], a[220:223], a[96:99], 0
    ds_read_b64_tr_b16 a[236:237], v2 offset:4096
    v_cvt_pk_bf16_f32 v194, v156, v157
    v_mfma_f32_16x16x32_bf16 v[152:155], a[220:223], a[100:103], 0
    ds_read_b64_tr_b16 a[238:239], v2 offset:6144
    v_cvt_pk_bf16_f32 v195, v158, v159
    v_mfma_f32_16x16x32_bf16 v[156:159], a[220:223], a[104:107], 0
    s_waitcnt lgkmcnt(6)
    buffer_load_dwordx4 v9, s[24:27], s72 offen offset:1024 nt lds
    v_cvt_pk_bf16_f32 v196, v160, v161
    v_cvt_pk_bf16_f32 v197, v162, v163
    v_mfma_f32_16x16x32_bf16 v[160:163], a[224:227], a[96:99], 0
    ds_read_b64_tr_b16 a[240:241], v1 offset:4608
    v_cvt_pk_bf16_f32 v200, v164, v165
    v_cvt_pk_bf16_f32 v201, v166, v167
    v_mfma_f32_16x16x32_bf16 v[164:167], a[224:227], a[100:103], 0
    ds_read_b64_tr_b16 a[242:243], v1 offset:6656
    v_cvt_pk_bf16_f32 v204, v168, v169
    v_cvt_pk_bf16_f32 v205, v170, v171
    v_mfma_f32_16x16x32_bf16 v[168:171], a[224:227], a[104:107], 0
    s_waitcnt lgkmcnt(6)
    v_cvt_pk_bf16_f32 v198, v172, v173
    v_cvt_pk_bf16_f32 v199, v174, v175
    v_mfma_f32_16x16x32_bf16 v[172:175], a[228:231], a[96:99], 0
    ds_read_b64_tr_b16 a[244:245], v2 offset:4608
    v_cvt_pk_bf16_f32 v202, v176, v177
    v_cvt_pk_bf16_f32 v203, v178, v179
    v_mfma_f32_16x16x32_bf16 v[176:179], a[228:231], a[100:103], 0
    ds_read_b64_tr_b16 a[246:247], v2 offset:6656
    v_cvt_pk_bf16_f32 v206, v180, v181
    v_cvt_pk_bf16_f32 v207, v182, v183
    v_mfma_f32_16x16x32_bf16 v[180:183], a[228:231], a[104:107], 0
    s_waitcnt lgkmcnt(6)
    v_mfma_f32_16x16x32_bf16 v[136:139], a[232:235], a[108:111], v[136:139]
    ds_read_b64_tr_b16 a[216:217], v1 offset:8192
    v_mfma_f32_16x16x32_bf16 v[140:143], a[232:235], a[112:115], v[140:143]
    ds_read_b64_tr_b16 a[218:219], v1 offset:10240
    v_mfma_f32_16x16x32_bf16 v[144:147], a[232:235], a[116:119], v[144:147]
    s_waitcnt lgkmcnt(6)
    buffer_store_dwordx4 v[184:187], v3, s[28:31], s96 offen sc1
    v_mfma_f32_16x16x32_bf16 v[148:151], a[236:239], a[108:111], v[148:151]
    ds_read_b64_tr_b16 a[220:221], v2 offset:8192
    v_mfma_f32_16x16x32_bf16 v[152:155], a[236:239], a[112:115], v[152:155]
    ds_read_b64_tr_b16 a[222:223], v2 offset:10240
    v_mfma_f32_16x16x32_bf16 v[156:159], a[236:239], a[116:119], v[156:159]
    s_waitcnt lgkmcnt(6)
    v_mfma_f32_16x16x32_bf16 v[160:163], a[240:243], a[108:111], v[160:163]
    ds_read_b64_tr_b16 a[224:225], v1 offset:8704
    v_mfma_f32_16x16x32_bf16 v[164:167], a[240:243], a[112:115], v[164:167]
    ds_read_b64_tr_b16 a[226:227], v1 offset:10752
    v_mfma_f32_16x16x32_bf16 v[168:171], a[240:243], a[116:119], v[168:171]
    s_waitcnt lgkmcnt(6)
    buffer_store_dwordx4 v[188:191], v3, s[28:31], s96 offen offset:1024 sc1
    v_mfma_f32_16x16x32_bf16 v[172:175], a[244:247], a[108:111], v[172:175]
    ds_read_b64_tr_b16 a[228:229], v2 offset:8704
    v_mfma_f32_16x16x32_bf16 v[176:179], a[244:247], a[112:115], v[176:179]
    ds_read_b64_tr_b16 a[230:231], v2 offset:10752
    v_mfma_f32_16x16x32_bf16 v[180:183], a[244:247], a[116:119], v[180:183]
    s_waitcnt lgkmcnt(6)
    v_mfma_f32_16x16x32_bf16 v[136:139], a[216:219], a[120:123], v[136:139]
    ds_read_b64_tr_b16 a[232:233], v1 offset:12288
    v_mfma_f32_16x16x32_bf16 v[140:143], a[216:219], a[124:127], v[140:143]
    ds_read_b64_tr_b16 a[234:235], v1 offset:14336
    v_mfma_f32_16x16x32_bf16 v[144:147], a[216:219], a[128:131], v[144:147]
    s_waitcnt lgkmcnt(6)
    buffer_store_dwordx4 v[192:195], v3, s[28:31], s96 offen offset:2048 sc1
    v_mfma_f32_16x16x32_bf16 v[148:151], a[220:223], a[120:123], v[148:151]
    ds_read_b64_tr_b16 a[236:237], v2 offset:12288
    v_mfma_f32_16x16x32_bf16 v[152:155], a[220:223], a[124:127], v[152:155]
    ds_read_b64_tr_b16 a[238:239], v2 offset:14336
    v_mfma_f32_16x16x32_bf16 v[156:159], a[220:223], a[128:131], v[156:159]
    s_waitcnt lgkmcnt(6)
    v_mfma_f32_16x16x32_bf16 v[160:163], a[224:227], a[120:123], v[160:163]
    ds_read_b64_tr_b16 a[240:241], v1 offset:12800
    v_mfma_f32_16x16x32_bf16 v[164:167], a[224:227], a[124:127], v[164:167]
    ds_read_b64_tr_b16 a[242:243], v1 offset:14848
    v_mfma_f32_16x16x32_bf16 v[168:171], a[224:227], a[128:131], v[168:171]
    s_waitcnt lgkmcnt(6)
    buffer_store_dwordx4 v[196:199], v3, s[28:31], s96 offen offset:3072 sc1
    v_mfma_f32_16x16x32_bf16 v[172:175], a[228:231], a[120:123], v[172:175]
    ds_read_b64_tr_b16 a[244:245], v2 offset:12800
    v_mfma_f32_16x16x32_bf16 v[176:179], a[228:231], a[124:127], v[176:179]
    ds_read_b64_tr_b16 a[246:247], v2 offset:14848
    v_mfma_f32_16x16x32_bf16 v[180:183], a[228:231], a[128:131], v[180:183]
    s_waitcnt lgkmcnt(6)
    v_mfma_f32_16x16x32_bf16 v[136:139], a[232:235], a[132:135], v[136:139]
    s_waitcnt vmcnt(20)
    s_barrier
    s_waitcnt lgkmcnt(4)
    v_mfma_f32_16x16x32_bf16 v[140:143], a[232:235], a[136:139], v[140:143]
    ds_read_b64_tr_b16 a[216:217], v1 offset:16384
    v_mfma_f32_16x16x32_bf16 v[144:147], a[232:235], a[140:143], v[144:147]
    ds_read_b64_tr_b16 a[218:219], v1 offset:18432
    v_mfma_f32_16x16x32_bf16 v[148:151], a[236:239], a[132:135], v[148:151]
    ds_read_b64_tr_b16 a[220:221], v2 offset:16384
    v_mfma_f32_16x16x32_bf16 v[152:155], a[236:239], a[136:139], v[152:155]
    ds_read_b64_tr_b16 a[222:223], v2 offset:18432
    v_mfma_f32_16x16x32_bf16 v[156:159], a[236:239], a[140:143], v[156:159]
    s_waitcnt lgkmcnt(6)
    s_add_u32 s84, s97, 7
    s_and_b32 s84, s84, 7
    s_cmp_eq_u32 s82, 1
    s_cselect_b32 s84, s41, s84
    s_lshl_b32 s84, s84, 2
    s_add_u32 s84, s84, s40
    s_lshl_b32 s84, s84, 7
    s_add_u32 s15, s84, s23
    buffer_store_dwordx2 v[92:93], v96, s[28:31], s15 offen sc1
    v_mfma_f32_16x16x32_bf16 v[160:163], a[240:243], a[132:135], v[160:163]
    ds_read_b64_tr_b16 a[224:225], v1 offset:16896
    v_mfma_f32_16x16x32_bf16 v[164:167], a[240:243], a[136:139], v[164:167]
    ds_read_b64_tr_b16 a[226:227], v1 offset:18944
    v_mfma_f32_16x16x32_bf16 v[168:171], a[240:243], a[140:143], v[168:171]
    s_waitcnt lgkmcnt(6)
    buffer_store_dwordx4 v[200:203], v3, s[28:31], s18 offen sc1
    v_mfma_f32_16x16x32_bf16 v[172:175], a[244:247], a[132:135], v[172:175]
    ds_read_b64_tr_b16 a[228:229], v2 offset:16896
    v_mfma_f32_16x16x32_bf16 v[176:179], a[244:247], a[136:139], v[176:179]
    ds_read_b64_tr_b16 a[230:231], v2 offset:18944
    v_mfma_f32_16x16x32_bf16 v[180:183], a[244:247], a[140:143], v[180:183]
    s_waitcnt lgkmcnt(6)
    v_mfma_f32_16x16x32_bf16 v[136:139], a[216:219], a[144:147], v[136:139]
    ds_read_b64_tr_b16 a[232:233], v1 offset:20480
    v_mfma_f32_16x16x32_bf16 v[140:143], a[216:219], a[148:151], v[140:143]
    ds_read_b64_tr_b16 a[234:235], v1 offset:22528
    v_mfma_f32_16x16x32_bf16 v[144:147], a[216:219], a[152:155], v[144:147]
    s_waitcnt lgkmcnt(6)
    buffer_store_dwordx4 v[204:207], v3, s[28:31], s18 offen offset:1024 sc1
    v_mfma_f32_16x16x32_bf16 v[148:151], a[220:223], a[144:147], v[148:151]
    ds_read_b64_tr_b16 a[236:237], v2 offset:20480
    v_mfma_f32_16x16x32_bf16 v[152:155], a[220:223], a[148:151], v[152:155]
    ds_read_b64_tr_b16 a[238:239], v2 offset:22528
    v_mfma_f32_16x16x32_bf16 v[156:159], a[220:223], a[152:155], v[156:159]
    s_waitcnt lgkmcnt(6)
    v_mfma_f32_16x16x32_bf16 v[160:163], a[224:227], a[144:147], v[160:163]
    ds_read_b64_tr_b16 a[240:241], v1 offset:20992
    v_mfma_f32_16x16x32_bf16 v[164:167], a[224:227], a[148:151], v[164:167]
    ds_read_b64_tr_b16 a[242:243], v1 offset:23040
    v_mfma_f32_16x16x32_bf16 v[168:171], a[224:227], a[152:155], v[168:171]
    s_add_u32 m0, s76, 65536
    s_add_u32 s72, s43, 262144
    s_waitcnt lgkmcnt(6)
    buffer_load_dwordx4 v6, s[24:27], s72 offen nt lds
    v_mfma_f32_16x16x32_bf16 v[172:175], a[228:231], a[144:147], v[172:175]
    ds_read_b64_tr_b16 a[244:245], v2 offset:20992
    v_mfma_f32_16x16x32_bf16 v[176:179], a[228:231], a[148:151], v[176:179]
    ds_read_b64_tr_b16 a[246:247], v2 offset:23040
    v_mfma_f32_16x16x32_bf16 v[180:183], a[228:231], a[152:155], v[180:183]
    s_waitcnt lgkmcnt(6)
    v_mfma_f32_16x16x32_bf16 v[136:139], a[232:235], a[156:159], v[136:139]
    ds_read_b64_tr_b16 a[216:217], v1 offset:24576
    v_mfma_f32_16x16x32_bf16 v[140:143], a[232:235], a[160:163], v[140:143]
    ds_read_b64_tr_b16 a[218:219], v1 offset:26624
    v_mfma_f32_16x16x32_bf16 v[144:147], a[232:235], a[164:167], v[144:147]
    s_waitcnt lgkmcnt(6)
    buffer_load_dwordx4 v7, s[24:27], s72 offen offset:1024 nt lds
    v_mfma_f32_16x16x32_bf16 v[148:151], a[236:239], a[156:159], v[148:151]
    ds_read_b64_tr_b16 a[220:221], v2 offset:24576
    v_mfma_f32_16x16x32_bf16 v[152:155], a[236:239], a[160:163], v[152:155]
    ds_read_b64_tr_b16 a[222:223], v2 offset:26624
    v_mfma_f32_16x16x32_bf16 v[156:159], a[236:239], a[164:167], v[156:159]
    s_waitcnt lgkmcnt(6)
    v_mfma_f32_16x16x32_bf16 v[160:163], a[240:243], a[156:159], v[160:163]
    ds_read_b64_tr_b16 a[224:225], v1 offset:25088
    v_mfma_f32_16x16x32_bf16 v[164:167], a[240:243], a[160:163], v[164:167]
    ds_read_b64_tr_b16 a[226:227], v1 offset:27136
    v_mfma_f32_16x16x32_bf16 v[168:171], a[240:243], a[164:167], v[168:171]
    s_add_u32 m0, s76, 73728
    s_waitcnt lgkmcnt(6)
    buffer_load_dwordx4 v8, s[24:27], s72 offen nt lds
    v_mfma_f32_16x16x32_bf16 v[172:175], a[244:247], a[156:159], v[172:175]
    ds_read_b64_tr_b16 a[228:229], v2 offset:25088
    v_mfma_f32_16x16x32_bf16 v[176:179], a[244:247], a[160:163], v[176:179]
    ds_read_b64_tr_b16 a[230:231], v2 offset:27136
    v_mfma_f32_16x16x32_bf16 v[180:183], a[244:247], a[164:167], v[180:183]
    s_waitcnt lgkmcnt(6)
    v_mfma_f32_16x16x32_bf16 v[136:139], a[216:219], a[168:171], v[136:139]
    ds_read_b64_tr_b16 a[232:233], v1 offset:28672
    v_mfma_f32_16x16x32_bf16 v[140:143], a[216:219], a[172:175], v[140:143]
    ds_read_b64_tr_b16 a[234:235], v1 offset:30720
    v_mfma_f32_16x16x32_bf16 v[144:147], a[216:219], a[176:179], v[144:147]
    s_waitcnt lgkmcnt(6)
    buffer_load_dwordx4 v9, s[24:27], s72 offen offset:1024 nt lds
    v_mfma_f32_16x16x32_bf16 v[148:151], a[220:223], a[168:171], v[148:151]
    ds_read_b64_tr_b16 a[236:237], v2 offset:28672
    v_mfma_f32_16x16x32_bf16 v[152:155], a[220:223], a[172:175], v[152:155]
    ds_read_b64_tr_b16 a[238:239], v2 offset:30720
    v_mfma_f32_16x16x32_bf16 v[156:159], a[220:223], a[176:179], v[156:159]
    s_waitcnt lgkmcnt(6)
    v_mfma_f32_16x16x32_bf16 v[160:163], a[224:227], a[168:171], v[160:163]
    ds_read_b64_tr_b16 a[240:241], v1 offset:29184
    v_mfma_f32_16x16x32_bf16 v[164:167], a[224:227], a[172:175], v[164:167]
    ds_read_b64_tr_b16 a[242:243], v1 offset:31232
    v_mfma_f32_16x16x32_bf16 v[168:171], a[224:227], a[176:179], v[168:171]
    s_waitcnt lgkmcnt(6)
    v_mfma_f32_16x16x32_bf16 v[172:175], a[228:231], a[168:171], v[172:175]
    ds_read_b64_tr_b16 a[244:245], v2 offset:29184
    v_mfma_f32_16x16x32_bf16 v[176:179], a[228:231], a[172:175], v[176:179]
    ds_read_b64_tr_b16 a[246:247], v2 offset:31232
    v_mfma_f32_16x16x32_bf16 v[180:183], a[228:231], a[176:179], v[180:183]
    s_waitcnt lgkmcnt(6)
    v_mfma_f32_16x16x32_bf16 v[136:139], a[232:235], a[180:183], v[136:139]
    s_waitcnt vmcnt(23)
    s_barrier
    s_waitcnt lgkmcnt(4)
    v_mfma_f32_16x16x32_bf16 v[140:143], a[232:235], a[184:187], v[140:143]
    ds_read_b64_tr_b16 a[216:217], v1 offset:32768
    v_mfma_f32_16x16x32_bf16 v[144:147], a[232:235], a[188:191], v[144:147]
    ds_read_b64_tr_b16 a[218:219], v1 offset:34816
    v_mfma_f32_16x16x32_bf16 v[148:151], a[236:239], a[180:183], v[148:151]
    ds_read_b64_tr_b16 a[220:221], v2 offset:32768
    v_mfma_f32_16x16x32_bf16 v[152:155], a[236:239], a[184:187], v[152:155]
    ds_read_b64_tr_b16 a[222:223], v2 offset:34816
    v_mfma_f32_16x16x32_bf16 v[156:159], a[236:239], a[188:191], v[156:159]
    s_add_u32 m0, s76, 81920
    s_add_u32 s72, s43, 393216
    s_waitcnt lgkmcnt(6)
    buffer_load_dwordx4 v6, s[24:27], s72 offen nt lds
    v_mfma_f32_16x16x32_bf16 v[160:163], a[240:243], a[180:183], v[160:163]
    ds_read_b64_tr_b16 a[224:225], v1 offset:33280
    v_mfma_f32_16x16x32_bf16 v[164:167], a[240:243], a[184:187], v[164:167]
    ds_read_b64_tr_b16 a[226:227], v1 offset:35328
    v_mfma_f32_16x16x32_bf16 v[168:171], a[240:243], a[188:191], v[168:171]
    s_waitcnt lgkmcnt(6)
    v_mfma_f32_16x16x32_bf16 v[172:175], a[244:247], a[180:183], v[172:175]
    ds_read_b64_tr_b16 a[228:229], v2 offset:33280
    v_mfma_f32_16x16x32_bf16 v[176:179], a[244:247], a[184:187], v[176:179]
    ds_read_b64_tr_b16 a[230:231], v2 offset:35328
    v_mfma_f32_16x16x32_bf16 v[180:183], a[244:247], a[188:191], v[180:183]
    s_waitcnt lgkmcnt(6)
    v_mfma_f32_16x16x32_bf16 v[136:139], a[216:219], a[0:3], v[136:139]
    ds_read_b64_tr_b16 a[232:233], v1 offset:36864
    v_mfma_f32_16x16x32_bf16 v[140:143], a[216:219], a[4:7], v[140:143]
    ds_read_b64_tr_b16 a[234:235], v1 offset:38912
    v_mfma_f32_16x16x32_bf16 v[144:147], a[216:219], a[8:11], v[144:147]
    s_waitcnt lgkmcnt(6)
    buffer_load_dwordx4 v7, s[24:27], s72 offen offset:1024 nt lds
    v_mfma_f32_16x16x32_bf16 v[148:151], a[220:223], a[0:3], v[148:151]
    ds_read_b64_tr_b16 a[236:237], v2 offset:36864
    v_mfma_f32_16x16x32_bf16 v[152:155], a[220:223], a[4:7], v[152:155]
    ds_read_b64_tr_b16 a[238:239], v2 offset:38912
    v_mfma_f32_16x16x32_bf16 v[156:159], a[220:223], a[8:11], v[156:159]
    s_waitcnt lgkmcnt(6)
    v_mfma_f32_16x16x32_bf16 v[160:163], a[224:227], a[0:3], v[160:163]
    ds_read_b64_tr_b16 a[240:241], v1 offset:37376
    v_mfma_f32_16x16x32_bf16 v[164:167], a[224:227], a[4:7], v[164:167]
    ds_read_b64_tr_b16 a[242:243], v1 offset:39424
    v_mfma_f32_16x16x32_bf16 v[168:171], a[224:227], a[8:11], v[168:171]
    s_waitcnt lgkmcnt(6)
    v_mfma_f32_16x16x32_bf16 v[172:175], a[228:231], a[0:3], v[172:175]
    ds_read_b64_tr_b16 a[244:245], v2 offset:37376
    v_mfma_f32_16x16x32_bf16 v[176:179], a[228:231], a[4:7], v[176:179]
    ds_read_b64_tr_b16 a[246:247], v2 offset:39424
    v_mfma_f32_16x16x32_bf16 v[180:183], a[228:231], a[8:11], v[180:183]
    s_add_u32 m0, s76, 90112
    s_waitcnt lgkmcnt(6)
    buffer_load_dwordx4 v8, s[24:27], s72 offen nt lds
    v_mfma_f32_16x16x32_bf16 v[136:139], a[232:235], a[12:15], v[136:139]
    ds_read_b64_tr_b16 a[216:217], v1 offset:40960
    v_mfma_f32_16x16x32_bf16 v[140:143], a[232:235], a[16:19], v[140:143]
    ds_read_b64_tr_b16 a[218:219], v1 offset:43008
    v_mfma_f32_16x16x32_bf16 v[144:147], a[232:235], a[20:23], v[144:147]
    s_waitcnt lgkmcnt(6)
    v_mfma_f32_16x16x32_bf16 v[148:151], a[236:239], a[12:15], v[148:151]
    ds_read_b64_tr_b16 a[220:221], v2 offset:40960
    v_mfma_f32_16x16x32_bf16 v[152:155], a[236:239], a[16:19], v[152:155]
    ds_read_b64_tr_b16 a[222:223], v2 offset:43008
    v_mfma_f32_16x16x32_bf16 v[156:159], a[236:239], a[20:23], v[156:159]
    s_waitcnt lgkmcnt(6)
    v_mfma_f32_16x16x32_bf16 v[160:163], a[240:243], a[12:15], v[160:163]
    ds_read_b64_tr_b16 a[224:225], v1 offset:41472
    v_mfma_f32_16x16x32_bf16 v[164:167], a[240:243], a[16:19], v[164:167]
    ds_read_b64_tr_b16 a[226:227], v1 offset:43520
    v_mfma_f32_16x16x32_bf16 v[168:171], a[240:243], a[20:23], v[168:171]
    s_waitcnt lgkmcnt(6)
    v_mfma_f32_16x16x32_bf16 v[172:175], a[244:247], a[12:15], v[172:175]
    ds_read_b64_tr_b16 a[228:229], v2 offset:41472
    v_mfma_f32_16x16x32_bf16 v[176:179], a[244:247], a[16:19], v[176:179]
    ds_read_b64_tr_b16 a[230:231], v2 offset:43520
    v_mfma_f32_16x16x32_bf16 v[180:183], a[244:247], a[20:23], v[180:183]
    s_waitcnt lgkmcnt(6)
    buffer_load_dwordx4 v9, s[24:27], s72 offen offset:1024 nt lds
    v_mfma_f32_16x16x32_bf16 v[136:139], a[216:219], a[24:27], v[136:139]
    ds_read_b64_tr_b16 a[232:233], v1 offset:45056
    v_mfma_f32_16x16x32_bf16 v[140:143], a[216:219], a[28:31], v[140:143]
    ds_read_b64_tr_b16 a[234:235], v1 offset:47104
    v_mfma_f32_16x16x32_bf16 v[144:147], a[216:219], a[32:35], v[144:147]
    s_waitcnt lgkmcnt(6)
    v_mfma_f32_16x16x32_bf16 v[148:151], a[220:223], a[24:27], v[148:151]
    ds_read_b64_tr_b16 a[236:237], v2 offset:45056
    v_mfma_f32_16x16x32_bf16 v[152:155], a[220:223], a[28:31], v[152:155]
    ds_read_b64_tr_b16 a[238:239], v2 offset:47104
    v_mfma_f32_16x16x32_bf16 v[156:159], a[220:223], a[32:35], v[156:159]
    s_waitcnt lgkmcnt(6)
    v_mfma_f32_16x16x32_bf16 v[160:163], a[224:227], a[24:27], v[160:163]
    ds_read_b64_tr_b16 a[240:241], v1 offset:45568
    v_mfma_f32_16x16x32_bf16 v[164:167], a[224:227], a[28:31], v[164:167]
    ds_read_b64_tr_b16 a[242:243], v1 offset:47616
    v_mfma_f32_16x16x32_bf16 v[168:171], a[224:227], a[32:35], v[168:171]
    s_waitcnt lgkmcnt(6)
    v_mfma_f32_16x16x32_bf16 v[172:175], a[228:231], a[24:27], v[172:175]
    ds_read_b64_tr_b16 a[244:245], v2 offset:45568
    v_mfma_f32_16x16x32_bf16 v[176:179], a[228:231], a[28:31], v[176:179]
    ds_read_b64_tr_b16 a[246:247], v2 offset:47616
    v_mfma_f32_16x16x32_bf16 v[180:183], a[228:231], a[32:35], v[180:183]
    s_waitcnt lgkmcnt(6)
    v_mfma_f32_16x16x32_bf16 v[136:139], a[232:235], a[36:39], v[136:139]
    s_waitcnt vmcnt(23)
    s_barrier
    s_cmp_eq_u32 s82, 7
    s_cbranch_scc0 L_nofs
    buffer_load_dwordx2 v[88:89], v90, s[28:31], s78 offen sc1
L_nofs:
    s_waitcnt lgkmcnt(4)
    v_mfma_f32_16x16x32_bf16 v[140:143], a[232:235], a[40:43], v[140:143]
    ds_read_b64_tr_b16 a[216:217], v1 offset:49152
    s_xor_b32 s77, s77, 65536
    v_mfma_f32_16x16x32_bf16 v[144:147], a[232:235], a[44:47], v[144:147]
    ds_read_b64_tr_b16 a[218:219], v1 offset:51200
    s_add_u32 s76, s74, s77
    v_mfma_f32_16x16x32_bf16 v[148:151], a[236:239], a[36:39], v[148:151]
    ds_read_b64_tr_b16 a[220:221], v2 offset:49152
    s_add_u32 s97, s97, 1
    v_mfma_f32_16x16x32_bf16 v[152:155], a[236:239], a[40:43], v[152:155]
    ds_read_b64_tr_b16 a[222:223], v2 offset:51200
    s_and_b32 s97, s97, 7
    v_mfma_f32_16x16x32_bf16 v[156:159], a[236:239], a[44:47], v[156:159]
    s_lshl_b32 s84, s97, 3
    s_add_u32 s43, s43, 128
    s_and_b32 s43, s43, 1023
    s_add_u32 m0, s75, 98304
    s_mov_b32 s72, s43
    s_waitcnt lgkmcnt(6)
    buffer_load_dwordx4 v6, s[24:27], s72 offen nt lds
    v_mfma_f32_16x16x32_bf16 v[160:163], a[240:243], a[36:39], v[160:163]
    ds_read_b64_tr_b16 a[224:225], v1 offset:49664
    s_add_u32 s84, s84, s41
    v_mfma_f32_16x16x32_bf16 v[164:167], a[240:243], a[40:43], v[164:167]
    ds_read_b64_tr_b16 a[226:227], v1 offset:51712
    s_mul_i32 s96, s84, 24576
    v_mfma_f32_16x16x32_bf16 v[168:171], a[240:243], a[44:47], v[168:171]
    s_waitcnt lgkmcnt(6)
    s_add_u32 s18, s96, 4096
    s_add_u32 s82, s82, 1
    v_mfma_f32_16x16x32_bf16 v[172:175], a[244:247], a[36:39], v[172:175]
    ds_read_b64_tr_b16 a[228:229], v2 offset:49664
    v_mfma_f32_16x16x32_bf16 v[176:179], a[244:247], a[40:43], v[176:179]
    ds_read_b64_tr_b16 a[230:231], v2 offset:51712
    v_mfma_f32_16x16x32_bf16 v[180:183], a[244:247], a[44:47], v[180:183]
    s_waitcnt lgkmcnt(6)
    v_mfma_f32_16x16x32_bf16 v[136:139], a[216:219], a[48:51], v[136:139]
    ds_read_b64_tr_b16 a[232:233], v1 offset:53248
    v_mfma_f32_16x16x32_bf16 v[140:143], a[216:219], a[52:55], v[140:143]
    ds_read_b64_tr_b16 a[234:235], v1 offset:55296
    v_mfma_f32_16x16x32_bf16 v[144:147], a[216:219], a[56:59], v[144:147]
    s_waitcnt lgkmcnt(6)
    buffer_load_dwordx4 v7, s[24:27], s72 offen offset:1024 nt lds
    v_mfma_f32_16x16x32_bf16 v[148:151], a[220:223], a[48:51], v[148:151]
    ds_read_b64_tr_b16 a[236:237], v2 offset:53248
    v_mfma_f32_16x16x32_bf16 v[152:155], a[220:223], a[52:55], v[152:155]
    ds_read_b64_tr_b16 a[238:239], v2 offset:55296
    v_mfma_f32_16x16x32_bf16 v[156:159], a[220:223], a[56:59], v[156:159]
    s_waitcnt lgkmcnt(6)
    v_mfma_f32_16x16x32_bf16 v[160:163], a[224:227], a[48:51], v[160:163]
    ds_read_b64_tr_b16 a[240:241], v1 offset:53760
    v_mfma_f32_16x16x32_bf16 v[164:167], a[224:227], a[52:55], v[164:167]
    ds_read_b64_tr_b16 a[242:243], v1 offset:55808
    v_mfma_f32_16x16x32_bf16 v[168:171], a[224:227], a[56:59], v[168:171]
    s_waitcnt lgkmcnt(6)
    v_mfma_f32_16x16x32_bf16 v[172:175], a[228:231], a[48:51], v[172:175]
    ds_read_b64_tr_b16 a[244:245], v2 offset:53760
    v_mfma_f32_16x16x32_bf16 v[176:179], a[228:231], a[52:55], v[176:179]
    ds_read_b64_tr_b16 a[246:247], v2 offset:55808
    v_mfma_f32_16x16x32_bf16 v[180:183], a[228:231], a[56:59], v[180:183]
    s_add_u32 m0, s75, 106496
    s_waitcnt lgkmcnt(6)
    buffer_load_dwordx4 v8, s[24:27], s72 offen nt lds
    v_mfma_f32_16x16x32_bf16 v[136:139], a[232:235], a[60:63], v[136:139]
    ds_read_b64_tr_b16 a[216:217], v1 offset:57344
    s_sub_u32 s75, s74, s77
    v_mfma_f32_16x16x32_bf16 v[140:143], a[232:235], a[64:67], v[140:143]
    ds_read_b64_tr_b16 a[218:219], v1 offset:59392
    v_mfma_f32_16x16x32_bf16 v[144:147], a[232:235], a[68:71], v[144:147]
    s_waitcnt lgkmcnt(6)
    v_mfma_f32_16x16x32_bf16 v[148:151], a[236:239], a[60:63], v[148:151]
    ds_read_b64_tr_b16 a[220:221], v2 offset:57344
    v_mfma_f32_16x16x32_bf16 v[152:155], a[236:239], a[64:67], v[152:155]
    ds_read_b64_tr_b16 a[222:223], v2 offset:59392
    v_mfma_f32_16x16x32_bf16 v[156:159], a[236:239], a[68:71], v[156:159]
    s_waitcnt lgkmcnt(6)
    v_mfma_f32_16x16x32_bf16 v[160:163], a[240:243], a[60:63], v[160:163]
    ds_read_b64_tr_b16 a[224:225], v1 offset:57856
    v_mfma_f32_16x16x32_bf16 v[164:167], a[240:243], a[64:67], v[164:167]
    ds_read_b64_tr_b16 a[226:227], v1 offset:59904
    v_mfma_f32_16x16x32_bf16 v[168:171], a[240:243], a[68:71], v[168:171]
    s_waitcnt lgkmcnt(6)
    v_mfma_f32_16x16x32_bf16 v[172:175], a[244:247], a[60:63], v[172:175]
    ds_read_b64_tr_b16 a[228:229], v2 offset:57856
    v_mfma_f32_16x16x32_bf16 v[176:179], a[244:247], a[64:67], v[176:179]
    ds_read_b64_tr_b16 a[230:231], v2 offset:59904
    v_mfma_f32_16x16x32_bf16 v[180:183], a[244:247], a[68:71], v[180:183]
    s_waitcnt lgkmcnt(6)
    buffer_load_dwordx4 v9, s[24:27], s72 offen offset:1024 nt lds
    v_mfma_f32_16x16x32_bf16 v[136:139], a[216:219], a[72:75], v[136:139]
    ds_read_b64_tr_b16 a[232:233], v1 offset:61440
    v_mfma_f32_16x16x32_bf16 v[140:143], a[216:219], a[76:79], v[140:143]
    ds_read_b64_tr_b16 a[234:235], v1 offset:63488
    v_mfma_f32_16x16x32_bf16 v[144:147], a[216:219], a[80:83], v[144:147]
    s_waitcnt lgkmcnt(6)
    v_mfma_f32_16x16x32_bf16 v[148:151], a[220:223], a[72:75], v[148:151]
    ds_read_b64_tr_b16 a[236:237], v2 offset:61440
    v_mfma_f32_16x16x32_bf16 v[152:155], a[220:223], a[76:79], v[152:155]
    ds_read_b64_tr_b16 a[238:239], v2 offset:63488
    v_mfma_f32_16x16x32_bf16 v[156:159], a[220:223], a[80:83], v[156:159]
    s_waitcnt lgkmcnt(6)
    v_mfma_f32_16x16x32_bf16 v[160:163], a[224:227], a[72:75], v[160:163]
    ds_read_b64_tr_b16 a[240:241], v1 offset:61952
    v_mfma_f32_16x16x32_bf16 v[164:167], a[224:227], a[76:79], v[164:167]
    ds_read_b64_tr_b16 a[242:243], v1 offset:64000
    v_mfma_f32_16x16x32_bf16 v[168:171], a[224:227], a[80:83], v[168:171]
    s_waitcnt lgkmcnt(6)
    v_add_u32 v1, s83, v1
    v_mfma_f32_16x16x32_bf16 v[172:175], a[228:231], a[72:75], v[172:175]
    ds_read_b64_tr_b16 a[244:245], v2 offset:61952
    v_mfma_f32_16x16x32_bf16 v[176:179], a[228:231], a[76:79], v[176:179]
    ds_read_b64_tr_b16 a[246:247], v2 offset:64000
    v_mfma_f32_16x16x32_bf16 v[180:183], a[228:231], a[80:83], v[180:183]
    s_waitcnt lgkmcnt(6)
    v_add_u32 v2, s83, v2
    s_sub_u32 s83, 0, s83
    s_cmp_le_u32 s82, 7
    s_cbranch_scc1 L_WOS
L_WOL:
    v_mfma_f32_16x16x32_bf16 v[136:139], a[232:235], a[84:87], v[136:139]
    s_waitcnt vmcnt(23)
    s_barrier
    s_waitcnt vmcnt(4)
    s_mov_b32 s21, 0
    s_sub_u32 s84, s41, 1
    s_and_b32 s84, s84, 7
    s_lshl_b32 s84, 1, s84
    s_or_b32 s21, s21, s84
    s_sub_u32 s84, s41, 2
    s_and_b32 s84, s84, 7
    s_lshl_b32 s84, 1, s84
    s_or_b32 s21, s21, s84
    s_sub_u32 s84, s41, 3
    s_and_b32 s84, s84, 7
    s_lshl_b32 s84, 1, s84
    s_or_b32 s21, s21, s84
    s_sub_u32 s84, s41, 4
    s_and_b32 s84, s84, 7
    s_lshl_b32 s84, 1, s84
    s_or_b32 s21, s21, s84
    s_sub_u32 s84, s41, 5
    s_and_b32 s84, s84, 7
    s_lshl_b32 s84, 1, s84
    s_or_b32 s21, s21, s84
    v_cmp_eq_u32 s[70:71], v92, v88
    v_cmp_eq_u32 vcc, v93, v89
    s_nop 3
    s_and_b32 s70, s70, vcc_lo
    s_and_b32 s70, s70, s21
    s_cmp_eq_u32 s70, s21
    s_cselect_b32 s81, 1, 0
    s_waitcnt lgkmcnt(4)
    v_mfma_f32_16x16x32_bf16 v[140:143], a[232:235], a[88:91], v[140:143]
    ds_read_b64_tr_b16 a[216:217], v1 offset:0
    v_mfma_f32_16x16x32_bf16 v[144:147], a[232:235], a[92:95], v[144:147]
    ds_read_b64_tr_b16 a[218:219], v1 offset:2048
    v_mfma_f32_16x16x32_bf16 v[148:151], a[236:239], a[84:87], v[148:151]
    ds_read_b64_tr_b16 a[220:221], v2 offset:0
    v_cvt_pk_bf16_f32 v184, v136, v137
    v_mfma_f32_16x16x32_bf16 v[152:155], a[236:239], a[88:91], v[152:155]
    ds_read_b64_tr_b16 a[222:223], v2 offset:2048
    v_cvt_pk_bf16_f32 v185, v138, v139
    v_mfma_f32_16x16x32_bf16 v[156:159], a[236:239], a[92:95], v[156:159]
    s_waitcnt lgkmcnt(6)
    s_sub_u32 s84, s41, 1
    s_and_b32 s84, s84, 7
    s_lshl_b32 s21, 1, s84
    s_lshl_b32 s85, s41, 3
    s_add_u32 s84, s84, s85
    s_mul_i32 s20, s84, 24576
    s_cmp_lg_u32 s81, 0
    s_cselect_b32 s20, s20, s19
    s_add_u32 s22, s20, 4096
    buffer_load_dwordx4 v[16:19], v3, s[28:31], s20 offen sc1
    v_mfma_f32_16x16x32_bf16 v[160:163], a[240:243], a[84:87], v[160:163]
    ds_read_b64_tr_b16 a[224:225], v1 offset:512
    v_cvt_pk_bf16_f32 v188, v140, v141
    v_mfma_f32_16x16x32_bf16 v[164:167], a[240:243], a[88:91], v[164:167]
    ds_read_b64_tr_b16 a[226:227], v1 offset:2560
    v_cvt_pk_bf16_f32 v189, v142, v143
    v_mfma_f32_16x16x32_bf16 v[168:171], a[240:243], a[92:95], v[168:171]
    s_waitcnt lgkmcnt(6)
    buffer_load_dwordx4 v[20:23], v3, s[28:31], s20 offen offset:1024 sc1
    v_mfma_f32_16x16x32_bf16 v[172:175], a[244:247], a[84:87], v[172:175]
    ds_read_b64_tr_b16 a[228:229], v2 offset:512
    v_cvt_pk_bf16_f32 v192, v144, v145
    v_mfma_f32_16x16x32_bf16 v[176:179], a[244:247], a[88:91], v[176:179]
    ds_read_b64_tr_b16 a[230:231], v2 offset:2560
    v_cvt_pk_bf16_f32 v193, v146, v147
    v_mfma_f32_16x16x32_bf16 v[180:183], a[244:247], a[92:95], v[180:183]
    s_waitcnt lgkmcnt(6)
    buffer_load_dwordx4 v[24:27], v3, s[28:31], s20 offen offset:2048 sc1
    v_mfma_f32_16x16x32_bf16 v[136:139], a[216:219], a[96:99], 0
    ds_read_b64_tr_b16 a[232:233], v1 offset:4096
    v_cvt_pk_bf16_f32 v186, v148, v149
    v_mfma_f32_16x16x32_bf16 v[140:143], a[216:219], a[100:103], 0
    ds_read_b64_tr_b16 a[234:235], v1 offset:6144
    v_cvt_pk_bf16_f32 v187, v150, v151
    v_mfma_f32_16x16x32_bf16 v[144:147], a[216:219], a[104:107], 0
    s_waitcnt lgkmcnt(6)
    buffer_load_dwordx4 v[28:31], v3, s[28:31], s20 offen offset:3072 sc1
    v_mfma_f32_16x16x32_bf16 v[148:151], a[220:223], a[96:99], 0
    ds_read_b64_tr_b16 a[236:237], v2 offset:4096
    v_cvt_pk_bf16_f32 v190, v152, v153
    v_cvt_pk_bf16_f32 v191, v154, v155
    v_mfma_f32_16x16x32_bf16 v[152:155], a[220:223], a[100:103], 0
    ds_read_b64_tr_b16 a[238:239], v2 offset:6144
    v_cvt_pk_bf16_f32 v194, v156, v157
    v_cvt_pk_bf16_f32 v195, v158, v159
    v_mfma_f32_16x16x32_bf16 v[156:159], a[220:223], a[104:107], 0
    s_waitcnt lgkmcnt(6)
    buffer_load_dwordx4 v[32:35], v3, s[28:31], s22 offen sc1
    v_cvt_pk_bf16_f32 v196, v160, v161
    v_cvt_pk_bf16_f32 v197, v162, v163
    v_mfma_f32_16x16x32_bf16 v[160:163], a[224:227], a[96:99], 0
    ds_read_b64_tr_b16 a[240:241], v1 offset:4608
    v_cvt_pk_bf16_f32 v200, v164, v165
    v_cvt_pk_bf16_f32 v201, v166, v167
    v_mfma_f32_16x16x32_bf16 v[164:167], a[224:227], a[100:103], 0
    ds_read_b64_tr_b16 a[242:243], v1 offset:6656
    v_cvt_pk_bf16_f32 v204, v168, v169
    v_cvt_pk_bf16_f32 v205, v170, v171
    v_mfma_f32_16x16x32_bf16 v[168:171], a[224:227], a[104:107], 0
    s_waitcnt lgkmcnt(6)
    buffer_load_dwordx4 v[36:39], v3, s[28:31], s22 offen offset:1024 sc1
    v_cvt_pk_bf16_f32 v198, v172, v173
    v_cvt_pk_bf16_f32 v199, v174, v175
    v_mfma_f32_16x16x32_bf16 v[172:175], a[228:231], a[96:99], 0
    ds_read_b64_tr_b16 a[244:245], v2 offset:4608
    v_cvt_pk_bf16_f32 v202, v176, v177
    v_cvt_pk_bf16_f32 v203, v178, v179
    v_mfma_f32_16x16x32_bf16 v[176:179], a[228:231], a[100:103], 0
    ds_read_b64_tr_b16 a[246:247], v2 offset:6656
    v_cvt_pk_bf16_f32 v206, v180, v181
    v_cvt_pk_bf16_f32 v207, v182, v183
    v_mfma_f32_16x16x32_bf16 v[180:183], a[228:231], a[104:107], 0
    s_waitcnt lgkmcnt(6)
    s_sub_u32 s84, s41, 2
    s_and_b32 s84, s84, 7
    s_lshl_b32 s21, 1, s84
    s_lshl_b32 s85, s41, 3
    s_add_u32 s84, s84, s85
    s_mul_i32 s20, s84, 24576
    s_cmp_lg_u32 s81, 0
    s_cselect_b32 s20, s20, s19
    s_add_u32 s22, s20, 4096
    buffer_load_dwordx4 v[40:43], v3, s[28:31], s20 offen sc1
    v_mfma_f32_16x16x32_bf16 v[136:139], a[232:235], a[108:111], v[136:139]
    ds_read_b64_tr_b16 a[216:217], v1 offset:8192
    v_mfma_f32_16x16x32_bf16 v[140:143], a[232:235], a[112:115], v[140:143]
    ds_read_b64_tr_b16 a[218:219], v1 offset:10240
    v_mfma_f32_16x16x32_bf16 v[144:147], a[232:235], a[116:119], v[144:147]
    s_waitcnt lgkmcnt(6)
    buffer_load_dwordx4 v[44:47], v3, s[28:31], s20 offen offset:1024 sc1
    v_mfma_f32_16x16x32_bf16 v[148:151], a[236:239], a[108:111], v[148:151]
    ds_read_b64_tr_b16 a[220:221], v2 offset:8192
    v_mfma_f32_16x16x32_bf16 v[152:155], a[236:239], a[112:115], v[152:155]
    ds_read_b64_tr_b16 a[222:223], v2 offset:10240
    v_mfma_f32_16x16x32_bf16 v[156:159], a[236:239], a[116:119], v[156:159]
    s_waitcnt lgkmcnt(6)
    buffer_store_dwordx4 v[184:187], v3, s[28:31], s96 offen sc1
    v_mfma_f32_16x16x32_bf16 v[160:163], a[240:243], a[108:111], v[160:163]
    ds_read_b64_tr_b16 a[224:225], v1 offset:8704
    v_mfma_f32_16x16x32_bf16 v[164:167], a[240:243], a[112:115], v[164:167]
    ds_read_b64_tr_b16 a[226:227], v1 offset:10752
    v_mfma_f32_16x16x32_bf16 v[168:171], a[240:243], a[116:119], v[168:171]
    s_waitcnt lgkmcnt(6)
    buffer_store_dwordx4 v[188:191], v3, s[28:31], s96 offen offset:1024 sc1
    v_mfma_f32_16x16x32_bf16 v[172:175], a[244:247], a[108:111], v[172:175]
    ds_read_b64_tr_b16 a[228:229], v2 offset:8704
    v_mfma_f32_16x16x32_bf16 v[176:179], a[244:247], a[112:115], v[176:179]
    ds_read_b64_tr_b16 a[230:231], v2 offset:10752
    v_mfma_f32_16x16x32_bf16 v[180:183], a[244:247], a[116:119], v[180:183]
    s_waitcnt lgkmcnt(6)
    v_mfma_f32_16x16x32_bf16 v[136:139], a[216:219], a[120:123], v[136:139]
    ds_read_b64_tr_b16 a[232:233], v1 offset:12288
    v_mfma_f32_16x16x32_bf16 v[140:143], a[216:219], a[124:127], v[140:143]
    ds_read_b64_tr_b16 a[234:235], v1 offset:14336
    v_mfma_f32_16x16x32_bf16 v[144:147], a[216:219], a[128:131], v[144:147]
    s_waitcnt lgkmcnt(6)
    buffer_store_dwordx4 v[192:195], v3, s[28:31], s96 offen offset:2048 sc1
    v_mfma_f32_16x16x32_bf16 v[148:151], a[220:223], a[120:123], v[148:151]
    ds_read_b64_tr_b16 a[236:237], v2 offset:12288
    v_mfma_f32_16x16x32_bf16 v[152:155], a[220:223], a[124:127], v[152:155]
    ds_read_b64_tr_b16 a[238:239], v2 offset:14336
    v_mfma_f32_16x16x32_bf16 v[156:159], a[220:223], a[128:131], v[156:159]
    s_waitcnt lgkmcnt(6)
    v_mfma_f32_16x16x32_bf16 v[160:163], a[224:227], a[120:123], v[160:163]
    ds_read_b64_tr_b16 a[240:241], v1 offset:12800
    v_mfma_f32_16x16x32_bf16 v[164:167], a[224:227], a[124:127], v[164:167]
    ds_read_b64_tr_b16 a[242:243], v1 offset:14848
    v_mfma_f32_16x16x32_bf16 v[168:171], a[224:227], a[128:131], v[168:171]
    s_waitcnt lgkmcnt(6)
    buffer_store_dwordx4 v[196:199], v3, s[28:31], s96 offen offset:3072 sc1
    v_mfma_f32_16x16x32_bf16 v[172:175], a[228:231], a[120:123], v[172:175]
    ds_read_b64_tr_b16 a[244:245], v2 offset:12800
    v_mfma_f32_16x16x32_bf16 v[176:179], a[228:231], a[124:127], v[176:179]
    ds_read_b64_tr_b16 a[246:247], v2 offset:14848
    v_mfma_f32_16x16x32_bf16 v[180:183], a[228:231], a[128:131], v[180:183]
    s_waitcnt lgkmcnt(6)
    v_mfma_f32_16x16x32_bf16 v[136:139], a[232:235], a[132:135], v[136:139]
    s_waitcnt vmcnt(24)
    s_barrier
    s_waitcnt lgkmcnt(4)
    v_mfma_f32_16x16x32_bf16 v[140:143], a[232:235], a[136:139], v[140:143]
    ds_read_b64_tr_b16 a[216:217], v1 offset:16384
    v_mfma_f32_16x16x32_bf16 v[144:147], a[232:235], a[140:143], v[144:147]
    ds_read_b64_tr_b16 a[218:219], v1 offset:18432
    v_mfma_f32_16x16x32_bf16 v[148:151], a[236:239], a[132:135], v[148:151]
    ds_read_b64_tr_b16 a[220:221], v2 offset:16384
    v_mfma_f32_16x16x32_bf16 v[152:155], a[236:239], a[136:139], v[152:155]
    ds_read_b64_tr_b16 a[222:223], v2 offset:18432
    v_mfma_f32_16x16x32_bf16 v[156:159], a[236:239], a[140:143], v[156:159]
    s_waitcnt lgkmcnt(6)
    s_add_u32 s84, s97, 7
    s_and_b32 s84, s84, 7
    s_cmp_eq_u32 s82, 1
    s_cselect_b32 s84, s41, s84
    s_lshl_b32 s84, s84, 2
    s_add_u32 s84, s84, s40
    s_lshl_b32 s84, s84, 7
    s_add_u32 s15, s84, s23
    buffer_store_dwordx2 v[92:93], v96, s[28:31], s15 offen sc1
    v_mfma_f32_16x16x32_bf16 v[160:163], a[240:243], a[132:135], v[160:163]
    ds_read_b64_tr_b16 a[224:225], v1 offset:16896
    v_mfma_f32_16x16x32_bf16 v[164:167], a[240:243], a[136:139], v[164:167]
    ds_read_b64_tr_b16 a[226:227], v1 offset:18944
    v_mfma_f32_16x16x32_bf16 v[168:171], a[240:243], a[140:143], v[168:171]
    s_waitcnt lgkmcnt(6)
    buffer_store_dwordx4 v[200:203], v3, s[28:31], s18 offen sc1
    v_mfma_f32_16x16x32_bf16 v[172:175], a[244:247], a[132:135], v[172:175]
    ds_read_b64_tr_b16 a[228:229], v2 offset:16896
    v_mfma_f32_16x16x32_bf16 v[176:179], a[244:247], a[136:139], v[176:179]
    ds_read_b64_tr_b16 a[230:231], v2 offset:18944
    v_mfma_f32_16x16x32_bf16 v[180:183], a[244:247], a[140:143], v[180:183]
    s_waitcnt lgkmcnt(6)
    v_mfma_f32_16x16x32_bf16 v[136:139], a[216:219], a[144:147], v[136:139]
    ds_read_b64_tr_b16 a[232:233], v1 offset:20480
    v_mfma_f32_16x16x32_bf16 v[140:143], a[216:219], a[148:151], v[140:143]
    ds_read_b64_tr_b16 a[234:235], v1 offset:22528
    v_mfma_f32_16x16x32_bf16 v[144:147], a[216:219], a[152:155], v[144:147]
    s_waitcnt lgkmcnt(6)
    buffer_store_dwordx4 v[204:207], v3, s[28:31], s18 offen offset:1024 sc1
    v_mfma_f32_16x16x32_bf16 v[148:151], a[220:223], a[144:147], v[148:151]
    ds_read_b64_tr_b16 a[236:237], v2 offset:20480
    v_mfma_f32_16x16x32_bf16 v[152:155], a[220:223], a[148:151], v[152:155]
    ds_read_b64_tr_b16 a[238:239], v2 offset:22528
    v_mfma_f32_16x16x32_bf16 v[156:159], a[220:223], a[152:155], v[156:159]
    s_waitcnt lgkmcnt(6)
    buffer_load_dwordx4 v[48:51], v3, s[28:31], s20 offen offset:2048 sc1
    v_mfma_f32_16x16x32_bf16 v[160:163], a[224:227], a[144:147], v[160:163]
    ds_read_b64_tr_b16 a[240:241], v1 offset:20992
    v_mfma_f32_16x16x32_bf16 v[164:167], a[224:227], a[148:151], v[164:167]
    ds_read_b64_tr_b16 a[242:243], v1 offset:23040
    v_mfma_f32_16x16x32_bf16 v[168:171], a[224:227], a[152:155], v[168:171]
    s_waitcnt lgkmcnt(6)
    buffer_load_dwordx4 v[52:55], v3, s[28:31], s20 offen offset:3072 sc1
    v_mfma_f32_16x16x32_bf16 v[172:175], a[228:231], a[144:147], v[172:175]
    ds_read_b64_tr_b16 a[244:245], v2 offset:20992
    v_mfma_f32_16x16x32_bf16 v[176:179], a[228:231], a[148:151], v[176:179]
    ds_read_b64_tr_b16 a[246:247], v2 offset:23040
    v_mfma_f32_16x16x32_bf16 v[180:183], a[228:231], a[152:155], v[180:183]
    s_waitcnt lgkmcnt(6)
    buffer_load_dwordx4 v[56:59], v3, s[28:31], s22 offen sc1
    v_mfma_f32_16x16x32_bf16 v[136:139], a[232:235], a[156:159], v[136:139]
    ds_read_b64_tr_b16 a[216:217], v1 offset:24576
    v_mfma_f32_16x16x32_bf16 v[140:143], a[232:235], a[160:163], v[140:143]
    ds_read_b64_tr_b16 a[218:219], v1 offset:26624
    v_mfma_f32_16x16x32_bf16 v[144:147], a[232:235], a[164:167], v[144:147]
    s_waitcnt lgkmcnt(6)
    buffer_load_dwordx4 v[60:63], v3, s[28:31], s22 offen offset:1024 sc1
    v_mfma_f32_16x16x32_bf16 v[148:151], a[236:239], a[156:159], v[148:151]
    ds_read_b64_tr_b16 a[220:221], v2 offset:24576
    v_mfma_f32_16x16x32_bf16 v[152:155], a[236:239], a[160:163], v[152:155]
    ds_read_b64_tr_b16 a[222:223], v2 offset:26624
    v_mfma_f32_16x16x32_bf16 v[156:159], a[236:239], a[164:167], v[156:159]
    s_waitcnt lgkmcnt(6)
    v_mfma_f32_16x16x32_bf16 v[160:163], a[240:243], a[156:159], v[160:163]
    ds_read_b64_tr_b16 a[224:225], v1 offset:25088
    v_mfma_f32_16x16x32_bf16 v[164:167], a[240:243], a[160:163], v[164:167]
    ds_read_b64_tr_b16 a[226:227], v1 offset:27136
    v_mfma_f32_16x16x32_bf16 v[168:171], a[240:243], a[164:167], v[168:171]
    s_waitcnt lgkmcnt(6)
    s_sub_u32 s84, s41, 3
    s_and_b32 s84, s84, 7
    s_lshl_b32 s21, 1, s84
    s_lshl_b32 s85, s41, 3
    s_add_u32 s84, s84, s85
    s_mul_i32 s20, s84, 24576
    s_cmp_lg_u32 s81, 0
    s_cselect_b32 s20, s20, s19
    s_add_u32 s22, s20, 4096
    buffer_load_dwordx4 v[64:67], v3, s[28:31], s20 offen sc1
    v_mfma_f32_16x16x32_bf16 v[172:175], a[244:247], a[156:159], v[172:175]
    ds_read_b64_tr_b16 a[228:229], v2 offset:25088
    v_mfma_f32_16x16x32_bf16 v[176:179], a[244:247], a[160:163], v[176:179]
    ds_read_b64_tr_b16 a[230:231], v2 offset:27136
    v_mfma_f32_16x16x32_bf16 v[180:183], a[244:247], a[164:167], v[180:183]
    s_waitcnt lgkmcnt(6)
    buffer_load_dwordx4 v[68:71], v3, s[28:31], s20 offen offset:1024 sc1
    v_mfma_f32_16x16x32_bf16 v[136:139], a[216:219], a[168:171], v[136:139]
    ds_read_b64_tr_b16 a[232:233], v1 offset:28672
    v_mfma_f32_16x16x32_bf16 v[140:143], a[216:219], a[172:175], v[140:143]
    ds_read_b64_tr_b16 a[234:235], v1 offset:30720
    v_mfma_f32_16x16x32_bf16 v[144:147], a[216:219], a[176:179], v[144:147]
    s_waitcnt lgkmcnt(6)
    buffer_load_dwordx4 v[72:75], v3, s[28:31], s20 offen offset:2048 sc1
    v_mfma_f32_16x16x32_bf16 v[148:151], a[220:223], a[168:171], v[148:151]
    ds_read_b64_tr_b16 a[236:237], v2 offset:28672
    v_mfma_f32_16x16x32_bf16 v[152:155], a[220:223], a[172:175], v[152:155]
    ds_read_b64_tr_b16 a[238:239], v2 offset:30720
    v_mfma_f32_16x16x32_bf16 v[156:159], a[220:223], a[176:179], v[156:159]
    s_waitcnt lgkmcnt(6)
    v_mfma_f32_16x16x32_bf16 v[160:163], a[224:227], a[168:171], v[160:163]
    ds_read_b64_tr_b16 a[240:241], v1 offset:29184
    v_mfma_f32_16x16x32_bf16 v[164:167], a[224:227], a[172:175], v[164:167]
    ds_read_b64_tr_b16 a[242:243], v1 offset:31232
    v_mfma_f32_16x16x32_bf16 v[168:171], a[224:227], a[176:179], v[168:171]
    s_waitcnt lgkmcnt(6)
    buffer_load_dwordx4 v[76:79], v3, s[28:31], s20 offen offset:3072 sc1
    v_mfma_f32_16x16x32_bf16 v[172:175], a[228:231], a[168:171], v[172:175]
    ds_read_b64_tr_b16 a[244:245], v2 offset:29184
    v_mfma_f32_16x16x32_bf16 v[176:179], a[228:231], a[172:175], v[176:179]
    ds_read_b64_tr_b16 a[246:247], v2 offset:31232
    v_mfma_f32_16x16x32_bf16 v[180:183], a[228:231], a[176:179], v[180:183]
    s_waitcnt lgkmcnt(6)
    v_mfma_f32_16x16x32_bf16 v[136:139], a[232:235], a[180:183], v[136:139]
    s_waitcnt vmcnt(31)
    s_barrier
    s_waitcnt lgkmcnt(4)
    v_mfma_f32_16x16x32_bf16 v[140:143], a[232:235], a[184:187], v[140:143]
    ds_read_b64_tr_b16 a[216:217], v1 offset:32768
    v_mfma_f32_16x16x32_bf16 v[144:147], a[232:235], a[188:191], v[144:147]
    ds_read_b64_tr_b16 a[218:219], v1 offset:34816
    v_mfma_f32_16x16x32_bf16 v[148:151], a[236:239], a[180:183], v[148:151]
    ds_read_b64_tr_b16 a[220:221], v2 offset:32768
    v_mfma_f32_16x16x32_bf16 v[152:155], a[236:239], a[184:187], v[152:155]
    ds_read_b64_tr_b16 a[222:223], v2 offset:34816
    v_mfma_f32_16x16x32_bf16 v[156:159], a[236:239], a[188:191], v[156:159]
    s_waitcnt lgkmcnt(6)
    buffer_load_dwordx4 v[80:83], v3, s[28:31], s22 offen sc1
    v_mfma_f32_16x16x32_bf16 v[160:163], a[240:243], a[180:183], v[160:163]
    ds_read_b64_tr_b16 a[224:225], v1 offset:33280
    v_mfma_f32_16x16x32_bf16 v[164:167], a[240:243], a[184:187], v[164:167]
    ds_read_b64_tr_b16 a[226:227], v1 offset:35328
    v_mfma_f32_16x16x32_bf16 v[168:171], a[240:243], a[188:191], v[168:171]
    s_waitcnt lgkmcnt(6)
    buffer_load_dwordx4 v[84:87], v3, s[28:31], s22 offen offset:1024 sc1
    v_mfma_f32_16x16x32_bf16 v[172:175], a[244:247], a[180:183], v[172:175]
    ds_read_b64_tr_b16 a[228:229], v2 offset:33280
    v_mfma_f32_16x16x32_bf16 v[176:179], a[244:247], a[184:187], v[176:179]
    ds_read_b64_tr_b16 a[230:231], v2 offset:35328
    v_mfma_f32_16x16x32_bf16 v[180:183], a[244:247], a[188:191], v[180:183]
    s_waitcnt lgkmcnt(6)
    v_mfma_f32_16x16x32_bf16 v[136:139], a[216:219], a[0:3], v[136:139]
    ds_read_b64_tr_b16 a[232:233], v1 offset:36864
    v_mfma_f32_16x16x32_bf16 v[140:143], a[216:219], a[4:7], v[140:143]
    ds_read_b64_tr_b16 a[234:235], v1 offset:38912
    v_mfma_f32_16x16x32_bf16 v[144:147], a[216:219], a[8:11], v[144:147]
    s_waitcnt lgkmcnt(6)
    s_sub_u32 s84, s41, 4
    s_and_b32 s84, s84, 7
    s_lshl_b32 s21, 1, s84
    s_lshl_b32 s85, s41, 3
    s_add_u32 s84, s84, s85
    s_mul_i32 s20, s84, 24576
    s_cmp_lg_u32 s81, 0
    s_cselect_b32 s20, s20, s19
    s_add_u32 s22, s20, 4096
    buffer_load_dwordx4 v[104:107], v3, s[28:31], s20 offen sc1
    v_mfma_f32_16x16x32_bf16 v[148:151], a[220:223], a[0:3], v[148:151]
    ds_read_b64_tr_b16 a[236:237], v2 offset:36864
    v_mfma_f32_16x16x32_bf16 v[152:155], a[220:223], a[4:7], v[152:155]
    ds_read_b64_tr_b16 a[238:239], v2 offset:38912
    v_mfma_f32_16x16x32_bf16 v[156:159], a[220:223], a[8:11], v[156:159]
    s_waitcnt lgkmcnt(6)
    v_mfma_f32_16x16x32_bf16 v[160:163], a[224:227], a[0:3], v[160:163]
    ds_read_b64_tr_b16 a[240:241], v1 offset:37376
    v_mfma_f32_16x16x32_bf16 v[164:167], a[224:227], a[4:7], v[164:167]
    ds_read_b64_tr_b16 a[242:243], v1 offset:39424
    v_mfma_f32_16x16x32_bf16 v[168:171], a[224:227], a[8:11], v[168:171]
    s_waitcnt lgkmcnt(6)
    buffer_load_dwordx4 v[108:111], v3, s[28:31], s20 offen offset:1024 sc1
    v_mfma_f32_16x16x32_bf16 v[172:175], a[228:231], a[0:3], v[172:175]
    ds_read_b64_tr_b16 a[244:245], v2 offset:37376
    v_mfma_f32_16x16x32_bf16 v[176:179], a[228:231], a[4:7], v[176:179]
    ds_read_b64_tr_b16 a[246:247], v2 offset:39424
    v_mfma_f32_16x16x32_bf16 v[180:183], a[228:231], a[8:11], v[180:183]
    s_waitcnt lgkmcnt(6)
    v_mfma_f32_16x16x32_bf16 v[136:139], a[232:235], a[12:15], v[136:139]
    ds_read_b64_tr_b16 a[216:217], v1 offset:40960
    v_mfma_f32_16x16x32_bf16 v[140:143], a[232:235], a[16:19], v[140:143]
    ds_read_b64_tr_b16 a[218:219], v1 offset:43008
    v_mfma_f32_16x16x32_bf16 v[144:147], a[232:235], a[20:23], v[144:147]
    s_waitcnt lgkmcnt(6)
    buffer_load_dwordx4 v[112:115], v3, s[28:31], s20 offen offset:2048 sc1
    v_mfma_f32_16x16x32_bf16 v[148:151], a[236:239], a[12:15], v[148:151]
    ds_read_b64_tr_b16 a[220:221], v2 offset:40960
    v_mfma_f32_16x16x32_bf16 v[152:155], a[236:239], a[16:19], v[152:155]
    ds_read_b64_tr_b16 a[222:223], v2 offset:43008
    v_mfma_f32_16x16x32_bf16 v[156:159], a[236:239], a[20:23], v[156:159]
    s_waitcnt lgkmcnt(6)
    buffer_load_dwordx4 v[116:119], v3, s[28:31], s20 offen offset:3072 sc1
    v_mfma_f32_16x16x32_bf16 v[160:163], a[240:243], a[12:15], v[160:163]
    ds_read_b64_tr_b16 a[224:225], v1 offset:41472
    v_mfma_f32_16x16x32_bf16 v[164:167], a[240:243], a[16:19], v[164:167]
    ds_read_b64_tr_b16 a[226:227], v1 offset:43520
    v_mfma_f32_16x16x32_bf16 v[168:171], a[240:243], a[20:23], v[168:171]
    s_waitcnt lgkmcnt(6)
    v_mfma_f32_16x16x32_bf16 v[172:175], a[244:247], a[12:15], v[172:175]
    ds_read_b64_tr_b16 a[228:229], v2 offset:41472
    v_mfma_f32_16x16x32_bf16 v[176:179], a[244:247], a[16:19], v[176:179]
    ds_read_b64_tr_b16 a[230:231], v2 offset:43520
    v_mfma_f32_16x16x32_bf16 v[180:183], a[244:247], a[20:23], v[180:183]
    s_waitcnt lgkmcnt(6)
    buffer_load_dwordx4 v[120:123], v3, s[28:31], s22 offen sc1
    v_mfma_f32_16x16x32_bf16 v[136:139], a[216:219], a[24:27], v[136:139]
    ds_read_b64_tr_b16 a[232:233], v1 offset:45056
    v_mfma_f32_16x16x32_bf16 v[140:143], a[216:219], a[28:31], v[140:143]
    ds_read_b64_tr_b16 a[234:235], v1 offset:47104
    v_mfma_f32_16x16x32_bf16 v[144:147], a[216:219], a[32:35], v[144:147]
    s_waitcnt lgkmcnt(6)
    v_mfma_f32_16x16x32_bf16 v[148:151], a[220:223], a[24:27], v[148:151]
    ds_read_b64_tr_b16 a[236:237], v2 offset:45056
    v_mfma_f32_16x16x32_bf16 v[152:155], a[220:223], a[28:31], v[152:155]
    ds_read_b64_tr_b16 a[238:239], v2 offset:47104
    v_mfma_f32_16x16x32_bf16 v[156:159], a[220:223], a[32:35], v[156:159]
    s_waitcnt lgkmcnt(6)
    buffer_load_dwordx4 v[124:127], v3, s[28:31], s22 offen offset:1024 sc1
    v_mfma_f32_16x16x32_bf16 v[160:163], a[224:227], a[24:27], v[160:163]
    ds_read_b64_tr_b16 a[240:241], v1 offset:45568
    v_mfma_f32_16x16x32_bf16 v[164:167], a[224:227], a[28:31], v[164:167]
    ds_read_b64_tr_b16 a[242:243], v1 offset:47616
    v_mfma_f32_16x16x32_bf16 v[168:171], a[224:227], a[32:35], v[168:171]
    s_waitcnt lgkmcnt(6)
    v_mfma_f32_16x16x32_bf16 v[172:175], a[228:231], a[24:27], v[172:175]
    ds_read_b64_tr_b16 a[244:245], v2 offset:45568
    v_mfma_f32_16x16x32_bf16 v[176:179], a[228:231], a[28:31], v[176:179]
    ds_read_b64_tr_b16 a[246:247], v2 offset:47616
    v_mfma_f32_16x16x32_bf16 v[180:183], a[228:231], a[32:35], v[180:183]
    s_waitcnt lgkmcnt(6)
    v_mfma_f32_16x16x32_bf16 v[136:139], a[232:235], a[36:39], v[136:139]
    s_waitcnt vmcnt(16)
    s_barrier
    s_waitcnt lgkmcnt(4)
    v_mfma_f32_16x16x32_bf16 v[140:143], a[232:235], a[40:43], v[140:143]
    ds_read_b64_tr_b16 a[216:217], v1 offset:49152
    v_mfma_f32_16x16x32_bf16 v[144:147], a[232:235], a[44:47], v[144:147]
    ds_read_b64_tr_b16 a[218:219], v1 offset:51200
    v_mfma_f32_16x16x32_bf16 v[148:151], a[236:239], a[36:39], v[148:151]
    ds_read_b64_tr_b16 a[220:221], v2 offset:49152
    v_mfma_f32_16x16x32_bf16 v[152:155], a[236:239], a[40:43], v[152:155]
    ds_read_b64_tr_b16 a[222:223], v2 offset:51200
    v_mfma_f32_16x16x32_bf16 v[156:159], a[236:239], a[44:47], v[156:159]
    s_waitcnt lgkmcnt(6)
    s_add_u32 s97, s97, 1
    s_add_u32 s84, s97, 7
    s_and_b32 s84, s84, 7
    s_lshl_b32 s84, s84, 2
    s_add_u32 s84, s84, s40
    s_lshl_b32 s84, s84, 7
    s_add_u32 s15, s84, s23
    buffer_store_dwordx2 v[92:93], v96, s[28:31], s15 offen sc1
    v_mfma_f32_16x16x32_bf16 v[160:163], a[240:243], a[36:39], v[160:163]
    ds_read_b64_tr_b16 a[224:225], v1 offset:49664
    v_mfma_f32_16x16x32_bf16 v[164:167], a[240:243], a[40:43], v[164:167]
    ds_read_b64_tr_b16 a[226:227], v1 offset:51712
    v_mfma_f32_16x16x32_bf16 v[168:171], a[240:243], a[44:47], v[168:171]
    s_waitcnt lgkmcnt(6)
    s_sub_u32 s84, s41, 5
    s_and_b32 s84, s84, 7
    s_lshl_b32 s21, 1, s84
    s_lshl_b32 s85, s41, 3
    s_add_u32 s84, s84, s85
    s_mul_i32 s20, s84, 24576
    s_cmp_lg_u32 s81, 0
    s_cselect_b32 s20, s20, s19
    s_add_u32 s22, s20, 4096
    buffer_load_dwordx4 v[128:131], v3, s[28:31], s20 offen sc1
    v_mfma_f32_16x16x32_bf16 v[172:175], a[244:247], a[36:39], v[172:175]
    ds_read_b64_tr_b16 a[228:229], v2 offset:49664
    v_mfma_f32_16x16x32_bf16 v[176:179], a[244:247], a[40:43], v[176:179]
    ds_read_b64_tr_b16 a[230:231], v2 offset:51712
    v_mfma_f32_16x16x32_bf16 v[180:183], a[244:247], a[44:47], v[180:183]
    s_waitcnt lgkmcnt(6)
    buffer_load_dwordx4 v[132:135], v3, s[28:31], s20 offen offset:1024 sc1
    v_mfma_f32_16x16x32_bf16 v[136:139], a[216:219], a[48:51], v[136:139]
    ds_read_b64_tr_b16 a[232:233], v1 offset:53248
    v_mfma_f32_16x16x32_bf16 v[140:143], a[216:219], a[52:55], v[140:143]
    ds_read_b64_tr_b16 a[234:235], v1 offset:55296
    v_mfma_f32_16x16x32_bf16 v[144:147], a[216:219], a[56:59], v[144:147]
    s_waitcnt lgkmcnt(6)
    buffer_load_dwordx4 v[208:211], v3, s[28:31], s20 offen offset:2048 sc1
    v_mfma_f32_16x16x32_bf16 v[148:151], a[220:223], a[48:51], v[148:151]
    ds_read_b64_tr_b16 a[236:237], v2 offset:53248
    v_mfma_f32_16x16x32_bf16 v[152:155], a[220:223], a[52:55], v[152:155]
    ds_read_b64_tr_b16 a[238:239], v2 offset:55296
    v_mfma_f32_16x16x32_bf16 v[156:159], a[220:223], a[56:59], v[156:159]
    s_waitcnt lgkmcnt(6)
    buffer_load_dwordx4 v[212:215], v3, s[28:31], s20 offen offset:3072 sc1
    v_mfma_f32_16x16x32_bf16 v[160:163], a[224:227], a[48:51], v[160:163]
    ds_read_b64_tr_b16 a[240:241], v1 offset:53760
    v_mfma_f32_16x16x32_bf16 v[164:167], a[224:227], a[52:55], v[164:167]
    ds_read_b64_tr_b16 a[242:243], v1 offset:55808
    v_mfma_f32_16x16x32_bf16 v[168:171], a[224:227], a[56:59], v[168:171]
    s_waitcnt lgkmcnt(6)
    v_mfma_f32_16x16x32_bf16 v[172:175], a[228:231], a[48:51], v[172:175]
    ds_read_b64_tr_b16 a[244:245], v2 offset:53760
    v_mfma_f32_16x16x32_bf16 v[176:179], a[228:231], a[52:55], v[176:179]
    ds_read_b64_tr_b16 a[246:247], v2 offset:55808
    v_mfma_f32_16x16x32_bf16 v[180:183], a[228:231], a[56:59], v[180:183]
    s_waitcnt lgkmcnt(6)
    buffer_load_dwordx4 v[216:219], v3, s[28:31], s22 offen sc1
    v_mfma_f32_16x16x32_bf16 v[136:139], a[232:235], a[60:63], v[136:139]
    ds_read_b64_tr_b16 a[216:217], v1 offset:57344
    v_mfma_f32_16x16x32_bf16 v[140:143], a[232:235], a[64:67], v[140:143]
    ds_read_b64_tr_b16 a[218:219], v1 offset:59392
    v_mfma_f32_16x16x32_bf16 v[144:147], a[232:235], a[68:71], v[144:147]
    s_waitcnt lgkmcnt(6)
    buffer_load_dwordx4 v[220:223], v3, s[28:31], s22 offen offset:1024 sc1
    v_mfma_f32_16x16x32_bf16 v[148:151], a[236:239], a[60:63], v[148:151]
    ds_read_b64_tr_b16 a[220:221], v2 offset:57344
    v_mfma_f32_16x16x32_bf16 v[152:155], a[236:239], a[64:67], v[152:155]
    ds_read_b64_tr_b16 a[222:223], v2 offset:59392
    v_mfma_f32_16x16x32_bf16 v[156:159], a[236:239], a[68:71], v[156:159]
    s_waitcnt lgkmcnt(6)
    v_mfma_f32_16x16x32_bf16 v[160:163], a[240:243], a[60:63], v[160:163]
    ds_read_b64_tr_b16 a[224:225], v1 offset:57856
    v_mfma_f32_16x16x32_bf16 v[164:167], a[240:243], a[64:67], v[164:167]
    ds_read_b64_tr_b16 a[226:227], v1 offset:59904
    v_mfma_f32_16x16x32_bf16 v[168:171], a[240:243], a[68:71], v[168:171]
    s_waitcnt lgkmcnt(6)
    v_mfma_f32_16x16x32_bf16 v[172:175], a[244:247], a[60:63], v[172:175]
    ds_read_b64_tr_b16 a[228:229], v2 offset:57856
    v_mfma_f32_16x16x32_bf16 v[176:179], a[244:247], a[64:67], v[176:179]
    ds_read_b64_tr_b16 a[230:231], v2 offset:59904
    v_mfma_f32_16x16x32_bf16 v[180:183], a[244:247], a[68:71], v[180:183]
    s_waitcnt lgkmcnt(6)
    v_mfma_f32_16x16x32_bf16 v[136:139], a[216:219], a[72:75], v[136:139]
    ds_read_b64_tr_b16 a[232:233], v1 offset:61440
    v_mfma_f32_16x16x32_bf16 v[140:143], a[216:219], a[76:79], v[140:143]
    ds_read_b64_tr_b16 a[234:235], v1 offset:63488
    v_mfma_f32_16x16x32_bf16 v[144:147], a[216:219], a[80:83], v[144:147]
    s_waitcnt lgkmcnt(6)
    v_mfma_f32_16x16x32_bf16 v[148:151], a[220:223], a[72:75], v[148:151]
    ds_read_b64_tr_b16 a[236:237], v2 offset:61440
    v_mfma_f32_16x16x32_bf16 v[152:155], a[220:223], a[76:79], v[152:155]
    ds_read_b64_tr_b16 a[238:239], v2 offset:63488
    v_mfma_f32_16x16x32_bf16 v[156:159], a[220:223], a[80:83], v[156:159]
    s_waitcnt lgkmcnt(6)
    v_mfma_f32_16x16x32_bf16 v[160:163], a[224:227], a[72:75], v[160:163]
    ds_read_b64_tr_b16 a[240:241], v1 offset:61952
    v_mfma_f32_16x16x32_bf16 v[164:167], a[224:227], a[76:79], v[164:167]
    ds_read_b64_tr_b16 a[242:243], v1 offset:64000
    v_mfma_f32_16x16x32_bf16 v[168:171], a[224:227], a[80:83], v[168:171]
    s_waitcnt lgkmcnt(6)
    v_mfma_f32_16x16x32_bf16 v[172:175], a[228:231], a[72:75], v[172:175]
    ds_read_b64_tr_b16 a[244:245], v2 offset:61952
    v_mfma_f32_16x16x32_bf16 v[176:179], a[228:231], a[76:79], v[176:179]
    ds_read_b64_tr_b16 a[246:247], v2 offset:64000
    v_mfma_f32_16x16x32_bf16 v[180:183], a[228:231], a[80:83], v[180:183]
    s_waitcnt lgkmcnt(0)
    v_mfma_f32_16x16x32_bf16 v[136:139], a[232:235], a[84:87], v[136:139]
    v_mfma_f32_16x16x32_bf16 v[140:143], a[232:235], a[88:91], v[140:143]
    v_mfma_f32_16x16x32_bf16 v[144:147], a[232:235], a[92:95], v[144:147]
    v_mfma_f32_16x16x32_bf16 v[148:151], a[236:239], a[84:87], v[148:151]
    v_mfma_f32_16x16x32_bf16 v[152:155], a[236:239], a[88:91], v[152:155]
    v_mfma_f32_16x16x32_bf16 v[156:159], a[236:239], a[92:95], v[156:159]
    v_mfma_f32_16x16x32_bf16 v[160:163], a[240:243], a[84:87], v[160:163]
    v_mfma_f32_16x16x32_bf16 v[164:167], a[240:243], a[88:91], v[164:167]
    v_mfma_f32_16x16x32_bf16 v[168:171], a[240:243], a[92:95], v[168:171]
    v_mfma_f32_16x16x32_bf16 v[172:175], a[244:247], a[84:87], v[172:175]
    v_mfma_f32_16x16x32_bf16 v[176:179], a[244:247], a[88:91], v[176:179]
    v_mfma_f32_16x16x32_bf16 v[180:183], a[244:247], a[92:95], v[180:183]
    s_cmp_lg_u32 s81, 0
    s_cbranch_scc1 L_haveE
    s_mov_b32 s21, 0
    s_sub_u32 s84, s41, 1
    s_and_b32 s84, s84, 7
    s_lshl_b32 s84, 1, s84
    s_or_b32 s21, s21, s84
    s_sub_u32 s84, s41, 2
    s_and_b32 s84, s84, 7
    s_lshl_b32 s84, 1, s84
    s_or_b32 s21, s21, s84
    s_sub_u32 s84, s41, 3
    s_and_b32 s84, s84, 7
    s_lshl_b32 s84, 1, s84
    s_or_b32 s21, s21, s84
    s_sub_u32 s84, s41, 4
    s_and_b32 s84, s84, 7
    s_lshl_b32 s84, 1, s84
    s_or_b32 s21, s21, s84
    s_sub_u32 s84, s41, 5
    s_and_b32 s84, s84, 7
    s_lshl_b32 s84, 1, s84
    s_or_b32 s21, s21, s84
    s_mov_b32 s90, 262144
L_spinA:
    buffer_load_dwordx2 v[88:89], v90, s[28:31], s78 offen sc1
    s_waitcnt vmcnt(0)
    v_cmp_eq_u32 s[70:71], v92, v88
    v_cmp_eq_u32 vcc, v93, v89
    s_nop 3
    s_and_b32 s70, s70, vcc_lo
    s_and_b32 s70, s70, s21
    s_cmp_eq_u32 s70, s21
    s_cbranch_scc1 L_gotA
    s_sleep 1
    s_sub_u32 s90, s90, 1
    s_cmp_lg_u32 s90, 0
    s_cbranch_scc1 L_spinA
L_gotA:
    s_sub_u32 s84, s41, 1
    s_and_b32 s84, s84, 7
    s_lshl_b32 s21, 1, s84
    s_lshl_b32 s85, s41, 3
    s_add_u32 s84, s84, s85
    s_mul_i32 s20, s84, 24576
    s_add_u32 s22, s20, 4096
    buffer_load_dwordx4 v[16:19], v3, s[28:31], s20 offen sc1
    buffer_load_dwordx4 v[20:23], v3, s[28:31], s20 offen offset:1024 sc1
    buffer_load_dwordx4 v[24:27], v3, s[28:31], s20 offen offset:2048 sc1
    buffer_load_dwordx4 v[28:31], v3, s[28:31], s20 offen offset:3072 sc1
    buffer_load_dwordx4 v[32:35], v3, s[28:31], s22 offen sc1
    buffer_load_dwordx4 v[36:39], v3, s[28:31], s22 offen offset:1024 sc1
    s_sub_u32 s84, s41, 2
    s_and_b32 s84, s84, 7
    s_lshl_b32 s21, 1, s84
    s_lshl_b32 s85, s41, 3
    s_add_u32 s84, s84, s85
    s_mul_i32 s20, s84, 24576
    s_add_u32 s22, s20, 4096
    buffer_load_dwordx4 v[40:43], v3, s[28:31], s20 offen sc1
    buffer_load_dwordx4 v[44:47], v3, s[28:31], s20 offen offset:1024 sc1
    buffer_load_dwordx4 v[48:51], v3, s[28:31], s20 offen offset:2048 sc1
    buffer_load_dwordx4 v[52:55], v3, s[28:31], s20 offen offset:3072 sc1
    buffer_load_dwordx4 v[56:59], v3, s[28:31], s22 offen sc1
    buffer_load_dwordx4 v[60:63], v3, s[28:31], s22 offen offset:1024 sc1
    s_sub_u32 s84, s41, 3
    s_and_b32 s84, s84, 7
    s_lshl_b32 s21, 1, s84
    s_lshl_b32 s85, s41, 3
    s_add_u32 s84, s84, s85
    s_mul_i32 s20, s84, 24576
    s_add_u32 s22, s20, 4096
    buffer_load_dwordx4 v[64:67], v3, s[28:31], s20 offen sc1
    buffer_load_dwordx4 v[68:71], v3, s[28:31], s20 offen offset:1024 sc1
    buffer_load_dwordx4 v[72:75], v3, s[28:31], s20 offen offset:2048 sc1
    buffer_load_dwordx4 v[76:79], v3, s[28:31], s20 offen offset:3072 sc1
    buffer_load_dwordx4 v[80:83], v3, s[28:31], s22 offen sc1
    buffer_load_dwordx4 v[84:87], v3, s[28:31], s22 offen offset:1024 sc1
    s_sub_u32 s84, s41, 4
    s_and_b32 s84, s84, 7
    s_lshl_b32 s21, 1, s84
    s_lshl_b32 s85, s41, 3
    s_add_u32 s84, s84, s85
    s_mul_i32 s20, s84, 24576
    s_add_u32 s22, s20, 4096
    buffer_load_dwordx4 v[104:107], v3, s[28:31], s20 offen sc1
    buffer_load_dwordx4 v[108:111], v3, s[28:31], s20 offen offset:1024 sc1
    buffer_load_dwordx4 v[112:115], v3, s[28:31], s20 offen offset:2048 sc1
    buffer_load_dwordx4 v[116:119], v3, s[28:31], s20 offen offset:3072 sc1
    buffer_load_dwordx4 v[120:123], v3, s[28:31], s22 offen sc1
    buffer_load_dwordx4 v[124:127], v3, s[28:31], s22 offen offset:1024 sc1
    s_sub_u32 s84, s41, 5
    s_and_b32 s84, s84, 7
    s_lshl_b32 s21, 1, s84
    s_lshl_b32 s85, s41, 3
    s_add_u32 s84, s84, s85
    s_mul_i32 s20, s84, 24576
    s_add_u32 s22, s20, 4096
    buffer_load_dwordx4 v[128:131], v3, s[28:31], s20 offen sc1
    buffer_load_dwordx4 v[132:135], v3, s[28:31], s20 offen offset:1024 sc1
    buffer_load_dwordx4 v[208:211], v3, s[28:31], s20 offen offset:2048 sc1
    buffer_load_dwordx4 v[212:215], v3, s[28:31], s20 offen offset:3072 sc1
    buffer_load_dwordx4 v[216:219], v3, s[28:31], s22 offen sc1
    buffer_load_dwordx4 v[220:223], v3, s[28:31], s22 offen offset:1024 sc1
    s_waitcnt vmcnt(0)
L_haveE:
    v_mfma_f32_16x16x32_bf16 v[136:139], v[234:237], v[16:19], v[136:139]
    v_mfma_f32_16x16x32_bf16 v[148:151], v[232:235], v[16:19], v[148:151]
    v_mfma_f32_16x16x32_bf16 v[140:143], v[234:237], v[20:23], v[140:143]
    v_mfma_f32_16x16x32_bf16 v[152:155], v[232:235], v[20:23], v[152:155]
    v_mfma_f32_16x16x32_bf16 v[144:147], v[234:237], v[24:27], v[144:147]
    v_mfma_f32_16x16x32_bf16 v[156:159], v[232:235], v[24:27], v[156:159]
    v_mfma_f32_16x16x32_bf16 v[160:163], v[234:237], v[28:31], v[160:163]
    v_mfma_f32_16x16x32_bf16 v[172:175], v[232:235], v[28:31], v[172:175]
    v_mfma_f32_16x16x32_bf16 v[164:167], v[234:237], v[32:35], v[164:167]
    v_mfma_f32_16x16x32_bf16 v[176:179], v[232:235], v[32:35], v[176:179]
    v_mfma_f32_16x16x32_bf16 v[168:171], v[234:237], v[36:39], v[168:171]
    v_mfma_f32_16x16x32_bf16 v[180:183], v[232:235], v[36:39], v[180:183]
    v_mfma_f32_16x16x32_bf16 v[136:139], v[234:237], v[40:43], v[136:139]
    v_mfma_f32_16x16x32_bf16 v[148:151], v[232:235], v[40:43], v[148:151]
    v_mfma_f32_16x16x32_bf16 v[140:143], v[234:237], v[44:47], v[140:143]
    v_mfma_f32_16x16x32_bf16 v[152:155], v[232:235], v[44:47], v[152:155]
    s_waitcnt vmcnt(22)
    v_mfma_f32_16x16x32_bf16 v[144:147], v[234:237], v[48:51], v[144:147]
    v_mfma_f32_16x16x32_bf16 v[156:159], v[232:235], v[48:51], v[156:159]
    s_waitcnt vmcnt(21)
    v_mfma_f32_16x16x32_bf16 v[160:163], v[234:237], v[52:55], v[160:163]
    v_mfma_f32_16x16x32_bf16 v[172:175], v[232:235], v[52:55], v[172:175]
    s_waitcnt vmcnt(20)
    v_mfma_f32_16x16x32_bf16 v[164:167], v[234:237], v[56:59], v[164:167]
    v_mfma_f32_16x16x32_bf16 v[176:179], v[232:235], v[56:59], v[176:179]
    s_waitcnt vmcnt(19)
    v_mfma_f32_16x16x32_bf16 v[168:171], v[234:237], v[60:63], v[168:171]
    v_mfma_f32_16x16x32_bf16 v[180:183], v[232:235], v[60:63], v[180:183]
    s_waitcnt vmcnt(18)
    v_mfma_f32_16x16x32_bf16 v[136:139], v[234:237], v[64:67], v[136:139]
    v_mfma_f32_16x16x32_bf16 v[148:151], v[232:235], v[64:67], v[148:151]
    s_waitcnt vmcnt(17)
    v_mfma_f32_16x16x32_bf16 v[140:143], v[234:237], v[68:71], v[140:143]
    v_mfma_f32_16x16x32_bf16 v[152:155], v[232:235], v[68:71], v[152:155]
    s_waitcnt vmcnt(16)
    v_mfma_f32_16x16x32_bf16 v[144:147], v[234:237], v[72:75], v[144:147]
    v_mfma_f32_16x16x32_bf16 v[156:159], v[232:235], v[72:75], v[156:159]
    s_waitcnt vmcnt(15)
    v_mfma_f32_16x16x32_bf16 v[160:163], v[234:237], v[76:79], v[160:163]
    v_mfma_f32_16x16x32_bf16 v[172:175], v[232:235], v[76:79], v[172:175]
    s_waitcnt vmcnt(14)
    v_mfma_f32_16x16x32_bf16 v[164:167], v[234:237], v[80:83], v[164:167]
    v_mfma_f32_16x16x32_bf16 v[176:179], v[232:235], v[80:83], v[176:179]
    s_waitcnt vmcnt(13)
    v_mfma_f32_16x16x32_bf16 v[168:171], v[234:237], v[84:87], v[168:171]
    v_mfma_f32_16x16x32_bf16 v[180:183], v[232:235], v[84:87], v[180:183]
    s_waitcnt vmcnt(12)
    v_mfma_f32_16x16x32_bf16 v[136:139], v[234:237], v[104:107], v[136:139]
    v_mfma_f32_16x16x32_bf16 v[148:151], v[232:235], v[104:107], v[148:151]
    s_waitcnt vmcnt(11)
    v_mfma_f32_16x16x32_bf16 v[140:143], v[234:237], v[108:111], v[140:143]
    v_mfma_f32_16x16x32_bf16 v[152:155], v[232:235], v[108:111], v[152:155]
    s_waitcnt vmcnt(10)
    v_mfma_f32_16x16x32_bf16 v[144:147], v[234:237], v[112:115], v[144:147]
    v_mfma_f32_16x16x32_bf16 v[156:159], v[232:235], v[112:115], v[156:159]
    s_waitcnt vmcnt(9)
    v_mfma_f32_16x16x32_bf16 v[160:163], v[234:237], v[116:119], v[160:163]
    v_mfma_f32_16x16x32_bf16 v[172:175], v[232:235], v[116:119], v[172:175]
    s_waitcnt vmcnt(8)
    v_mfma_f32_16x16x32_bf16 v[164:167], v[234:237], v[120:123], v[164:167]
    v_mfma_f32_16x16x32_bf16 v[176:179], v[232:235], v[120:123], v[176:179]
    s_waitcnt vmcnt(7)
    v_mfma_f32_16x16x32_bf16 v[168:171], v[234:237], v[124:127], v[168:171]
    v_mfma_f32_16x16x32_bf16 v[180:183], v[232:235], v[124:127], v[180:183]
    s_waitcnt vmcnt(5)
    v_mfma_f32_16x16x32_bf16 v[136:139], v[234:237], v[128:131], v[136:139]
    v_mfma_f32_16x16x32_bf16 v[148:151], v[232:235], v[128:131], v[148:151]
    s_waitcnt vmcnt(4)
    v_mfma_f32_16x16x32_bf16 v[140:143], v[234:237], v[132:135], v[140:143]
    v_mfma_f32_16x16x32_bf16 v[152:155], v[232:235], v[132:135], v[152:155]
    s_waitcnt vmcnt(3)
    v_mfma_f32_16x16x32_bf16 v[144:147], v[234:237], v[208:211], v[144:147]
    v_mfma_f32_16x16x32_bf16 v[156:159], v[232:235], v[208:211], v[156:159]
    s_waitcnt vmcnt(2)
    v_mfma_f32_16x16x32_bf16 v[160:163], v[234:237], v[212:215], v[160:163]
    v_mfma_f32_16x16x32_bf16 v[172:175], v[232:235], v[212:215], v[172:175]
    s_waitcnt vmcnt(1)
    v_mfma_f32_16x16x32_bf16 v[164:167], v[234:237], v[216:219], v[164:167]
    v_mfma_f32_16x16x32_bf16 v[176:179], v[232:235], v[216:219], v[176:179]
    s_waitcnt vmcnt(0)
    v_mfma_f32_16x16x32_bf16 v[168:171], v[234:237], v[220:223], v[168:171]
    v_mfma_f32_16x16x32_bf16 v[180:183], v[232:235], v[220:223], v[180:183]
    s_mov_b32 s21, 0
    s_sub_u32 s84, s41, 6
    s_and_b32 s84, s84, 7
    s_lshl_b32 s84, 1, s84
    s_or_b32 s21, s21, s84
    s_sub_u32 s84, s41, 7
    s_and_b32 s84, s84, 7
    s_lshl_b32 s84, 1, s84
    s_or_b32 s21, s21, s84
    s_mov_b32 s90, 262144
L_spinB:
    buffer_load_dwordx2 v[88:89], v90, s[28:31], s78 offen sc1
    s_waitcnt vmcnt(0)
    v_cmp_eq_u32 s[70:71], v92, v88
    v_cmp_eq_u32 vcc, v93, v89
    s_nop 3
    s_and_b32 s70, s70, vcc_lo
    s_and_b32 s70, s70, s21
    s_cmp_eq_u32 s70, s21
    s_cbranch_scc1 L_gotB
    s_sleep 1
    s_sub_u32 s90, s90, 1
    s_cmp_lg_u32 s90, 0
    s_cbranch_scc1 L_spinB
L_gotB:
    s_sub_u32 s84, s41, 6
    s_and_b32 s84, s84, 7
    s_lshl_b32 s21, 1, s84
    s_lshl_b32 s85, s41, 3
    s_add_u32 s84, s84, s85
    s_mul_i32 s20, s84, 24576
    s_add_u32 s22, s20, 4096
    buffer_load_dwordx4 v[224:227], v3, s[28:31], s20 offen sc1
    buffer_load_dwordx4 v[228:231], v3, s[28:31], s20 offen offset:1024 sc1
    buffer_load_dwordx4 a[0:3], v3, s[28:31], s20 offen offset:2048 sc1
    buffer_load_dwordx4 a[4:7], v3, s[28:31], s20 offen offset:3072 sc1
    buffer_load_dwordx4 a[8:11], v3, s[28:31], s22 offen sc1
    buffer_load_dwordx4 a[12:15], v3, s[28:31], s22 offen offset:1024 sc1
    s_sub_u32 s84, s41, 7
    s_and_b32 s84, s84, 7
    s_lshl_b32 s21, 1, s84
    s_lshl_b32 s85, s41, 3
    s_add_u32 s84, s84, s85
    s_mul_i32 s20, s84, 24576
    s_add_u32 s22, s20, 4096
    buffer_load_dwordx4 a[16:19], v3, s[28:31], s20 offen sc1
    buffer_load_dwordx4 a[20:23], v3, s[28:31], s20 offen offset:1024 sc1
    buffer_load_dwordx4 a[24:27], v3, s[28:31], s20 offen offset:2048 sc1
    buffer_load_dwordx4 a[28:31], v3, s[28:31], s20 offen offset:3072 sc1
    buffer_load_dwordx4 a[32:35], v3, s[28:31], s22 offen sc1
    buffer_load_dwordx4 a[36:39], v3, s[28:31], s22 offen offset:1024 sc1
    s_waitcnt vmcnt(11)
    v_mfma_f32_16x16x32_bf16 v[136:139], v[234:237], v[224:227], v[136:139]
    v_mfma_f32_16x16x32_bf16 v[148:151], v[232:235], v[224:227], v[148:151]
    s_waitcnt vmcnt(10)
    v_mfma_f32_16x16x32_bf16 v[140:143], v[234:237], v[228:231], v[140:143]
    v_mfma_f32_16x16x32_bf16 v[152:155], v[232:235], v[228:231], v[152:155]
    s_waitcnt vmcnt(9)
    v_mfma_f32_16x16x32_bf16 v[144:147], v[234:237], a[0:3], v[144:147]
    v_mfma_f32_16x16x32_bf16 v[156:159], v[232:235], a[0:3], v[156:159]
    s_waitcnt vmcnt(8)
    v_mfma_f32_16x16x32_bf16 v[160:163], v[234:237], a[4:7], v[160:163]
    v_mfma_f32_16x16x32_bf16 v[172:175], v[232:235], a[4:7], v[172:175]
    s_waitcnt vmcnt(7)
    v_mfma_f32_16x16x32_bf16 v[164:167], v[234:237], a[8:11], v[164:167]
    v_mfma_f32_16x16x32_bf16 v[176:179], v[232:235], a[8:11], v[176:179]
    s_waitcnt vmcnt(6)
    v_mfma_f32_16x16x32_bf16 v[168:171], v[234:237], a[12:15], v[168:171]
    v_mfma_f32_16x16x32_bf16 v[180:183], v[232:235], a[12:15], v[180:183]
    s_waitcnt vmcnt(5)
    v_mfma_f32_16x16x32_bf16 v[136:139], v[234:237], a[16:19], v[136:139]
    v_mfma_f32_16x16x32_bf16 v[148:151], v[232:235], a[16:19], v[148:151]
    s_waitcnt vmcnt(4)
    v_mfma_f32_16x16x32_bf16 v[140:143], v[234:237], a[20:23], v[140:143]
    v_mfma_f32_16x16x32_bf16 v[152:155], v[232:235], a[20:23], v[152:155]
    s_waitcnt vmcnt(3)
    v_mfma_f32_16x16x32_bf16 v[144:147], v[234:237], a[24:27], v[144:147]
    v_mfma_f32_16x16x32_bf16 v[156:159], v[232:235], a[24:27], v[156:159]
    s_waitcnt vmcnt(2)
    v_mfma_f32_16x16x32_bf16 v[160:163], v[234:237], a[28:31], v[160:163]
    v_mfma_f32_16x16x32_bf16 v[172:175], v[232:235], a[28:31], v[172:175]
    s_waitcnt vmcnt(1)
    v_mfma_f32_16x16x32_bf16 v[164:167], v[234:237], a[32:35], v[164:167]
    v_mfma_f32_16x16x32_bf16 v[176:179], v[232:235], a[32:35], v[176:179]
    s_waitcnt vmcnt(0)
    v_mfma_f32_16x16x32_bf16 v[168:171], v[234:237], a[36:39], v[168:171]
    v_mfma_f32_16x16x32_bf16 v[180:183], v[232:235], a[36:39], v[180:183]
    v_lshrrev_b32 v240, 6, v0
    v_mul_u32_u24 v240, 48, v240
    v_and_b32 v241, 15, v14
    v_add_u32 v240, v240, v241
    v_lshlrev_b32 v242, 11, v240
    v_bfe_u32 v240, v14, 4, 1
    v_lshl_add_u32 v242, v240, 5, v242
    v_lshrrev_b32 v240, 5, v14
    v_lshl_add_u32 v242, v240, 4, v242
    s_lshl_b32 s84, s41, 7
    s_mov_b32 s85, 32768
    s_mov_b32 s86, 65536
    s_add_u32 s85, s85, s84
    s_add_u32 s86, s86, s84
    v_cvt_pk_bf16_f32 v16, v136, v137
    v_cvt_pk_bf16_f32 v17, v138, v139
    v_cvt_pk_bf16_f32 v18, v148, v149
    v_cvt_pk_bf16_f32 v19, v150, v151
    v_cvt_pk_bf16_f32 v20, v140, v141
    v_cvt_pk_bf16_f32 v21, v142, v143
    v_cvt_pk_bf16_f32 v22, v152, v153
    v_cvt_pk_bf16_f32 v23, v154, v155
    v_cvt_pk_bf16_f32 v24, v144, v145
    v_cvt_pk_bf16_f32 v25, v146, v147
    v_cvt_pk_bf16_f32 v26, v156, v157
    v_cvt_pk_bf16_f32 v27, v158, v159
    v_cvt_pk_bf16_f32 v28, v160, v161
    v_cvt_pk_bf16_f32 v29, v162, v163
    v_cvt_pk_bf16_f32 v30, v172, v173
    v_cvt_pk_bf16_f32 v31, v174, v175
    v_cvt_pk_bf16_f32 v32, v164, v165
    v_cvt_pk_bf16_f32 v33, v166, v167
    v_cvt_pk_bf16_f32 v34, v176, v177
    v_cvt_pk_bf16_f32 v35, v178, v179
    v_cvt_pk_bf16_f32 v36, v168, v169
    v_cvt_pk_bf16_f32 v37, v170, v171
    v_cvt_pk_bf16_f32 v38, v180, v181
    v_cvt_pk_bf16_f32 v39, v182, v183
    v_permlane16_swap_b32 v16, v18
    v_permlane16_swap_b32 v17, v19
    buffer_store_dwordx4 v[16:19], v242, s[32:35], s84 offen
    v_permlane16_swap_b32 v20, v22
    v_permlane16_swap_b32 v21, v23
    buffer_store_dwordx4 v[20:23], v242, s[32:35], s85 offen
    v_permlane16_swap_b32 v24, v26
    v_permlane16_swap_b32 v25, v27
    buffer_store_dwordx4 v[24:27], v242, s[32:35], s86 offen
    v_permlane16_swap_b32 v28, v30
    v_permlane16_swap_b32 v29, v31
    buffer_store_dwordx4 v[28:31], v242, s[32:35], s84 offen offset:64
    v_permlane16_swap_b32 v32, v34
    v_permlane16_swap_b32 v33, v35
    buffer_store_dwordx4 v[32:35], v242, s[32:35], s85 offen offset:64
    v_permlane16_swap_b32 v36, v38
    v_permlane16_swap_b32 v37, v39
    buffer_store_dwordx4 v[36:39], v242, s[32:35], s86 offen offset:64
    s_endpgm
L_slow:
    s_waitcnt vmcnt(0) lgkmcnt(0)
    v_and_b32 v56, 15, v14
    v_lshrrev_b32 v57, 4, v14
    v_lshlrev_b32 v234, 8, v56
    v_lshl_add_u32 v234, v57, 4, v234
    v_add_u32 v234, 64, v234
    v_lshlrev_b32 v235, 10, v57
    v_lshl_add_u32 v235, v56, 1, v235
    v_add_u32 v235, 64, v235
    v_add_u32 v236, 4096, v235
    s_lshl_b32 s84, s91, 17
    v_mov_b32 v237, 4286578688
    v_mov_b32 v238, 4286578688
    v_mov_b32 v239, 4286578688
    s_mov_b32 s85, 0
L_slow1:
    s_add_u32 s86, s84, s85
    buffer_load_dwordx4 v[40:43], v234, s[12:15], s86 offen
    buffer_load_dwordx4 v[44:47], v234, s[12:15], s86 offen offset:64
    buffer_load_dwordx4 v[48:51], v234, s[12:15], s86 offen offset:128
    buffer_load_dwordx4 v[52:55], v234, s[12:15], s86 offen offset:192
    s_waitcnt vmcnt(0)
    v_mfma_f32_16x16x32_bf16 v[16:19], v[40:43], v[88:91], 0
    v_mfma_f32_16x16x32_bf16 v[20:23], v[40:43], v[92:95], 0
    v_mfma_f32_16x16x32_bf16 v[24:27], v[40:43], v[96:99], 0
    v_mfma_f32_16x16x32_bf16 v[16:19], v[44:47], v[100:103], v[16:19]
    v_mfma_f32_16x16x32_bf16 v[20:23], v[44:47], v[104:107], v[20:23]
    v_mfma_f32_16x16x32_bf16 v[24:27], v[44:47], v[108:111], v[24:27]
    v_mfma_f32_16x16x32_bf16 v[16:19], v[48:51], v[112:115], v[16:19]
    v_mfma_f32_16x16x32_bf16 v[20:23], v[48:51], v[116:119], v[20:23]
    v_mfma_f32_16x16x32_bf16 v[24:27], v[48:51], v[120:123], v[24:27]
    v_mfma_f32_16x16x32_bf16 v[16:19], v[52:55], v[124:127], v[16:19]
    v_mfma_f32_16x16x32_bf16 v[20:23], v[52:55], v[128:131], v[20:23]
    v_mfma_f32_16x16x32_bf16 v[24:27], v[52:55], v[132:135], v[24:27]
    s_nop 5
    v_max3_f32 v237, v237, v16, v17
    s_nop 4
    v_max3_f32 v237, v237, v18, v19
    s_nop 4
    v_max3_f32 v238, v238, v20, v21
    s_nop 3
    v_max3_f32 v238, v238, v22, v23
    s_nop 3
    v_max3_f32 v239, v239, v24, v25
    s_nop 2
    v_max3_f32 v239, v239, v26, v27
    s_add_u32 s85, s85, 4096
    s_cmp_lt_u32 s85, 131072
    s_cbranch_scc1 L_slow1
    v_mov_b32 v240, v237
    s_nop 1
    v_permlane16_swap_b32 v237, v240
    v_max_f32 v237, v237, v240
    v_mov_b32 v240, v237
    s_nop 1
    v_permlane32_swap_b32 v237, v240
    v_max_f32 v237, v237, v240
    v_mov_b32 v11, 0
    v_mov_b32 v240, v238
    s_nop 1
    v_permlane16_swap_b32 v238, v240
    v_max_f32 v238, v238, v240
    v_mov_b32 v240, v238
    s_nop 1
    v_permlane32_swap_b32 v238, v240
    v_max_f32 v238, v238, v240
    v_mov_b32 v12, 0
    v_mov_b32 v240, v239
    s_nop 1
    v_permlane16_swap_b32 v239, v240
    v_max_f32 v239, v239, v240
    v_mov_b32 v240, v239
    s_nop 1
    v_permlane32_swap_b32 v239, v240
    v_max_f32 v239, v239, v240
    v_mov_b32 v13, 0
    v_mov_b32 v136, 0
    v_mov_b32 v137, 0
    v_mov_b32 v138, 0
    v_mov_b32 v139, 0
    v_mov_b32 v140, 0
    v_mov_b32 v141, 0
    v_mov_b32 v142, 0
    v_mov_b32 v143, 0
    v_mov_b32 v144, 0
    v_mov_b32 v145, 0
    v_mov_b32 v146, 0
    v_mov_b32 v147, 0
    v_mov_b32 v148, 0
    v_mov_b32 v149, 0
    v_mov_b32 v150, 0
    v_mov_b32 v151, 0
    v_mov_b32 v152, 0
    v_mov_b32 v153, 0
    v_mov_b32 v154, 0
    v_mov_b32 v155, 0
    v_mov_b32 v156, 0
    v_mov_b32 v157, 0
    v_mov_b32 v158, 0
    v_mov_b32 v159, 0
    v_mov_b32 v160, 0
    v_mov_b32 v161, 0
    v_mov_b32 v162, 0
    v_mov_b32 v163, 0
    v_mov_b32 v164, 0
    v_mov_b32 v165, 0
    v_mov_b32 v166, 0
    v_mov_b32 v167, 0
    v_mov_b32 v168, 0
    v_mov_b32 v169, 0
    v_mov_b32 v170, 0
    v_mov_b32 v171, 0
    v_mov_b32 v172, 0
    v_mov_b32 v173, 0
    v_mov_b32 v174, 0
    v_mov_b32 v175, 0
    v_mov_b32 v176, 0
    v_mov_b32 v177, 0
    v_mov_b32 v178, 0
    v_mov_b32 v179, 0
    v_mov_b32 v180, 0
    v_mov_b32 v181, 0
    v_mov_b32 v182, 0
    v_mov_b32 v183, 0
    v_mov_b32 v184, 0
    v_mov_b32 v185, 0
    v_mov_b32 v186, 0
    v_mov_b32 v187, 0
    v_mov_b32 v188, 0
    v_mov_b32 v189, 0
    v_mov_b32 v190, 0
    v_mov_b32 v191, 0
    v_mov_b32 v192, 0
    v_mov_b32 v193, 0
    v_mov_b32 v194, 0
    v_mov_b32 v195, 0
    v_mov_b32 v196, 0
    v_mov_b32 v197, 0
    v_mov_b32 v198, 0
    v_mov_b32 v199, 0
    v_mov_b32 v200, 0
    v_mov_b32 v201, 0
    v_mov_b32 v202, 0
    v_mov_b32 v203, 0
    v_mov_b32 v204, 0
    v_mov_b32 v205, 0
    v_mov_b32 v206, 0
    v_mov_b32 v207, 0
    v_mov_b32 v208, 0
    v_mov_b32 v209, 0
    v_mov_b32 v210, 0
    v_mov_b32 v211, 0
    v_mov_b32 v212, 0
    v_mov_b32 v213, 0
    v_mov_b32 v214, 0
    v_mov_b32 v215, 0
    v_mov_b32 v216, 0
    v_mov_b32 v217, 0
    v_mov_b32 v218, 0
    v_mov_b32 v219, 0
    v_mov_b32 v220, 0
    v_mov_b32 v221, 0
    v_mov_b32 v222, 0
    v_mov_b32 v223, 0
    v_mov_b32 v224, 0
    v_mov_b32 v225, 0
    v_mov_b32 v226, 0
    v_mov_b32 v227, 0
    v_mov_b32 v228, 0
    v_mov_b32 v229, 0
    v_mov_b32 v230, 0
    v_mov_b32 v231, 0
    s_mov_b32 s85, 0
L_slow2:
    s_add_u32 s86, s84, s85
    buffer_load_dwordx4 v[40:43], v234, s[12:15], s86 offen
    buffer_load_dwordx4 v[44:47], v234, s[12:15], s86 offen offset:64
    buffer_load_dwordx4 v[48:51], v234, s[12:15], s86 offen offset:128
    buffer_load_dwordx4 v[52:55], v234, s[12:15], s86 offen offset:192
    s_waitcnt vmcnt(0)
    v_mfma_f32_16x16x32_bf16 v[16:19], v[40:43], v[88:91], 0
    v_mfma_f32_16x16x32_bf16 v[20:23], v[40:43], v[92:95], 0
    v_mfma_f32_16x16x32_bf16 v[24:27], v[40:43], v[96:99], 0
    v_mfma_f32_16x16x32_bf16 v[16:19], v[44:47], v[100:103], v[16:19]
    v_mfma_f32_16x16x32_bf16 v[20:23], v[44:47], v[104:107], v[20:23]
    v_mfma_f32_16x16x32_bf16 v[24:27], v[44:47], v[108:111], v[24:27]
    v_mfma_f32_16x16x32_bf16 v[16:19], v[48:51], v[112:115], v[16:19]
    v_mfma_f32_16x16x32_bf16 v[20:23], v[48:51], v[116:119], v[20:23]
    v_mfma_f32_16x16x32_bf16 v[24:27], v[48:51], v[120:123], v[24:27]
    v_mfma_f32_16x16x32_bf16 v[16:19], v[52:55], v[124:127], v[16:19]
    v_mfma_f32_16x16x32_bf16 v[20:23], v[52:55], v[128:131], v[20:23]
    v_mfma_f32_16x16x32_bf16 v[24:27], v[52:55], v[132:135], v[24:27]
    s_add_u32 s86, s86, 4096
    buffer_load_dwordx4 v[40:43], v234, s[12:15], s86 offen
    buffer_load_dwordx4 v[44:47], v234, s[12:15], s86 offen offset:64
    buffer_load_dwordx4 v[48:51], v234, s[12:15], s86 offen offset:128
    buffer_load_dwordx4 v[52:55], v234, s[12:15], s86 offen offset:192
    s_waitcnt vmcnt(0)
    v_mfma_f32_16x16x32_bf16 v[28:31], v[40:43], v[88:91], 0
    v_mfma_f32_16x16x32_bf16 v[32:35], v[40:43], v[92:95], 0
    v_mfma_f32_16x16x32_bf16 v[36:39], v[40:43], v[96:99], 0
    v_mfma_f32_16x16x32_bf16 v[28:31], v[44:47], v[100:103], v[28:31]
    v_mfma_f32_16x16x32_bf16 v[32:35], v[44:47], v[104:107], v[32:35]
    v_mfma_f32_16x16x32_bf16 v[36:39], v[44:47], v[108:111], v[36:39]
    v_mfma_f32_16x16x32_bf16 v[28:31], v[48:51], v[112:115], v[28:31]
    v_mfma_f32_16x16x32_bf16 v[32:35], v[48:51], v[116:119], v[32:35]
    v_mfma_f32_16x16x32_bf16 v[36:39], v[48:51], v[120:123], v[36:39]
    v_mfma_f32_16x16x32_bf16 v[28:31], v[52:55], v[124:127], v[28:31]
    v_mfma_f32_16x16x32_bf16 v[32:35], v[52:55], v[128:131], v[32:35]
    v_mfma_f32_16x16x32_bf16 v[36:39], v[52:55], v[132:135], v[36:39]
    v_sub_f32 v16, v16, v237
    v_sub_f32 v17, v17, v237
    v_sub_f32 v18, v18, v237
    v_sub_f32 v19, v19, v237
    v_exp_f32 v16, v16
    v_exp_f32 v17, v17
    v_exp_f32 v18, v18
    v_exp_f32 v19, v19
    v_add_f32 v11, v16, v11
    v_add_f32 v11, v17, v11
    v_add_f32 v11, v18, v11
    v_add_f32 v11, v19, v11
    v_cvt_pk_bf16_f32 v64, v16, v17
    v_cvt_pk_bf16_f32 v65, v18, v19
    v_sub_f32 v20, v20, v238
    v_sub_f32 v21, v21, v238
    v_sub_f32 v22, v22, v238
    v_sub_f32 v23, v23, v238
    v_exp_f32 v20, v20
    v_exp_f32 v21, v21
    v_exp_f32 v22, v22
    v_exp_f32 v23, v23
    v_add_f32 v12, v20, v12
    v_add_f32 v12, v21, v12
    v_add_f32 v12, v22, v12
    v_add_f32 v12, v23, v12
    v_cvt_pk_bf16_f32 v68, v20, v21
    v_cvt_pk_bf16_f32 v69, v22, v23
    v_sub_f32 v24, v24, v239
    v_sub_f32 v25, v25, v239
    v_sub_f32 v26, v26, v239
    v_sub_f32 v27, v27, v239
    v_exp_f32 v24, v24
    v_exp_f32 v25, v25
    v_exp_f32 v26, v26
    v_exp_f32 v27, v27
    v_add_f32 v13, v24, v13
    v_add_f32 v13, v25, v13
    v_add_f32 v13, v26, v13
    v_add_f32 v13, v27, v13
    v_cvt_pk_bf16_f32 v72, v24, v25
    v_cvt_pk_bf16_f32 v73, v26, v27
    v_sub_f32 v28, v28, v237
    v_sub_f32 v29, v29, v237
    v_sub_f32 v30, v30, v237
    v_sub_f32 v31, v31, v237
    v_exp_f32 v28, v28
    v_exp_f32 v29, v29
    v_exp_f32 v30, v30
    v_exp_f32 v31, v31
    v_add_f32 v11, v28, v11
    v_add_f32 v11, v29, v11
    v_add_f32 v11, v30, v11
    v_add_f32 v11, v31, v11
    v_cvt_pk_bf16_f32 v66, v28, v29
    v_cvt_pk_bf16_f32 v67, v30, v31
    v_sub_f32 v32, v32, v238
    v_sub_f32 v33, v33, v238
    v_sub_f32 v34, v34, v238
    v_sub_f32 v35, v35, v238
    v_exp_f32 v32, v32
    v_exp_f32 v33, v33
    v_exp_f32 v34, v34
    v_exp_f32 v35, v35
    v_add_f32 v12, v32, v12
    v_add_f32 v12, v33, v12
    v_add_f32 v12, v34, v12
    v_add_f32 v12, v35, v12
    v_cvt_pk_bf16_f32 v70, v32, v33
    v_cvt_pk_bf16_f32 v71, v34, v35
    v_sub_f32 v36, v36, v239
    v_sub_f32 v37, v37, v239
    v_sub_f32 v38, v38, v239
    v_sub_f32 v39, v39, v239
    v_exp_f32 v36, v36
    v_exp_f32 v37, v37
    v_exp_f32 v38, v38
    v_exp_f32 v39, v39
    v_add_f32 v13, v36, v13
    v_add_f32 v13, v37, v13
    v_add_f32 v13, v38, v13
    v_add_f32 v13, v39, v13
    v_cvt_pk_bf16_f32 v74, v36, v37
    v_cvt_pk_bf16_f32 v75, v38, v39
    s_add_u32 s86, s84, s85
    s_add_u32 s86, s86, 16384
    buffer_load_ushort v56, v235, s[16:19], s86 offen
    buffer_load_ushort v57, v235, s[16:19], s86 offen offset:256
    buffer_load_ushort v58, v235, s[16:19], s86 offen offset:512
    buffer_load_ushort v59, v235, s[16:19], s86 offen offset:768
    buffer_load_ushort v60, v236, s[16:19], s86 offen
    buffer_load_ushort v61, v236, s[16:19], s86 offen offset:256
    buffer_load_ushort v62, v236, s[16:19], s86 offen offset:512
    buffer_load_ushort v63, v236, s[16:19], s86 offen offset:768
    s_waitcnt vmcnt(0)
    v_lshl_or_b32 v76, v57, 16, v56
    v_lshl_or_b32 v77, v59, 16, v58
    v_lshl_or_b32 v78, v61, 16, v60
    v_lshl_or_b32 v79, v63, 16, v62
    s_nop 1
    v_mfma_f32_16x16x32_bf16 v[136:139], v[76:79], v[64:67], v[136:139]
    s_nop 0
    v_mfma_f32_16x16x32_bf16 v[140:143], v[76:79], v[68:71], v[140:143]
    v_mfma_f32_16x16x32_bf16 v[144:147], v[76:79], v[72:75], v[144:147]
    buffer_load_ushort v56, v235, s[16:19], s86 offen offset:32
    buffer_load_ushort v57, v235, s[16:19], s86 offen offset:288
    buffer_load_ushort v58, v235, s[16:19], s86 offen offset:544
    buffer_load_ushort v59, v235, s[16:19], s86 offen offset:800
    buffer_load_ushort v60, v236, s[16:19], s86 offen offset:32
    buffer_load_ushort v61, v236, s[16:19], s86 offen offset:288
    buffer_load_ushort v62, v236, s[16:19], s86 offen offset:544
    buffer_load_ushort v63, v236, s[16:19], s86 offen offset:800
    s_waitcnt vmcnt(0)
    v_lshl_or_b32 v76, v57, 16, v56
    v_lshl_or_b32 v77, v59, 16, v58
    v_lshl_or_b32 v78, v61, 16, v60
    v_lshl_or_b32 v79, v63, 16, v62
    s_nop 1
    v_mfma_f32_16x16x32_bf16 v[148:151], v[76:79], v[64:67], v[148:151]
    s_nop 0
    v_mfma_f32_16x16x32_bf16 v[152:155], v[76:79], v[68:71], v[152:155]
    v_mfma_f32_16x16x32_bf16 v[156:159], v[76:79], v[72:75], v[156:159]
    buffer_load_ushort v56, v235, s[16:19], s86 offen offset:64
    buffer_load_ushort v57, v235, s[16:19], s86 offen offset:320
    buffer_load_ushort v58, v235, s[16:19], s86 offen offset:576
    buffer_load_ushort v59, v235, s[16:19], s86 offen offset:832
    buffer_load_ushort v60, v236, s[16:19], s86 offen offset:64
    buffer_load_ushort v61, v236, s[16:19], s86 offen offset:320
    buffer_load_ushort v62, v236, s[16:19], s86 offen offset:576
    buffer_load_ushort v63, v236, s[16:19], s86 offen offset:832
    s_waitcnt vmcnt(0)
    v_lshl_or_b32 v76, v57, 16, v56
    v_lshl_or_b32 v77, v59, 16, v58
    v_lshl_or_b32 v78, v61, 16, v60
    v_lshl_or_b32 v79, v63, 16, v62
    s_nop 1
    v_mfma_f32_16x16x32_bf16 v[160:163], v[76:79], v[64:67], v[160:163]
    s_nop 0
    v_mfma_f32_16x16x32_bf16 v[164:167], v[76:79], v[68:71], v[164:167]
    v_mfma_f32_16x16x32_bf16 v[168:171], v[76:79], v[72:75], v[168:171]
    buffer_load_ushort v56, v235, s[16:19], s86 offen offset:96
    buffer_load_ushort v57, v235, s[16:19], s86 offen offset:352
    buffer_load_ushort v58, v235, s[16:19], s86 offen offset:608
    buffer_load_ushort v59, v235, s[16:19], s86 offen offset:864
    buffer_load_ushort v60, v236, s[16:19], s86 offen offset:96
    buffer_load_ushort v61, v236, s[16:19], s86 offen offset:352
    buffer_load_ushort v62, v236, s[16:19], s86 offen offset:608
    buffer_load_ushort v63, v236, s[16:19], s86 offen offset:864
    s_waitcnt vmcnt(0)
    v_lshl_or_b32 v76, v57, 16, v56
    v_lshl_or_b32 v77, v59, 16, v58
    v_lshl_or_b32 v78, v61, 16, v60
    v_lshl_or_b32 v79, v63, 16, v62
    s_nop 1
    v_mfma_f32_16x16x32_bf16 v[172:175], v[76:79], v[64:67], v[172:175]
    s_nop 0
    v_mfma_f32_16x16x32_bf16 v[176:179], v[76:79], v[68:71], v[176:179]
    v_mfma_f32_16x16x32_bf16 v[180:183], v[76:79], v[72:75], v[180:183]
    buffer_load_ushort v56, v235, s[16:19], s86 offen offset:128
    buffer_load_ushort v57, v235, s[16:19], s86 offen offset:384
    buffer_load_ushort v58, v235, s[16:19], s86 offen offset:640
    buffer_load_ushort v59, v235, s[16:19], s86 offen offset:896
    buffer_load_ushort v60, v236, s[16:19], s86 offen offset:128
    buffer_load_ushort v61, v236, s[16:19], s86 offen offset:384
    buffer_load_ushort v62, v236, s[16:19], s86 offen offset:640
    buffer_load_ushort v63, v236, s[16:19], s86 offen offset:896
    s_waitcnt vmcnt(0)
    v_lshl_or_b32 v76, v57, 16, v56
    v_lshl_or_b32 v77, v59, 16, v58
    v_lshl_or_b32 v78, v61, 16, v60
    v_lshl_or_b32 v79, v63, 16, v62
    s_nop 1
    v_mfma_f32_16x16x32_bf16 v[184:187], v[76:79], v[64:67], v[184:187]
    s_nop 0
    v_mfma_f32_16x16x32_bf16 v[188:191], v[76:79], v[68:71], v[188:191]
    v_mfma_f32_16x16x32_bf16 v[192:195], v[76:79], v[72:75], v[192:195]
    buffer_load_ushort v56, v235, s[16:19], s86 offen offset:160
    buffer_load_ushort v57, v235, s[16:19], s86 offen offset:416
    buffer_load_ushort v58, v235, s[16:19], s86 offen offset:672
    buffer_load_ushort v59, v235, s[16:19], s86 offen offset:928
    buffer_load_ushort v60, v236, s[16:19], s86 offen offset:160
    buffer_load_ushort v61, v236, s[16:19], s86 offen offset:416
    buffer_load_ushort v62, v236, s[16:19], s86 offen offset:672
    buffer_load_ushort v63, v236, s[16:19], s86 offen offset:928
    s_waitcnt vmcnt(0)
    v_lshl_or_b32 v76, v57, 16, v56
    v_lshl_or_b32 v77, v59, 16, v58
    v_lshl_or_b32 v78, v61, 16, v60
    v_lshl_or_b32 v79, v63, 16, v62
    s_nop 1
    v_mfma_f32_16x16x32_bf16 v[196:199], v[76:79], v[64:67], v[196:199]
    s_nop 0
    v_mfma_f32_16x16x32_bf16 v[200:203], v[76:79], v[68:71], v[200:203]
    v_mfma_f32_16x16x32_bf16 v[204:207], v[76:79], v[72:75], v[204:207]
    buffer_load_ushort v56, v235, s[16:19], s86 offen offset:192
    buffer_load_ushort v57, v235, s[16:19], s86 offen offset:448
    buffer_load_ushort v58, v235, s[16:19], s86 offen offset:704
    buffer_load_ushort v59, v235, s[16:19], s86 offen offset:960
    buffer_load_ushort v60, v236, s[16:19], s86 offen offset:192
    buffer_load_ushort v61, v236, s[16:19], s86 offen offset:448
    buffer_load_ushort v62, v236, s[16:19], s86 offen offset:704
    buffer_load_ushort v63, v236, s[16:19], s86 offen offset:960
    s_waitcnt vmcnt(0)
    v_lshl_or_b32 v76, v57, 16, v56
    v_lshl_or_b32 v77, v59, 16, v58
    v_lshl_or_b32 v78, v61, 16, v60
    v_lshl_or_b32 v79, v63, 16, v62
    s_nop 1
    v_mfma_f32_16x16x32_bf16 v[208:211], v[76:79], v[64:67], v[208:211]
    s_nop 0
    v_mfma_f32_16x16x32_bf16 v[212:215], v[76:79], v[68:71], v[212:215]
    v_mfma_f32_16x16x32_bf16 v[216:219], v[76:79], v[72:75], v[216:219]
    buffer_load_ushort v56, v235, s[16:19], s86 offen offset:224
    buffer_load_ushort v57, v235, s[16:19], s86 offen offset:480
    buffer_load_ushort v58, v235, s[16:19], s86 offen offset:736
    buffer_load_ushort v59, v235, s[16:19], s86 offen offset:992
    buffer_load_ushort v60, v236, s[16:19], s86 offen offset:224
    buffer_load_ushort v61, v236, s[16:19], s86 offen offset:480
    buffer_load_ushort v62, v236, s[16:19], s86 offen offset:736
    buffer_load_ushort v63, v236, s[16:19], s86 offen offset:992
    s_waitcnt vmcnt(0)
    v_lshl_or_b32 v76, v57, 16, v56
    v_lshl_or_b32 v77, v59, 16, v58
    v_lshl_or_b32 v78, v61, 16, v60
    v_lshl_or_b32 v79, v63, 16, v62
    s_nop 1
    v_mfma_f32_16x16x32_bf16 v[220:223], v[76:79], v[64:67], v[220:223]
    s_nop 0
    v_mfma_f32_16x16x32_bf16 v[224:227], v[76:79], v[68:71], v[224:227]
    v_mfma_f32_16x16x32_bf16 v[228:231], v[76:79], v[72:75], v[228:231]
    s_add_u32 s85, s85, 8192
    s_cmp_lt_u32 s85, 131072
    s_cbranch_scc1 L_slow2
    v_mov_b32 v240, v11
    s_nop 1
    v_permlane16_swap_b32 v11, v240
    v_add_f32 v11, v11, v240
    v_mov_b32 v240, v11
    s_nop 1
    v_permlane32_swap_b32 v11, v240
    v_add_f32 v11, v11, v240
    v_rcp_f32 v248, v11
    v_mov_b32 v241, v12
    s_nop 1
    v_permlane16_swap_b32 v12, v241
    v_add_f32 v12, v12, v241
    v_mov_b32 v241, v12
    s_nop 1
    v_permlane32_swap_b32 v12, v241
    v_add_f32 v12, v12, v241
    v_rcp_f32 v249, v12
    v_mov_b32 v242, v13
    s_nop 1
    v_permlane16_swap_b32 v13, v242
    v_add_f32 v13, v13, v242
    v_mov_b32 v242, v13
    s_nop 1
    v_permlane32_swap_b32 v13, v242
    v_add_f32 v13, v13, v242
    v_rcp_f32 v250, v13
    v_mov_b32 v64, 0
    v_mov_b32 v76, 0
    v_mov_b32 v65, 0
    v_mov_b32 v77, 0
    v_mov_b32 v66, 0
    v_mov_b32 v78, 0
    v_mov_b32 v67, 0
    v_mov_b32 v79, 0
    v_mov_b32 v68, 0
    v_mov_b32 v80, 0
    v_mov_b32 v69, 0
    v_mov_b32 v81, 0
    v_mov_b32 v70, 0
    v_mov_b32 v82, 0
    v_mov_b32 v71, 0
    v_mov_b32 v83, 0
    v_mov_b32 v72, 0
    v_mov_b32 v84, 0
    v_mov_b32 v73, 0
    v_mov_b32 v85, 0
    v_mov_b32 v74, 0
    v_mov_b32 v86, 0
    v_mov_b32 v75, 0
    v_mov_b32 v87, 0
    s_nop 7
    s_nop 7
    s_cmp_lt_u32 s91, 3
    s_cbranch_scc1 L_retC
    s_branch L_retC3
L_codeend:
.section .rodata,"a"
.p2align 6
.amdhsa_kernel concat_heads__mha_block_cached__mha_block_cached__near_ridge_kernel
  .amdhsa_next_free_vgpr 512
  .amdhsa_next_free_sgpr 102
  .amdhsa_accum_offset 256
  .amdhsa_group_segment_fixed_size 0
  .amdhsa_kernarg_size 104
  .amdhsa_user_sgpr_count 2
  .amdhsa_user_sgpr_kernarg_segment_ptr 1
  .amdhsa_system_sgpr_workgroup_id_x 1
  .amdhsa_float_denorm_mode_32 3
  .amdhsa_float_denorm_mode_16_64 3
.end_amdhsa_kernel
```
